```python
import torch

def _softmax(x, axis=-1):
    return torch.softmax(x, dim=axis)
def _gelu(x):
    return torch.nn.functional.gelu(x, approximate="tanh")
def _silu(x):
    return torch.nn.functional.silu(x)
def _sigmoid(x):
    return torch.sigmoid(x)
def _layernorm(x, axis=-1, eps=1e-5):
    m = x.mean(dim=axis, keepdim=True)
    v = x.var(dim=axis, keepdim=True, unbiased=False)
    return (x - m) / torch.sqrt(v + eps)
def _scatter_add(tgt, idx, src, axis=0):
    return tgt.clone().index_add_(axis, idx, src)
def _segment_sum(src, seg, n):
    out = torch.zeros((n,) + src.shape[1:], dtype=src.dtype)
    return out.index_add_(0, seg, src)
def _pad(x, pw):
    flat = tuple(v for pair in reversed(pw) for v in pair)
    return torch.nn.functional.pad(x, flat)

kernel_name = 'parallel_sum__softmax_full_mha__dense_activation_relu__prompt'

def setup_inputs():

    _w = (lambda a: (lambda t: t.to(torch.bfloat16) if t.is_floating_point() else t)(torch.as_tensor(a)))
    def _A_setup():
        B, S, D = 1, 2048, 640
        return {
            "x": _w((lambda *s: torch.randn(*s, dtype=torch.bfloat16) * 0.05)(B, S, D)),
            "wqkv": _w((lambda *s: torch.randn(*s, dtype=torch.bfloat16) * 0.2)(D, 3 * D)),
            "wo": _w((lambda *s: torch.randn(*s, dtype=torch.bfloat16) * 0.1)(D, D)),
        }
    _A_in = _A_setup()

    def _B_setup():
        B, S, D, Dff = 1, 2048, 640, 1728
        return {
            "x": _w((lambda *s: torch.randn(*s, dtype=torch.bfloat16) * 0.05)(B, S, D)),
            "w1": _w((lambda *s: torch.randn(*s, dtype=torch.bfloat16) * 0.2)(D, Dff)),
            "w2": _w((lambda *s: torch.randn(*s, dtype=torch.bfloat16) * 0.2)(Dff, D)),
        }
    _B_in = _B_setup()

    return {
        "A_x": _A_in["x"],
        "A_wqkv": _A_in["wqkv"],
        "A_wo": _A_in["wo"],
        "B_x": _B_in["x"],
        "B_w1": _B_in["w1"],
        "B_w2": _B_in["w2"],
    }

def reference(A_x, A_wqkv, A_wo, B_x, B_w1, B_w2):
    def _A_ref(x, wqkv, wo):
        B, S, D = x.shape
        H = 32; Dh = D // H
        qkv = (lambda x, *d: x.permute(*d))((x @ wqkv).reshape(B, S, 3, H, Dh), 2, 0, 3, 1, 4)
        q, k, v = qkv[0], qkv[1], qkv[2]
        scale = Dh ** -0.5
        scores = torch.einsum("bhqd,bhkd->bhqk", q, k) * scale
        p = _softmax(scores, axis=-1)
        o = torch.einsum("bhqk,bhkd->bhqd", p, v)
        return (lambda x, *d: x.permute(*d))(o, 0, 2, 1, 3).reshape(B, S, D) @ wo

    def _B_ref(x, w1, w2):
        h = torch.einsum("bsd,df->bsf", x, w1)
        zero = torch.zeros_like(h)
        h = torch.maximum(h, zero)
        return torch.einsum("bsf,fd->bsd", h, w2)

    x = A_x
    xn = _layernorm(x, axis=-1)
    return x + _A_ref(xn, A_wqkv, A_wo) + _B_ref(xn, B_w1, B_w2)
```

```asm
; @launch kernel=fused_kernel grid=(256,1,1) block=(768,1,1) lds=163840
.amdgcn_target "amdgcn-amd-amdhsa--gfx950"
.text
.globl fused_kernel
.p2align 8
.type fused_kernel,@function
fused_kernel:
    s_cmp_ge_u32 s2, 256
    s_cbranch_scc1 L_f_end
    v_lshrrev_b32 v1, 6, v0
    s_load_dwordx2 s[12:13], s[0:1], 64
    v_readfirstlane_b32 s29, v1
    v_and_b32 v2, 63, v0
    s_and_b32 s40, s2, 7
    s_lshr_b32 s41, s2, 3
    s_cmp_lt_u32 s29, 8
    s_cbranch_scc1 L_f_comp
    s_load_dwordx4 s[4:7], s[0:1], 0
    s_load_dwordx4 s[8:11], s[0:1], 32
    s_and_b32 s14, s40, 1
    s_lshl_b32 s14, s14, 3
    s_and_b32 s15, s41, 7
    s_add_u32 s14, s14, s15
    s_lshr_b32 s15, s40, 1
    s_lshl_b32 s15, s15, 2
    s_lshr_b32 s16, s41, 3
    s_add_u32 s15, s15, s16
    s_lshl_b32 s17, s15, 2
    s_mov_b32 s18, 0x32221000
    s_mov_b32 s19, 0x55554444
    s_lshr_b64 s[18:19], s[18:19], s17
    s_and_b32 s18, s18, 15
    s_lshl_b32 s17, s15, 1
    s_sub_u32 s19, s17, s18
    s_mov_b32 s18, 2252
    s_bitcmp1_b32 s18, s15
    s_cselect_b32 s18, 1, 2
    s_mov_b32 s46, 28311552
    s_mov_b32 s47, 0x20000
    s_setprio 3
    s_sub_u32 s29, s29, 8
    s_mov_b32 s22, 2621440
    s_mov_b32 s23, 0x20000
    s_mov_b32 s27, 0x20000
    s_mov_b32 s50, 2211840
    s_mov_b32 s51, 0x20000
    s_cmp_lt_u32 s15, 15
    s_cselect_b32 s26, 2457600, 0
    v_lshrrev_b32 v3, 3, v2
    s_lshl_b32 s30, s29, 5
    s_lshl_b32 s31, s14, 7
    s_add_u32 s30, s30, s31
    v_add_u32 v3, s30, v3
    v_lshrrev_b32 v4, 4, v2
    v_and_b32 v5, 7, v2
    v_xor_b32 v6, v5, v4
    v_xor_b32 v7, 4, v6
    s_movk_i32 s32, 1280
    v_mul_lo_u32 v3, v3, s32
    v_lshl_add_u32 v10, v6, 4, v3
    v_lshl_add_u32 v11, v7, 4, v3
    v_add_u32 v11, 10240, v11
    v_and_b32 v5, 15, v2
    v_lshlrev_b32 v6, 2, v4
    v_xor_b32 v5, v5, v6
    s_lshl_b32 s30, s29, 4
    v_add_u32 v4, s30, v4
    v_mul_u32_u24 v6, 3840, v4
    v_mul_u32_u24 v7, 3456, v4
    s_lshl_b32 s31, s17, 7
    s_lshl_b32 s33, s19, 7
    v_lshl_add_u32 v6, v5, 4, v6
    v_lshl_add_u32 v7, v5, 4, v7
    v_add_u32 v12, s31, v6
    v_add_u32 v44, s33, v7
    s_lshl_b32 s33, s18, 3
    v_mov_b32 v8, 0x7fffffff
    v_cmp_gt_u32 vcc, s33, v5
    s_lshr_b32 s35, s40, 1
    s_mul_i32 s35, s35, 1
    s_and_b32 s36, s40, 1
    s_mul_i32 s36, s36, 4
    s_add_u32 s35, s35, s36
    s_bfe_u32 s36, s41, 65536
    s_mul_i32 s36, s36, 0
    s_add_u32 s35, s35, s36
    s_cmp_ge_u32 s35, 10
    s_cselect_b32 s36, 10, 0
    s_sub_u32 s35, s35, s36
    v_add_u32 v13, 15360, v12
    v_add_u32 v45, 13824, v44
    v_add_u32 v14, 30720, v12
    v_add_u32 v46, 27648, v44
    v_add_u32 v15, 46080, v12
    v_add_u32 v47, 41472, v44
    v_cndmask_b32 v44, v8, v44, vcc
    v_cndmask_b32 v45, v8, v45, vcc
    v_cndmask_b32 v46, v8, v46, vcc
    v_cndmask_b32 v47, v8, v47, vcc
    s_mul_i32 s36, s35, 245760
    s_mul_i32 s39, s35, 221184
    s_lshl_b32 s35, s35, 7
    s_lshl_b32 s37, s29, 12
    s_waitcnt lgkmcnt(0)
    s_mov_b32 s20, s4
    s_mov_b32 s21, s5
    s_mov_b32 s24, s6
    s_mov_b32 s25, s7
    s_mov_b32 s48, s8
    s_mov_b32 s49, s9
    s_add_u32 s30, s35, 20480
    s_add_u32 m0, s37, 81920
    s_nop 0
    buffer_load_dwordx4 v10, s[20:23], s35 offen lds
    s_add_u32 m0, s37, 82944
    s_nop 0
    buffer_load_dwordx4 v11, s[20:23], s35 offen lds
    s_add_u32 m0, s37, 83968
    s_nop 0
    buffer_load_dwordx4 v10, s[20:23], s30 offen lds
    s_add_u32 m0, s37, 84992
    s_nop 0
    buffer_load_dwordx4 v11, s[20:23], s30 offen lds
    s_add_u32 s35, s35, 128
    s_cmp_eq_u32 s35, 1280
    s_cselect_b32 s35, 0, s35
    s_add_u32 m0, s37, 16384
    s_nop 0
    buffer_load_dwordx4 v12, s[24:27], s36 offen lds
    s_add_u32 m0, s37, 17408
    s_nop 0
    buffer_load_dwordx4 v13, s[24:27], s36 offen lds
    s_add_u32 m0, s37, 18432
    s_nop 0
    buffer_load_dwordx4 v14, s[24:27], s36 offen lds
    s_add_u32 m0, s37, 19456
    s_nop 0
    buffer_load_dwordx4 v15, s[24:27], s36 offen lds
    s_add_u32 s36, s36, 245760
    s_cmp_eq_u32 s36, 2457600
    s_cselect_b32 s36, 0, s36
    s_add_u32 m0, s37, 32768
    s_nop 0
    buffer_load_dwordx4 v44, s[48:51], s39 offen lds
    s_add_u32 m0, s37, 33792
    s_nop 0
    buffer_load_dwordx4 v45, s[48:51], s39 offen lds
    s_add_u32 m0, s37, 34816
    s_nop 0
    buffer_load_dwordx4 v46, s[48:51], s39 offen lds
    s_add_u32 m0, s37, 35840
    s_nop 0
    buffer_load_dwordx4 v47, s[48:51], s39 offen lds
    s_add_u32 s39, s39, 221184
    s_cmp_eq_u32 s39, 2211840
    s_cselect_b32 s39, 0, s39
    s_add_u32 s30, s35, 20480
    s_add_u32 m0, s37, 98304
    s_nop 0
    buffer_load_dwordx4 v10, s[20:23], s35 offen lds
    s_add_u32 m0, s37, 99328
    s_nop 0
    buffer_load_dwordx4 v11, s[20:23], s35 offen lds
    s_add_u32 m0, s37, 100352
    s_nop 0
    buffer_load_dwordx4 v10, s[20:23], s30 offen lds
    s_add_u32 m0, s37, 101376
    s_nop 0
    buffer_load_dwordx4 v11, s[20:23], s30 offen lds
    s_add_u32 s35, s35, 128
    s_cmp_eq_u32 s35, 1280
    s_cselect_b32 s35, 0, s35
    s_add_u32 m0, s37, 49152
    s_nop 0
    buffer_load_dwordx4 v12, s[24:27], s36 offen lds
    s_add_u32 m0, s37, 50176
    s_nop 0
    buffer_load_dwordx4 v13, s[24:27], s36 offen lds
    s_add_u32 m0, s37, 51200
    s_nop 0
    buffer_load_dwordx4 v14, s[24:27], s36 offen lds
    s_add_u32 m0, s37, 52224
    s_nop 0
    buffer_load_dwordx4 v15, s[24:27], s36 offen lds
    s_add_u32 s36, s36, 245760
    s_cmp_eq_u32 s36, 2457600
    s_cselect_b32 s36, 0, s36
    s_add_u32 m0, s37, 65536
    s_nop 0
    buffer_load_dwordx4 v44, s[48:51], s39 offen lds
    s_add_u32 m0, s37, 66560
    s_nop 0
    buffer_load_dwordx4 v45, s[48:51], s39 offen lds
    s_add_u32 m0, s37, 67584
    s_nop 0
    buffer_load_dwordx4 v46, s[48:51], s39 offen lds
    s_add_u32 m0, s37, 68608
    s_nop 0
    buffer_load_dwordx4 v47, s[48:51], s39 offen lds
    s_add_u32 s39, s39, 221184
    s_cmp_eq_u32 s39, 2211840
    s_cselect_b32 s39, 0, s39
    s_load_dwordx2 s[6:7], s[0:1], 16
    v_mov_b32 v1, 0
    v_lshrrev_b32 v0, 2, v2
    v_cmp_eq_u32 vcc, 11, v0
    s_nop 1
    v_cndmask_b32 v1, v1, 12, vcc
    v_mov_b32 v0, 0x100
    v_cmp_eq_u32 vcc, 56, v2
    s_nop 1
    v_cndmask_b32 v1, v1, v0, vcc
    v_lshlrev_b32 v7, 2, v2
    ds_write_b32 v7, v1
    v_and_b32 v1, 3, v2
    v_lshlrev_b32 v1, 2, v1
    s_lshl_b32 s30, s29, 2
    v_mov_b32 v7, s30
    s_mov_b32 s44, s12
    s_mov_b32 s45, s13
    s_mov_b32 s52, s10
    s_mov_b32 s53, s11
    s_mov_b32 s55, 0x20000
    s_lshl_b32 s57, s29, 8
    s_add_u32 s58, s57, s2
    s_min_u32 s57, s58, 539
    s_mul_i32 s59, s57, 13108
    s_lshr_b32 s59, s59, 16
    s_mul_i32 s60, s59, 5
    s_sub_u32 s60, s57, s60
    s_mul_i32 s61, s59, 20480
    s_lshl_b32 s62, s60, 8
    s_add_u32 s62, s62, s61
    s_add_u32 s63, s62, 5120
    v_lshrrev_b32 v3, 5, v2
    v_and_b32 v4, 31, v2
    v_mul_u32_u24 v5, 10240, v3
    v_lshl_add_u32 v98, v4, 3, v5
    s_cmp_ge_u32 s58, 540
    s_cselect_b32 s54, 0, 2211840
    s_mov_b32 s64, s12
    s_mov_b32 s65, s13
    s_mov_b32 s67, 0x20000
    s_cselect_b32 s66, 0, 28311552
    v_lshrrev_b32 v5, 3, v4
    v_and_b32 v6, 7, v2
    v_lshlrev_b32 v5, 10, v5
    v_lshl_add_u32 v5, v6, 6, v5
    v_lshl_add_u32 v5, v3, 9, v5
    s_add_u32 s34, s37, 131072
    v_add_u32 v48, s34, v5
    v_lshlrev_b32 v6, 4, v2
    v_add_u32 v49, s34, v6
    v_add_u32 v50, s37, v6
    v_add_u32 v51, 65536, v50
    v_add_u32 v52, 131072, v50
    s_mov_b32 s56, 0xffff0000
    v_and_b32 v53, 3, v2
    v_lshrrev_b32 v54, 3, v2
    v_lshl_add_u32 v54, v53, 3, v54
    s_lshl_b32 s30, s29, 5
    v_add_u32 v54, s30, v54
    v_lshlrev_b32 v54, 2, v54
    s_lshl_b32 s69, s60, 12
    s_add_u32 s69, s69, s61
    s_add_u32 s69, s69, 17825792
    s_mul_i32 s68, s60, 108
    s_add_u32 s68, s68, s59
    s_lshl_b32 s68, s68, 7
    s_add_u32 s68, s68, 27545600
    s_waitcnt lgkmcnt(0)
    v_mov_b32 v32, 0
    v_mov_b32 v33, 0
    v_mov_b32 v34, 0
    v_mov_b32 v35, 0
    v_mov_b32 v36, 0
    v_mov_b32 v37, 0
    v_mov_b32 v38, 0
    v_mov_b32 v39, 0
    s_waitcnt vmcnt(12)
    s_barrier
    ds_read_b128 v[16:19], v51 offset:16384
    ds_read_b128 v[20:23], v51 offset:17408
    ds_read_b128 v[24:27], v51 offset:18432
    ds_read_b128 v[28:31], v51 offset:19456
    s_add_u32 s30, s35, 20480
    s_add_u32 m0, s37, 114688
    s_nop 0
    buffer_load_dwordx4 v10, s[20:23], s35 offen lds
    s_add_u32 m0, s37, 115712
    s_nop 0
    buffer_load_dwordx4 v11, s[20:23], s35 offen lds
    s_waitcnt lgkmcnt(0)
    v_lshlrev_b32 v40, 16, v16
    v_and_b32 v41, s56, v16
    v_lshlrev_b32 v42, 16, v20
    v_and_b32 v43, s56, v20
    v_add_f32 v32, v32, v40
    v_fmac_f32 v33, v40, v40
    v_add_f32 v34, v34, v42
    v_fmac_f32 v35, v42, v42
    s_add_u32 m0, s37, 116736
    s_nop 0
    buffer_load_dwordx4 v10, s[20:23], s30 offen lds
    v_add_f32 v32, v32, v41
    v_fmac_f32 v33, v41, v41
    v_add_f32 v34, v34, v43
    v_fmac_f32 v35, v43, v43
    v_lshlrev_b32 v40, 16, v24
    v_and_b32 v41, s56, v24
    v_lshlrev_b32 v42, 16, v28
    v_and_b32 v43, s56, v28
    v_add_f32 v36, v36, v40
    s_add_u32 m0, s37, 117760
    s_nop 0
    buffer_load_dwordx4 v11, s[20:23], s30 offen lds
    s_add_u32 s35, s35, 128
    s_cmp_eq_u32 s35, 1280
    s_cselect_b32 s35, 0, s35
    v_fmac_f32 v37, v40, v40
    v_add_f32 v38, v38, v42
    v_fmac_f32 v39, v42, v42
    v_add_f32 v36, v36, v41
    v_fmac_f32 v37, v41, v41
    v_add_f32 v38, v38, v43
    v_fmac_f32 v39, v43, v43
    v_lshlrev_b32 v40, 16, v17
    v_and_b32 v41, s56, v17
    s_add_u32 m0, s37, 131072
    s_nop 0
    buffer_load_dwordx4 v12, s[24:27], s36 offen lds
    v_lshlrev_b32 v42, 16, v21
    v_and_b32 v43, s56, v21
    v_add_f32 v32, v32, v40
    v_fmac_f32 v33, v40, v40
    v_add_f32 v34, v34, v42
    v_fmac_f32 v35, v42, v42
    v_add_f32 v32, v32, v41
    v_fmac_f32 v33, v41, v41
    v_add_f32 v34, v34, v43
    s_add_u32 m0, s37, 132096
    s_nop 0
    buffer_load_dwordx4 v13, s[24:27], s36 offen lds
    v_fmac_f32 v35, v43, v43
    v_lshlrev_b32 v40, 16, v25
    v_and_b32 v41, s56, v25
    v_lshlrev_b32 v42, 16, v29
    v_and_b32 v43, s56, v29
    v_add_f32 v36, v36, v40
    v_fmac_f32 v37, v40, v40
    v_add_f32 v38, v38, v42
    v_fmac_f32 v39, v42, v42
    s_add_u32 m0, s37, 133120
    s_nop 0
    buffer_load_dwordx4 v14, s[24:27], s36 offen lds
    v_add_f32 v36, v36, v41
    v_fmac_f32 v37, v41, v41
    v_add_f32 v38, v38, v43
    v_fmac_f32 v39, v43, v43
    v_lshlrev_b32 v40, 16, v18
    v_and_b32 v41, s56, v18
    v_lshlrev_b32 v42, 16, v22
    v_and_b32 v43, s56, v22
    v_add_f32 v32, v32, v40
    s_add_u32 m0, s37, 134144
    s_nop 0
    buffer_load_dwordx4 v15, s[24:27], s36 offen lds
    s_add_u32 s36, s36, 245760
    s_cmp_eq_u32 s36, 2457600
    s_cselect_b32 s36, 0, s36
    v_fmac_f32 v33, v40, v40
    v_add_f32 v34, v34, v42
    v_fmac_f32 v35, v42, v42
    v_add_f32 v32, v32, v41
    v_fmac_f32 v33, v41, v41
    v_add_f32 v34, v34, v43
    v_fmac_f32 v35, v43, v43
    v_lshlrev_b32 v40, 16, v26
    v_and_b32 v41, s56, v26
    s_add_u32 m0, s37, 147456
    s_nop 0
    buffer_load_dwordx4 v44, s[48:51], s39 offen lds
    v_lshlrev_b32 v42, 16, v30
    v_and_b32 v43, s56, v30
    v_add_f32 v36, v36, v40
    v_fmac_f32 v37, v40, v40
    v_add_f32 v38, v38, v42
    v_fmac_f32 v39, v42, v42
    v_add_f32 v36, v36, v41
    v_fmac_f32 v37, v41, v41
    v_add_f32 v38, v38, v43
    s_add_u32 m0, s37, 148480
    s_nop 0
    buffer_load_dwordx4 v45, s[48:51], s39 offen lds
    v_fmac_f32 v39, v43, v43
    v_lshlrev_b32 v40, 16, v19
    v_and_b32 v41, s56, v19
    v_lshlrev_b32 v42, 16, v23
    v_and_b32 v43, s56, v23
    v_add_f32 v32, v32, v40
    v_fmac_f32 v33, v40, v40
    v_add_f32 v34, v34, v42
    v_fmac_f32 v35, v42, v42
    s_add_u32 m0, s37, 149504
    s_nop 0
    buffer_load_dwordx4 v46, s[48:51], s39 offen lds
    v_add_f32 v32, v32, v41
    v_fmac_f32 v33, v41, v41
    v_add_f32 v34, v34, v43
    v_fmac_f32 v35, v43, v43
    v_lshlrev_b32 v40, 16, v27
    v_and_b32 v41, s56, v27
    v_lshlrev_b32 v42, 16, v31
    v_and_b32 v43, s56, v31
    v_add_f32 v36, v36, v40
    s_add_u32 m0, s37, 150528
    s_nop 0
    buffer_load_dwordx4 v47, s[48:51], s39 offen lds
    s_add_u32 s39, s39, 221184
    s_cmp_eq_u32 s39, 2211840
    s_cselect_b32 s39, 0, s39
    v_fmac_f32 v37, v40, v40
    v_add_f32 v38, v38, v42
    v_fmac_f32 v39, v42, v42
    v_add_f32 v36, v36, v41
    v_fmac_f32 v37, v41, v41
    v_add_f32 v38, v38, v43
    v_fmac_f32 v39, v43, v43
    s_waitcnt vmcnt(12)
    s_barrier
    ds_read_b128 v[16:19], v51 offset:32768
    ds_read_b128 v[20:23], v51 offset:33792
    ds_read_b128 v[24:27], v51 offset:34816
    ds_read_b128 v[28:31], v51 offset:35840
    s_add_u32 s30, s35, 20480
    s_add_u32 m0, s37, 81920
    s_nop 0
    buffer_load_dwordx4 v10, s[20:23], s35 offen lds
    s_add_u32 m0, s37, 82944
    s_nop 0
    buffer_load_dwordx4 v11, s[20:23], s35 offen lds
    s_waitcnt lgkmcnt(0)
    v_lshlrev_b32 v40, 16, v16
    v_and_b32 v41, s56, v16
    v_lshlrev_b32 v42, 16, v20
    v_and_b32 v43, s56, v20
    v_add_f32 v32, v32, v40
    v_fmac_f32 v33, v40, v40
    v_add_f32 v34, v34, v42
    v_fmac_f32 v35, v42, v42
    s_add_u32 m0, s37, 83968
    s_nop 0
    buffer_load_dwordx4 v10, s[20:23], s30 offen lds
    v_add_f32 v32, v32, v41
    v_fmac_f32 v33, v41, v41
    v_add_f32 v34, v34, v43
    v_fmac_f32 v35, v43, v43
    v_lshlrev_b32 v40, 16, v24
    v_and_b32 v41, s56, v24
    v_lshlrev_b32 v42, 16, v28
    v_and_b32 v43, s56, v28
    v_add_f32 v36, v36, v40
    s_add_u32 m0, s37, 84992
    s_nop 0
    buffer_load_dwordx4 v11, s[20:23], s30 offen lds
    s_add_u32 s35, s35, 128
    s_cmp_eq_u32 s35, 1280
    s_cselect_b32 s35, 0, s35
    v_fmac_f32 v37, v40, v40
    v_add_f32 v38, v38, v42
    v_fmac_f32 v39, v42, v42
    v_add_f32 v36, v36, v41
    v_fmac_f32 v37, v41, v41
    v_add_f32 v38, v38, v43
    v_fmac_f32 v39, v43, v43
    v_lshlrev_b32 v40, 16, v17
    v_and_b32 v41, s56, v17
    s_add_u32 m0, s37, 16384
    s_nop 0
    buffer_load_dwordx4 v12, s[24:27], s36 offen lds
    v_lshlrev_b32 v42, 16, v21
    v_and_b32 v43, s56, v21
    v_add_f32 v32, v32, v40
    v_fmac_f32 v33, v40, v40
    v_add_f32 v34, v34, v42
    v_fmac_f32 v35, v42, v42
    v_add_f32 v32, v32, v41
    v_fmac_f32 v33, v41, v41
    v_add_f32 v34, v34, v43
    s_add_u32 m0, s37, 17408
    s_nop 0
    buffer_load_dwordx4 v13, s[24:27], s36 offen lds
    v_fmac_f32 v35, v43, v43
    v_lshlrev_b32 v40, 16, v25
    v_and_b32 v41, s56, v25
    v_lshlrev_b32 v42, 16, v29
    v_and_b32 v43, s56, v29
    v_add_f32 v36, v36, v40
    v_fmac_f32 v37, v40, v40
    v_add_f32 v38, v38, v42
    v_fmac_f32 v39, v42, v42
    s_add_u32 m0, s37, 18432
    s_nop 0
    buffer_load_dwordx4 v14, s[24:27], s36 offen lds
    v_add_f32 v36, v36, v41
    v_fmac_f32 v37, v41, v41
    v_add_f32 v38, v38, v43
    v_fmac_f32 v39, v43, v43
    v_lshlrev_b32 v40, 16, v18
    v_and_b32 v41, s56, v18
    v_lshlrev_b32 v42, 16, v22
    v_and_b32 v43, s56, v22
    v_add_f32 v32, v32, v40
    s_add_u32 m0, s37, 19456
    s_nop 0
    buffer_load_dwordx4 v15, s[24:27], s36 offen lds
    s_add_u32 s36, s36, 245760
    s_cmp_eq_u32 s36, 2457600
    s_cselect_b32 s36, 0, s36
    v_fmac_f32 v33, v40, v40
    v_add_f32 v34, v34, v42
    v_fmac_f32 v35, v42, v42
    v_add_f32 v32, v32, v41
    v_fmac_f32 v33, v41, v41
    v_add_f32 v34, v34, v43
    v_fmac_f32 v35, v43, v43
    v_lshlrev_b32 v40, 16, v26
    v_and_b32 v41, s56, v26
    s_add_u32 m0, s37, 32768
    s_nop 0
    buffer_load_dwordx4 v44, s[48:51], s39 offen lds
    v_lshlrev_b32 v42, 16, v30
    v_and_b32 v43, s56, v30
    v_add_f32 v36, v36, v40
    v_fmac_f32 v37, v40, v40
    v_add_f32 v38, v38, v42
    v_fmac_f32 v39, v42, v42
    v_add_f32 v36, v36, v41
    v_fmac_f32 v37, v41, v41
    v_add_f32 v38, v38, v43
    s_add_u32 m0, s37, 33792
    s_nop 0
    buffer_load_dwordx4 v45, s[48:51], s39 offen lds
    v_fmac_f32 v39, v43, v43
    v_lshlrev_b32 v40, 16, v19
    v_and_b32 v41, s56, v19
    v_lshlrev_b32 v42, 16, v23
    v_and_b32 v43, s56, v23
    v_add_f32 v32, v32, v40
    v_fmac_f32 v33, v40, v40
    v_add_f32 v34, v34, v42
    v_fmac_f32 v35, v42, v42
    s_add_u32 m0, s37, 34816
    s_nop 0
    buffer_load_dwordx4 v46, s[48:51], s39 offen lds
    v_add_f32 v32, v32, v41
    v_fmac_f32 v33, v41, v41
    v_add_f32 v34, v34, v43
    v_fmac_f32 v35, v43, v43
    v_lshlrev_b32 v40, 16, v27
    v_and_b32 v41, s56, v27
    v_lshlrev_b32 v42, 16, v31
    v_and_b32 v43, s56, v31
    v_add_f32 v36, v36, v40
    s_add_u32 m0, s37, 35840
    s_nop 0
    buffer_load_dwordx4 v47, s[48:51], s39 offen lds
    s_add_u32 s39, s39, 221184
    s_cmp_eq_u32 s39, 2211840
    s_cselect_b32 s39, 0, s39
    v_fmac_f32 v37, v40, v40
    v_add_f32 v38, v38, v42
    v_fmac_f32 v39, v42, v42
    v_add_f32 v36, v36, v41
    v_fmac_f32 v37, v41, v41
    v_add_f32 v38, v38, v43
    v_fmac_f32 v39, v43, v43
    s_waitcnt vmcnt(12)
    s_barrier
    ds_read_b128 v[16:19], v51 offset:49152
    ds_read_b128 v[20:23], v51 offset:50176
    ds_read_b128 v[24:27], v51 offset:51200
    ds_read_b128 v[28:31], v51 offset:52224
    s_add_u32 s30, s35, 20480
    s_add_u32 m0, s37, 98304
    s_nop 0
    buffer_load_dwordx4 v10, s[20:23], s35 offen lds
    s_add_u32 m0, s37, 99328
    s_nop 0
    buffer_load_dwordx4 v11, s[20:23], s35 offen lds
    s_waitcnt lgkmcnt(0)
    v_lshlrev_b32 v40, 16, v16
    v_and_b32 v41, s56, v16
    v_lshlrev_b32 v42, 16, v20
    v_and_b32 v43, s56, v20
    v_add_f32 v32, v32, v40
    v_fmac_f32 v33, v40, v40
    v_add_f32 v34, v34, v42
    v_fmac_f32 v35, v42, v42
    s_add_u32 m0, s37, 100352
    s_nop 0
    buffer_load_dwordx4 v10, s[20:23], s30 offen lds
    v_add_f32 v32, v32, v41
    v_fmac_f32 v33, v41, v41
    v_add_f32 v34, v34, v43
    v_fmac_f32 v35, v43, v43
    v_lshlrev_b32 v40, 16, v24
    v_and_b32 v41, s56, v24
    v_lshlrev_b32 v42, 16, v28
    v_and_b32 v43, s56, v28
    v_add_f32 v36, v36, v40
    s_add_u32 m0, s37, 101376
    s_nop 0
    buffer_load_dwordx4 v11, s[20:23], s30 offen lds
    s_add_u32 s35, s35, 128
    s_cmp_eq_u32 s35, 1280
    s_cselect_b32 s35, 0, s35
    v_fmac_f32 v37, v40, v40
    v_add_f32 v38, v38, v42
    v_fmac_f32 v39, v42, v42
    v_add_f32 v36, v36, v41
    v_fmac_f32 v37, v41, v41
    v_add_f32 v38, v38, v43
    v_fmac_f32 v39, v43, v43
    v_lshlrev_b32 v40, 16, v17
    v_and_b32 v41, s56, v17
    s_add_u32 m0, s37, 49152
    s_nop 0
    buffer_load_dwordx4 v12, s[24:27], s36 offen lds
    v_lshlrev_b32 v42, 16, v21
    v_and_b32 v43, s56, v21
    v_add_f32 v32, v32, v40
    v_fmac_f32 v33, v40, v40
    v_add_f32 v34, v34, v42
    v_fmac_f32 v35, v42, v42
    v_add_f32 v32, v32, v41
    v_fmac_f32 v33, v41, v41
    v_add_f32 v34, v34, v43
    s_add_u32 m0, s37, 50176
    s_nop 0
    buffer_load_dwordx4 v13, s[24:27], s36 offen lds
    v_fmac_f32 v35, v43, v43
    v_lshlrev_b32 v40, 16, v25
    v_and_b32 v41, s56, v25
    v_lshlrev_b32 v42, 16, v29
    v_and_b32 v43, s56, v29
    v_add_f32 v36, v36, v40
    v_fmac_f32 v37, v40, v40
    v_add_f32 v38, v38, v42
    v_fmac_f32 v39, v42, v42
    s_add_u32 m0, s37, 51200
    s_nop 0
    buffer_load_dwordx4 v14, s[24:27], s36 offen lds
    v_add_f32 v36, v36, v41
    v_fmac_f32 v37, v41, v41
    v_add_f32 v38, v38, v43
    v_fmac_f32 v39, v43, v43
    v_lshlrev_b32 v40, 16, v18
    v_and_b32 v41, s56, v18
    v_lshlrev_b32 v42, 16, v22
    v_and_b32 v43, s56, v22
    v_add_f32 v32, v32, v40
    s_add_u32 m0, s37, 52224
    s_nop 0
    buffer_load_dwordx4 v15, s[24:27], s36 offen lds
    s_add_u32 s36, s36, 245760
    s_cmp_eq_u32 s36, 2457600
    s_cselect_b32 s36, 0, s36
    v_fmac_f32 v33, v40, v40
    v_add_f32 v34, v34, v42
    v_fmac_f32 v35, v42, v42
    v_add_f32 v32, v32, v41
    v_fmac_f32 v33, v41, v41
    v_add_f32 v34, v34, v43
    v_fmac_f32 v35, v43, v43
    v_lshlrev_b32 v40, 16, v26
    v_and_b32 v41, s56, v26
    s_add_u32 m0, s37, 65536
    s_nop 0
    buffer_load_dwordx4 v44, s[48:51], s39 offen lds
    v_lshlrev_b32 v42, 16, v30
    v_and_b32 v43, s56, v30
    v_add_f32 v36, v36, v40
    v_fmac_f32 v37, v40, v40
    v_add_f32 v38, v38, v42
    v_fmac_f32 v39, v42, v42
    v_add_f32 v36, v36, v41
    v_fmac_f32 v37, v41, v41
    v_add_f32 v38, v38, v43
    s_add_u32 m0, s37, 66560
    s_nop 0
    buffer_load_dwordx4 v45, s[48:51], s39 offen lds
    v_fmac_f32 v39, v43, v43
    v_lshlrev_b32 v40, 16, v19
    v_and_b32 v41, s56, v19
    v_lshlrev_b32 v42, 16, v23
    v_and_b32 v43, s56, v23
    v_add_f32 v32, v32, v40
    v_fmac_f32 v33, v40, v40
    v_add_f32 v34, v34, v42
    v_fmac_f32 v35, v42, v42
    s_add_u32 m0, s37, 67584
    s_nop 0
    buffer_load_dwordx4 v46, s[48:51], s39 offen lds
    v_add_f32 v32, v32, v41
    v_fmac_f32 v33, v41, v41
    v_add_f32 v34, v34, v43
    v_fmac_f32 v35, v43, v43
    v_lshlrev_b32 v40, 16, v27
    v_and_b32 v41, s56, v27
    v_lshlrev_b32 v42, 16, v31
    v_and_b32 v43, s56, v31
    v_add_f32 v36, v36, v40
    s_add_u32 m0, s37, 68608
    s_nop 0
    buffer_load_dwordx4 v47, s[48:51], s39 offen lds
    s_add_u32 s39, s39, 221184
    s_cmp_eq_u32 s39, 2211840
    s_cselect_b32 s39, 0, s39
    v_fmac_f32 v37, v40, v40
    v_add_f32 v38, v38, v42
    v_fmac_f32 v39, v42, v42
    v_add_f32 v36, v36, v41
    v_fmac_f32 v37, v41, v41
    v_add_f32 v38, v38, v43
    v_fmac_f32 v39, v43, v43
    s_waitcnt vmcnt(12)
    s_barrier
    ds_read_b128 v[16:19], v51 offset:16384
    ds_read_b128 v[20:23], v51 offset:17408
    ds_read_b128 v[24:27], v51 offset:18432
    ds_read_b128 v[28:31], v51 offset:19456
    s_add_u32 s30, s35, 20480
    s_add_u32 m0, s37, 131072
    s_nop 0
    buffer_load_dwordx4 v10, s[20:23], s35 offen lds
    s_add_u32 m0, s37, 132096
    s_nop 0
    buffer_load_dwordx4 v11, s[20:23], s35 offen lds
    s_waitcnt lgkmcnt(0)
    v_lshlrev_b32 v40, 16, v16
    v_and_b32 v41, s56, v16
    v_lshlrev_b32 v42, 16, v20
    v_and_b32 v43, s56, v20
    v_add_f32 v32, v32, v40
    v_fmac_f32 v33, v40, v40
    v_add_f32 v34, v34, v42
    v_fmac_f32 v35, v42, v42
    s_add_u32 m0, s37, 133120
    s_nop 0
    buffer_load_dwordx4 v10, s[20:23], s30 offen lds
    v_add_f32 v32, v32, v41
    v_fmac_f32 v33, v41, v41
    v_add_f32 v34, v34, v43
    v_fmac_f32 v35, v43, v43
    v_lshlrev_b32 v40, 16, v24
    v_and_b32 v41, s56, v24
    v_lshlrev_b32 v42, 16, v28
    v_and_b32 v43, s56, v28
    v_add_f32 v36, v36, v40
    s_add_u32 m0, s37, 134144
    s_nop 0
    buffer_load_dwordx4 v11, s[20:23], s30 offen lds
    s_add_u32 s35, s35, 128
    s_cmp_eq_u32 s35, 1280
    s_cselect_b32 s35, 0, s35
    v_fmac_f32 v37, v40, v40
    v_add_f32 v38, v38, v42
    v_fmac_f32 v39, v42, v42
    v_add_f32 v36, v36, v41
    v_fmac_f32 v37, v41, v41
    v_add_f32 v38, v38, v43
    v_fmac_f32 v39, v43, v43
    v_lshlrev_b32 v40, 16, v17
    v_and_b32 v41, s56, v17
    s_add_u32 m0, s37, 114688
    s_nop 0
    buffer_load_dwordx4 v12, s[24:27], s36 offen lds
    v_lshlrev_b32 v42, 16, v21
    v_and_b32 v43, s56, v21
    v_add_f32 v32, v32, v40
    v_fmac_f32 v33, v40, v40
    v_add_f32 v34, v34, v42
    v_fmac_f32 v35, v42, v42
    v_add_f32 v32, v32, v41
    v_fmac_f32 v33, v41, v41
    v_add_f32 v34, v34, v43
    s_add_u32 m0, s37, 115712
    s_nop 0
    buffer_load_dwordx4 v13, s[24:27], s36 offen lds
    v_fmac_f32 v35, v43, v43
    v_lshlrev_b32 v40, 16, v25
    v_and_b32 v41, s56, v25
    v_lshlrev_b32 v42, 16, v29
    v_and_b32 v43, s56, v29
    v_add_f32 v36, v36, v40
    v_fmac_f32 v37, v40, v40
    v_add_f32 v38, v38, v42
    v_fmac_f32 v39, v42, v42
    s_add_u32 m0, s37, 116736
    s_nop 0
    buffer_load_dwordx4 v14, s[24:27], s36 offen lds
    v_add_f32 v36, v36, v41
    v_fmac_f32 v37, v41, v41
    v_add_f32 v38, v38, v43
    v_fmac_f32 v39, v43, v43
    v_lshlrev_b32 v40, 16, v18
    v_and_b32 v41, s56, v18
    v_lshlrev_b32 v42, 16, v22
    v_and_b32 v43, s56, v22
    v_add_f32 v32, v32, v40
    s_add_u32 m0, s37, 117760
    s_nop 0
    buffer_load_dwordx4 v15, s[24:27], s36 offen lds
    s_add_u32 s36, s36, 245760
    s_cmp_eq_u32 s36, 2457600
    s_cselect_b32 s36, 0, s36
    v_fmac_f32 v33, v40, v40
    v_add_f32 v34, v34, v42
    v_fmac_f32 v35, v42, v42
    v_add_f32 v32, v32, v41
    v_fmac_f32 v33, v41, v41
    v_add_f32 v34, v34, v43
    v_fmac_f32 v35, v43, v43
    v_lshlrev_b32 v40, 16, v26
    v_and_b32 v41, s56, v26
    s_add_u32 s30, s35, 20480
    s_add_u32 m0, s37, 147456
    s_nop 0
    buffer_load_dwordx4 v10, s[20:23], s35 offen lds
    v_lshlrev_b32 v42, 16, v30
    v_and_b32 v43, s56, v30
    v_add_f32 v36, v36, v40
    v_fmac_f32 v37, v40, v40
    v_add_f32 v38, v38, v42
    v_fmac_f32 v39, v42, v42
    v_add_f32 v36, v36, v41
    v_fmac_f32 v37, v41, v41
    v_add_f32 v38, v38, v43
    s_add_u32 m0, s37, 148480
    s_nop 0
    buffer_load_dwordx4 v11, s[20:23], s35 offen lds
    v_fmac_f32 v39, v43, v43
    v_lshlrev_b32 v40, 16, v19
    v_and_b32 v41, s56, v19
    v_lshlrev_b32 v42, 16, v23
    v_and_b32 v43, s56, v23
    v_add_f32 v32, v32, v40
    v_fmac_f32 v33, v40, v40
    v_add_f32 v34, v34, v42
    v_fmac_f32 v35, v42, v42
    s_add_u32 m0, s37, 149504
    s_nop 0
    buffer_load_dwordx4 v10, s[20:23], s30 offen lds
    v_add_f32 v32, v32, v41
    v_fmac_f32 v33, v41, v41
    v_add_f32 v34, v34, v43
    v_fmac_f32 v35, v43, v43
    v_lshlrev_b32 v40, 16, v27
    v_and_b32 v41, s56, v27
    v_lshlrev_b32 v42, 16, v31
    v_and_b32 v43, s56, v31
    v_add_f32 v36, v36, v40
    s_add_u32 m0, s37, 150528
    s_nop 0
    buffer_load_dwordx4 v11, s[20:23], s30 offen lds
    s_add_u32 s35, s35, 128
    s_cmp_eq_u32 s35, 1280
    s_cselect_b32 s35, 0, s35
    v_fmac_f32 v37, v40, v40
    v_add_f32 v38, v38, v42
    v_fmac_f32 v39, v42, v42
    v_add_f32 v36, v36, v41
    v_fmac_f32 v37, v41, v41
    v_add_f32 v38, v38, v43
    v_fmac_f32 v39, v43, v43
    v_bfe_u32 v55, v2, 1, 4
    v_mul_u32_u24 v55, 1280, v55
    v_and_b32 v0, 1, v2
    v_lshl_add_u32 v55, v0, 7, v55
    buffer_load_dword v55, v55, s[52:55], s62 offen
    s_waitcnt vmcnt(9)
    s_barrier
    ds_read_b128 v[16:19], v51 offset:32768
    ds_read_b128 v[20:23], v51 offset:33792
    ds_read_b128 v[24:27], v51 offset:34816
    ds_read_b128 v[28:31], v51 offset:35840
    ds_read_b128 v[56:59], v52 offset:0
    ds_read_b128 v[60:63], v52 offset:1024
    ds_read_b128 v[64:67], v52 offset:2048
    ds_read_b128 v[68:71], v52 offset:3072
    s_add_u32 m0, s37, 16384
    s_nop 0
    buffer_load_dwordx4 v12, s[24:27], s36 offen lds
    s_add_u32 m0, s37, 17408
    s_nop 0
    buffer_load_dwordx4 v13, s[24:27], s36 offen lds
    s_waitcnt lgkmcnt(4)
    v_lshlrev_b32 v40, 16, v16
    v_and_b32 v41, s56, v16
    v_lshlrev_b32 v42, 16, v20
    v_and_b32 v43, s56, v20
    v_add_f32 v32, v32, v40
    v_fmac_f32 v33, v40, v40
    v_add_f32 v34, v34, v42
    v_fmac_f32 v35, v42, v42
    v_add_f32 v32, v32, v41
    v_fmac_f32 v33, v41, v41
    v_add_f32 v34, v34, v43
    v_fmac_f32 v35, v43, v43
    v_lshlrev_b32 v40, 16, v24
    v_and_b32 v41, s56, v24
    v_lshlrev_b32 v42, 16, v28
    v_and_b32 v43, s56, v28
    v_add_f32 v36, v36, v40
    s_add_u32 m0, s37, 18432
    s_nop 0
    buffer_load_dwordx4 v14, s[24:27], s36 offen lds
    v_fmac_f32 v37, v40, v40
    v_add_f32 v38, v38, v42
    v_fmac_f32 v39, v42, v42
    v_add_f32 v36, v36, v41
    v_fmac_f32 v37, v41, v41
    v_add_f32 v38, v38, v43
    v_fmac_f32 v39, v43, v43
    v_lshlrev_b32 v40, 16, v17
    v_and_b32 v41, s56, v17
    v_lshlrev_b32 v42, 16, v21
    v_and_b32 v43, s56, v21
    v_add_f32 v32, v32, v40
    v_fmac_f32 v33, v40, v40
    v_add_f32 v34, v34, v42
    v_fmac_f32 v35, v42, v42
    v_add_f32 v32, v32, v41
    v_fmac_f32 v33, v41, v41
    v_add_f32 v34, v34, v43
    s_add_u32 m0, s37, 19456
    s_nop 0
    buffer_load_dwordx4 v15, s[24:27], s36 offen lds
    s_add_u32 s36, s36, 245760
    s_cmp_eq_u32 s36, 2457600
    s_cselect_b32 s36, 0, s36
    v_fmac_f32 v35, v43, v43
    v_lshlrev_b32 v40, 16, v25
    v_and_b32 v41, s56, v25
    v_lshlrev_b32 v42, 16, v29
    v_and_b32 v43, s56, v29
    v_add_f32 v36, v36, v40
    v_fmac_f32 v37, v40, v40
    v_add_f32 v38, v38, v42
    v_fmac_f32 v39, v42, v42
    v_add_f32 v36, v36, v41
    v_fmac_f32 v37, v41, v41
    v_add_f32 v38, v38, v43
    v_fmac_f32 v39, v43, v43
    v_lshlrev_b32 v40, 16, v18
    v_and_b32 v41, s56, v18
    v_lshlrev_b32 v42, 16, v22
    v_and_b32 v43, s56, v22
    v_add_f32 v32, v32, v40
    s_add_u32 s30, s35, 20480
    s_add_u32 m0, s37, 81920
    s_nop 0
    buffer_load_dwordx4 v10, s[20:23], s35 offen lds
    v_fmac_f32 v33, v40, v40
    v_add_f32 v34, v34, v42
    v_fmac_f32 v35, v42, v42
    v_add_f32 v32, v32, v41
    v_fmac_f32 v33, v41, v41
    v_add_f32 v34, v34, v43
    v_fmac_f32 v35, v43, v43
    v_lshlrev_b32 v40, 16, v26
    v_and_b32 v41, s56, v26
    v_lshlrev_b32 v42, 16, v30
    v_and_b32 v43, s56, v30
    v_add_f32 v36, v36, v40
    v_fmac_f32 v37, v40, v40
    v_add_f32 v38, v38, v42
    v_fmac_f32 v39, v42, v42
    v_add_f32 v36, v36, v41
    v_fmac_f32 v37, v41, v41
    v_add_f32 v38, v38, v43
    s_add_u32 m0, s37, 82944
    s_nop 0
    buffer_load_dwordx4 v11, s[20:23], s35 offen lds
    v_fmac_f32 v39, v43, v43
    v_lshlrev_b32 v40, 16, v19
    v_and_b32 v41, s56, v19
    v_lshlrev_b32 v42, 16, v23
    v_and_b32 v43, s56, v23
    v_add_f32 v32, v32, v40
    v_fmac_f32 v33, v40, v40
    v_add_f32 v34, v34, v42
    v_fmac_f32 v35, v42, v42
    v_add_f32 v32, v32, v41
    v_fmac_f32 v33, v41, v41
    v_add_f32 v34, v34, v43
    v_fmac_f32 v35, v43, v43
    v_lshlrev_b32 v40, 16, v27
    v_and_b32 v41, s56, v27
    v_lshlrev_b32 v42, 16, v31
    v_and_b32 v43, s56, v31
    v_add_f32 v36, v36, v40
    s_add_u32 m0, s37, 83968
    s_nop 0
    buffer_load_dwordx4 v10, s[20:23], s30 offen lds
    v_fmac_f32 v37, v40, v40
    v_add_f32 v38, v38, v42
    v_fmac_f32 v39, v42, v42
    v_add_f32 v36, v36, v41
    v_fmac_f32 v37, v41, v41
    v_add_f32 v38, v38, v43
    v_fmac_f32 v39, v43, v43
    s_waitcnt lgkmcnt(0)
    v_lshlrev_b32 v40, 16, v56
    v_and_b32 v41, s56, v56
    v_lshlrev_b32 v42, 16, v60
    v_and_b32 v43, s56, v60
    v_add_f32 v32, v32, v40
    v_fmac_f32 v33, v40, v40
    v_add_f32 v34, v34, v42
    v_fmac_f32 v35, v42, v42
    v_add_f32 v32, v32, v41
    v_fmac_f32 v33, v41, v41
    s_add_u32 m0, s37, 84992
    s_nop 0
    buffer_load_dwordx4 v11, s[20:23], s30 offen lds
    s_add_u32 s35, s35, 128
    s_cmp_eq_u32 s35, 1280
    s_cselect_b32 s35, 0, s35
    v_add_f32 v34, v34, v43
    v_fmac_f32 v35, v43, v43
    v_lshlrev_b32 v40, 16, v64
    v_and_b32 v41, s56, v64
    v_lshlrev_b32 v42, 16, v68
    v_and_b32 v43, s56, v68
    v_add_f32 v36, v36, v40
    v_fmac_f32 v37, v40, v40
    v_add_f32 v38, v38, v42
    v_fmac_f32 v39, v42, v42
    v_add_f32 v36, v36, v41
    v_fmac_f32 v37, v41, v41
    v_add_f32 v38, v38, v43
    v_fmac_f32 v39, v43, v43
    v_lshlrev_b32 v40, 16, v57
    v_and_b32 v41, s56, v57
    v_lshlrev_b32 v42, 16, v61
    v_and_b32 v43, s56, v61
    s_add_u32 m0, s37, 32768
    s_nop 0
    buffer_load_dwordx4 v12, s[24:27], s36 offen lds
    v_add_f32 v32, v32, v40
    v_fmac_f32 v33, v40, v40
    v_add_f32 v34, v34, v42
    v_fmac_f32 v35, v42, v42
    v_add_f32 v32, v32, v41
    v_fmac_f32 v33, v41, v41
    v_add_f32 v34, v34, v43
    v_fmac_f32 v35, v43, v43
    v_lshlrev_b32 v40, 16, v65
    v_and_b32 v41, s56, v65
    v_lshlrev_b32 v42, 16, v69
    v_and_b32 v43, s56, v69
    v_add_f32 v36, v36, v40
    v_fmac_f32 v37, v40, v40
    v_add_f32 v38, v38, v42
    v_fmac_f32 v39, v42, v42
    v_add_f32 v36, v36, v41
    v_fmac_f32 v37, v41, v41
    s_add_u32 m0, s37, 33792
    s_nop 0
    buffer_load_dwordx4 v13, s[24:27], s36 offen lds
    v_add_f32 v38, v38, v43
    v_fmac_f32 v39, v43, v43
    v_lshlrev_b32 v40, 16, v58
    v_and_b32 v41, s56, v58
    v_lshlrev_b32 v42, 16, v62
    v_and_b32 v43, s56, v62
    v_add_f32 v32, v32, v40
    v_fmac_f32 v33, v40, v40
    v_add_f32 v34, v34, v42
    v_fmac_f32 v35, v42, v42
    v_add_f32 v32, v32, v41
    v_fmac_f32 v33, v41, v41
    v_add_f32 v34, v34, v43
    v_fmac_f32 v35, v43, v43
    v_lshlrev_b32 v40, 16, v66
    v_and_b32 v41, s56, v66
    v_lshlrev_b32 v42, 16, v70
    v_and_b32 v43, s56, v70
    s_add_u32 m0, s37, 34816
    s_nop 0
    buffer_load_dwordx4 v14, s[24:27], s36 offen lds
    v_add_f32 v36, v36, v40
    v_fmac_f32 v37, v40, v40
    v_add_f32 v38, v38, v42
    v_fmac_f32 v39, v42, v42
    v_add_f32 v36, v36, v41
    v_fmac_f32 v37, v41, v41
    v_add_f32 v38, v38, v43
    v_fmac_f32 v39, v43, v43
    v_lshlrev_b32 v40, 16, v59
    v_and_b32 v41, s56, v59
    v_lshlrev_b32 v42, 16, v63
    v_and_b32 v43, s56, v63
    v_add_f32 v32, v32, v40
    v_fmac_f32 v33, v40, v40
    v_add_f32 v34, v34, v42
    v_fmac_f32 v35, v42, v42
    v_add_f32 v32, v32, v41
    v_fmac_f32 v33, v41, v41
    s_add_u32 m0, s37, 35840
    s_nop 0
    buffer_load_dwordx4 v15, s[24:27], s36 offen lds
    s_add_u32 s36, s36, 245760
    s_cmp_eq_u32 s36, 2457600
    s_cselect_b32 s36, 0, s36
    v_add_f32 v34, v34, v43
    v_fmac_f32 v35, v43, v43
    v_lshlrev_b32 v40, 16, v67
    v_and_b32 v41, s56, v67
    v_lshlrev_b32 v42, 16, v71
    v_and_b32 v43, s56, v71
    v_add_f32 v36, v36, v40
    v_fmac_f32 v37, v40, v40
    v_add_f32 v38, v38, v42
    v_fmac_f32 v39, v42, v42
    v_add_f32 v36, v36, v41
    v_fmac_f32 v37, v41, v41
    v_add_f32 v38, v38, v43
    v_fmac_f32 v39, v43, v43
    s_waitcnt vmcnt(13)
    s_barrier
    ds_read_b128 v[16:19], v52 offset:16384
    ds_read_b128 v[20:23], v52 offset:17408
    ds_read_b128 v[24:27], v52 offset:18432
    ds_read_b128 v[28:31], v52 offset:19456
    s_add_u32 s30, s35, 20480
    s_add_u32 m0, s37, 98304
    s_nop 0
    buffer_load_dwordx4 v10, s[20:23], s35 offen lds
    s_add_u32 m0, s37, 99328
    s_nop 0
    buffer_load_dwordx4 v11, s[20:23], s35 offen lds
    s_waitcnt lgkmcnt(0)
    v_lshlrev_b32 v40, 16, v16
    v_and_b32 v41, s56, v16
    v_lshlrev_b32 v42, 16, v20
    v_and_b32 v43, s56, v20
    v_add_f32 v32, v32, v40
    v_fmac_f32 v33, v40, v40
    v_add_f32 v34, v34, v42
    v_fmac_f32 v35, v42, v42
    s_add_u32 m0, s37, 100352
    s_nop 0
    buffer_load_dwordx4 v10, s[20:23], s30 offen lds
    v_add_f32 v32, v32, v41
    v_fmac_f32 v33, v41, v41
    v_add_f32 v34, v34, v43
    v_fmac_f32 v35, v43, v43
    v_lshlrev_b32 v40, 16, v24
    v_and_b32 v41, s56, v24
    v_lshlrev_b32 v42, 16, v28
    v_and_b32 v43, s56, v28
    v_add_f32 v36, v36, v40
    s_add_u32 m0, s37, 101376
    s_nop 0
    buffer_load_dwordx4 v11, s[20:23], s30 offen lds
    s_add_u32 s35, s35, 128
    s_cmp_eq_u32 s35, 1280
    s_cselect_b32 s35, 0, s35
    v_fmac_f32 v37, v40, v40
    v_add_f32 v38, v38, v42
    v_fmac_f32 v39, v42, v42
    v_add_f32 v36, v36, v41
    v_fmac_f32 v37, v41, v41
    v_add_f32 v38, v38, v43
    v_fmac_f32 v39, v43, v43
    v_lshlrev_b32 v40, 16, v17
    v_and_b32 v41, s56, v17
    s_add_u32 m0, s37, 49152
    s_nop 0
    buffer_load_dwordx4 v12, s[24:27], s36 offen lds
    v_lshlrev_b32 v42, 16, v21
    v_and_b32 v43, s56, v21
    v_add_f32 v32, v32, v40
    v_fmac_f32 v33, v40, v40
    v_add_f32 v34, v34, v42
    v_fmac_f32 v35, v42, v42
    v_add_f32 v32, v32, v41
    v_fmac_f32 v33, v41, v41
    v_add_f32 v34, v34, v43
    s_add_u32 m0, s37, 50176
    s_nop 0
    buffer_load_dwordx4 v13, s[24:27], s36 offen lds
    v_fmac_f32 v35, v43, v43
    v_lshlrev_b32 v40, 16, v25
    v_and_b32 v41, s56, v25
    v_lshlrev_b32 v42, 16, v29
    v_and_b32 v43, s56, v29
    v_add_f32 v36, v36, v40
    v_fmac_f32 v37, v40, v40
    v_add_f32 v38, v38, v42
    v_fmac_f32 v39, v42, v42
    s_add_u32 m0, s37, 51200
    s_nop 0
    buffer_load_dwordx4 v14, s[24:27], s36 offen lds
    v_add_f32 v36, v36, v41
    v_fmac_f32 v37, v41, v41
    v_add_f32 v38, v38, v43
    v_fmac_f32 v39, v43, v43
    v_lshlrev_b32 v40, 16, v18
    v_and_b32 v41, s56, v18
    v_lshlrev_b32 v42, 16, v22
    v_and_b32 v43, s56, v22
    v_add_f32 v32, v32, v40
    s_add_u32 m0, s37, 52224
    s_nop 0
    buffer_load_dwordx4 v15, s[24:27], s36 offen lds
    s_add_u32 s36, s36, 245760
    s_cmp_eq_u32 s36, 2457600
    s_cselect_b32 s36, 0, s36
    v_fmac_f32 v33, v40, v40
    v_add_f32 v34, v34, v42
    v_fmac_f32 v35, v42, v42
    v_add_f32 v32, v32, v41
    v_fmac_f32 v33, v41, v41
    v_add_f32 v34, v34, v43
    v_fmac_f32 v35, v43, v43
    v_lshlrev_b32 v40, 16, v26
    v_and_b32 v41, s56, v26
    s_add_u32 m0, s37, 65536
    s_nop 0
    buffer_load_dwordx4 v44, s[48:51], s39 offen lds
    v_lshlrev_b32 v42, 16, v30
    v_and_b32 v43, s56, v30
    v_add_f32 v36, v36, v40
    v_fmac_f32 v37, v40, v40
    v_add_f32 v38, v38, v42
    v_fmac_f32 v39, v42, v42
    v_add_f32 v36, v36, v41
    v_fmac_f32 v37, v41, v41
    v_add_f32 v38, v38, v43
    s_add_u32 m0, s37, 66560
    s_nop 0
    buffer_load_dwordx4 v45, s[48:51], s39 offen lds
    v_fmac_f32 v39, v43, v43
    v_lshlrev_b32 v40, 16, v19
    v_and_b32 v41, s56, v19
    v_lshlrev_b32 v42, 16, v23
    v_and_b32 v43, s56, v23
    v_add_f32 v32, v32, v40
    v_fmac_f32 v33, v40, v40
    v_add_f32 v34, v34, v42
    v_fmac_f32 v35, v42, v42
    s_add_u32 m0, s37, 67584
    s_nop 0
    buffer_load_dwordx4 v46, s[48:51], s39 offen lds
    v_add_f32 v32, v32, v41
    v_fmac_f32 v33, v41, v41
    v_add_f32 v34, v34, v43
    v_fmac_f32 v35, v43, v43
    v_lshlrev_b32 v40, 16, v27
    v_and_b32 v41, s56, v27
    v_lshlrev_b32 v42, 16, v31
    v_and_b32 v43, s56, v31
    v_add_f32 v36, v36, v40
    s_add_u32 m0, s37, 68608
    s_nop 0
    buffer_load_dwordx4 v47, s[48:51], s39 offen lds
    s_add_u32 s39, s39, 221184
    s_cmp_eq_u32 s39, 2211840
    s_cselect_b32 s39, 0, s39
    v_fmac_f32 v37, v40, v40
    v_add_f32 v38, v38, v42
    v_fmac_f32 v39, v42, v42
    v_add_f32 v36, v36, v41
    v_fmac_f32 v37, v41, v41
    v_add_f32 v38, v38, v43
    v_fmac_f32 v39, v43, v43
    s_waitcnt vmcnt(16)
    s_barrier
    ds_read_b128 v[16:19], v51 offset:16384
    ds_read_b128 v[20:23], v51 offset:17408
    ds_read_b128 v[24:27], v51 offset:18432
    ds_read_b128 v[28:31], v51 offset:19456
    s_add_u32 s30, s35, 20480
    s_add_u32 m0, s37, 114688
    s_nop 0
    buffer_load_dwordx4 v10, s[20:23], s35 offen lds
    s_add_u32 m0, s37, 115712
    s_nop 0
    buffer_load_dwordx4 v11, s[20:23], s35 offen lds
    s_waitcnt lgkmcnt(0)
    v_lshlrev_b32 v40, 16, v16
    v_and_b32 v41, s56, v16
    v_lshlrev_b32 v42, 16, v20
    v_and_b32 v43, s56, v20
    v_add_f32 v32, v32, v40
    v_fmac_f32 v33, v40, v40
    v_add_f32 v34, v34, v42
    v_fmac_f32 v35, v42, v42
    v_add_f32 v32, v32, v41
    v_fmac_f32 v33, v41, v41
    v_add_f32 v34, v34, v43
    v_fmac_f32 v35, v43, v43
    v_lshlrev_b32 v40, 16, v24
    v_and_b32 v41, s56, v24
    v_lshlrev_b32 v42, 16, v28
    v_and_b32 v43, s56, v28
    v_add_f32 v36, v36, v40
    v_fmac_f32 v37, v40, v40
    v_add_f32 v38, v38, v42
    v_fmac_f32 v39, v42, v42
    v_add_f32 v36, v36, v41
    v_fmac_f32 v37, v41, v41
    v_add_f32 v38, v38, v43
    v_fmac_f32 v39, v43, v43
    v_lshlrev_b32 v40, 16, v17
    v_and_b32 v41, s56, v17
    v_lshlrev_b32 v42, 16, v21
    v_and_b32 v43, s56, v21
    v_add_f32 v32, v32, v40
    v_fmac_f32 v33, v40, v40
    v_add_f32 v34, v34, v42
    v_fmac_f32 v35, v42, v42
    s_add_u32 m0, s37, 116736
    s_nop 0
    buffer_load_dwordx4 v10, s[20:23], s30 offen lds
    v_add_f32 v32, v32, v41
    v_fmac_f32 v33, v41, v41
    v_add_f32 v34, v34, v43
    v_fmac_f32 v35, v43, v43
    v_lshlrev_b32 v40, 16, v25
    v_and_b32 v41, s56, v25
    v_lshlrev_b32 v42, 16, v29
    v_and_b32 v43, s56, v29
    v_add_f32 v36, v36, v40
    v_fmac_f32 v37, v40, v40
    v_add_f32 v38, v38, v42
    v_fmac_f32 v39, v42, v42
    v_add_f32 v36, v36, v41
    v_fmac_f32 v37, v41, v41
    v_add_f32 v38, v38, v43
    v_fmac_f32 v39, v43, v43
    v_lshlrev_b32 v40, 16, v18
    v_and_b32 v41, s56, v18
    v_lshlrev_b32 v42, 16, v22
    v_and_b32 v43, s56, v22
    v_add_f32 v32, v32, v40
    v_fmac_f32 v33, v40, v40
    v_add_f32 v34, v34, v42
    v_fmac_f32 v35, v42, v42
    v_add_f32 v32, v32, v41
    v_fmac_f32 v33, v41, v41
    v_add_f32 v34, v34, v43
    v_fmac_f32 v35, v43, v43
    v_lshlrev_b32 v40, 16, v26
    v_and_b32 v41, s56, v26
    v_lshlrev_b32 v42, 16, v30
    v_and_b32 v43, s56, v30
    v_add_f32 v36, v36, v40
    s_add_u32 m0, s37, 117760
    s_nop 0
    buffer_load_dwordx4 v11, s[20:23], s30 offen lds
    s_add_u32 s35, s35, 128
    s_cmp_eq_u32 s35, 1280
    s_cselect_b32 s35, 0, s35
    v_fmac_f32 v37, v40, v40
    v_add_f32 v38, v38, v42
    v_fmac_f32 v39, v42, v42
    v_add_f32 v36, v36, v41
    v_fmac_f32 v37, v41, v41
    v_add_f32 v38, v38, v43
    v_fmac_f32 v39, v43, v43
    v_lshlrev_b32 v40, 16, v19
    v_and_b32 v41, s56, v19
    v_lshlrev_b32 v42, 16, v23
    v_and_b32 v43, s56, v23
    v_add_f32 v32, v32, v40
    v_fmac_f32 v33, v40, v40
    v_add_f32 v34, v34, v42
    v_fmac_f32 v35, v42, v42
    v_add_f32 v32, v32, v41
    v_fmac_f32 v33, v41, v41
    v_add_f32 v34, v34, v43
    v_fmac_f32 v35, v43, v43
    v_lshlrev_b32 v40, 16, v27
    v_and_b32 v41, s56, v27
    v_lshlrev_b32 v42, 16, v31
    v_and_b32 v43, s56, v31
    v_add_f32 v36, v36, v40
    v_fmac_f32 v37, v40, v40
    v_add_f32 v38, v38, v42
    v_fmac_f32 v39, v42, v42
    v_add_f32 v36, v36, v41
    v_fmac_f32 v37, v41, v41
    v_add_f32 v38, v38, v43
    v_fmac_f32 v39, v43, v43
    s_waitcnt vmcnt(12)
    s_barrier
    ds_read_b128 v[16:19], v51 offset:32768
    ds_read_b128 v[20:23], v51 offset:33792
    ds_read_b128 v[24:27], v51 offset:34816
    ds_read_b128 v[28:31], v51 offset:35840
    s_add_u32 m0, s37, 16384
    s_nop 0
    buffer_load_dwordx4 v12, s[24:27], s36 offen lds
    s_add_u32 m0, s37, 17408
    s_nop 0
    buffer_load_dwordx4 v13, s[24:27], s36 offen lds
    s_waitcnt lgkmcnt(0)
    v_lshlrev_b32 v40, 16, v16
    v_and_b32 v41, s56, v16
    v_lshlrev_b32 v42, 16, v20
    v_and_b32 v43, s56, v20
    v_add_f32 v32, v32, v40
    v_fmac_f32 v33, v40, v40
    v_add_f32 v34, v34, v42
    v_fmac_f32 v35, v42, v42
    v_add_f32 v32, v32, v41
    v_fmac_f32 v33, v41, v41
    v_add_f32 v34, v34, v43
    v_fmac_f32 v35, v43, v43
    v_lshlrev_b32 v40, 16, v24
    v_and_b32 v41, s56, v24
    v_lshlrev_b32 v42, 16, v28
    v_and_b32 v43, s56, v28
    v_add_f32 v36, v36, v40
    v_fmac_f32 v37, v40, v40
    v_add_f32 v38, v38, v42
    v_fmac_f32 v39, v42, v42
    v_add_f32 v36, v36, v41
    v_fmac_f32 v37, v41, v41
    v_add_f32 v38, v38, v43
    v_fmac_f32 v39, v43, v43
    v_lshlrev_b32 v40, 16, v17
    v_and_b32 v41, s56, v17
    v_lshlrev_b32 v42, 16, v21
    v_and_b32 v43, s56, v21
    v_add_f32 v32, v32, v40
    v_fmac_f32 v33, v40, v40
    v_add_f32 v34, v34, v42
    v_fmac_f32 v35, v42, v42
    s_add_u32 m0, s37, 18432
    s_nop 0
    buffer_load_dwordx4 v14, s[24:27], s36 offen lds
    v_add_f32 v32, v32, v41
    v_fmac_f32 v33, v41, v41
    v_add_f32 v34, v34, v43
    v_fmac_f32 v35, v43, v43
    v_lshlrev_b32 v40, 16, v25
    v_and_b32 v41, s56, v25
    v_lshlrev_b32 v42, 16, v29
    v_and_b32 v43, s56, v29
    v_add_f32 v36, v36, v40
    v_fmac_f32 v37, v40, v40
    v_add_f32 v38, v38, v42
    v_fmac_f32 v39, v42, v42
    v_add_f32 v36, v36, v41
    v_fmac_f32 v37, v41, v41
    v_add_f32 v38, v38, v43
    v_fmac_f32 v39, v43, v43
    v_lshlrev_b32 v40, 16, v18
    v_and_b32 v41, s56, v18
    v_lshlrev_b32 v42, 16, v22
    v_and_b32 v43, s56, v22
    v_add_f32 v32, v32, v40
    v_fmac_f32 v33, v40, v40
    v_add_f32 v34, v34, v42
    v_fmac_f32 v35, v42, v42
    v_add_f32 v32, v32, v41
    v_fmac_f32 v33, v41, v41
    v_add_f32 v34, v34, v43
    v_fmac_f32 v35, v43, v43
    v_lshlrev_b32 v40, 16, v26
    v_and_b32 v41, s56, v26
    v_lshlrev_b32 v42, 16, v30
    v_and_b32 v43, s56, v30
    v_add_f32 v36, v36, v40
    s_add_u32 m0, s37, 19456
    s_nop 0
    buffer_load_dwordx4 v15, s[24:27], s36 offen lds
    s_add_u32 s36, s36, 245760
    s_cmp_eq_u32 s36, 2457600
    s_cselect_b32 s36, 0, s36
    v_fmac_f32 v37, v40, v40
    v_add_f32 v38, v38, v42
    v_fmac_f32 v39, v42, v42
    v_add_f32 v36, v36, v41
    v_fmac_f32 v37, v41, v41
    v_add_f32 v38, v38, v43
    v_fmac_f32 v39, v43, v43
    v_lshlrev_b32 v40, 16, v19
    v_and_b32 v41, s56, v19
    v_lshlrev_b32 v42, 16, v23
    v_and_b32 v43, s56, v23
    v_add_f32 v32, v32, v40
    v_fmac_f32 v33, v40, v40
    v_add_f32 v34, v34, v42
    v_fmac_f32 v35, v42, v42
    v_add_f32 v32, v32, v41
    v_fmac_f32 v33, v41, v41
    v_add_f32 v34, v34, v43
    v_fmac_f32 v35, v43, v43
    v_lshlrev_b32 v40, 16, v27
    v_and_b32 v41, s56, v27
    v_lshlrev_b32 v42, 16, v31
    v_and_b32 v43, s56, v31
    v_add_f32 v36, v36, v40
    v_fmac_f32 v37, v40, v40
    v_add_f32 v38, v38, v42
    v_fmac_f32 v39, v42, v42
    v_add_f32 v36, v36, v41
    v_fmac_f32 v37, v41, v41
    v_add_f32 v38, v38, v43
    v_fmac_f32 v39, v43, v43
    s_waitcnt vmcnt(4)
    s_barrier
    ds_read_b128 v[16:19], v51 offset:49152
    ds_read_b128 v[20:23], v51 offset:50176
    ds_read_b128 v[24:27], v51 offset:51200
    ds_read_b128 v[28:31], v51 offset:52224
    s_add_u32 m0, s37, 32768
    s_nop 0
    buffer_load_dwordx4 v44, s[48:51], s39 offen lds
    s_add_u32 m0, s37, 33792
    s_nop 0
    buffer_load_dwordx4 v45, s[48:51], s39 offen lds
    s_waitcnt lgkmcnt(0)
    v_lshlrev_b32 v40, 16, v16
    v_and_b32 v41, s56, v16
    v_lshlrev_b32 v42, 16, v20
    v_and_b32 v43, s56, v20
    v_add_f32 v32, v32, v40
    v_fmac_f32 v33, v40, v40
    v_add_f32 v34, v34, v42
    v_fmac_f32 v35, v42, v42
    v_add_f32 v32, v32, v41
    v_fmac_f32 v33, v41, v41
    v_add_f32 v34, v34, v43
    v_fmac_f32 v35, v43, v43
    v_lshlrev_b32 v40, 16, v24
    v_and_b32 v41, s56, v24
    v_lshlrev_b32 v42, 16, v28
    v_and_b32 v43, s56, v28
    v_add_f32 v36, v36, v40
    v_fmac_f32 v37, v40, v40
    v_add_f32 v38, v38, v42
    v_fmac_f32 v39, v42, v42
    v_add_f32 v36, v36, v41
    v_fmac_f32 v37, v41, v41
    v_add_f32 v38, v38, v43
    v_fmac_f32 v39, v43, v43
    v_lshlrev_b32 v40, 16, v17
    v_and_b32 v41, s56, v17
    v_lshlrev_b32 v42, 16, v21
    v_and_b32 v43, s56, v21
    v_add_f32 v32, v32, v40
    v_fmac_f32 v33, v40, v40
    v_add_f32 v34, v34, v42
    v_fmac_f32 v35, v42, v42
    s_add_u32 m0, s37, 34816
    s_nop 0
    buffer_load_dwordx4 v46, s[48:51], s39 offen lds
    v_add_f32 v32, v32, v41
    v_fmac_f32 v33, v41, v41
    v_add_f32 v34, v34, v43
    v_fmac_f32 v35, v43, v43
    v_lshlrev_b32 v40, 16, v25
    v_and_b32 v41, s56, v25
    v_lshlrev_b32 v42, 16, v29
    v_and_b32 v43, s56, v29
    v_add_f32 v36, v36, v40
    v_fmac_f32 v37, v40, v40
    v_add_f32 v38, v38, v42
    v_fmac_f32 v39, v42, v42
    v_add_f32 v36, v36, v41
    v_fmac_f32 v37, v41, v41
    v_add_f32 v38, v38, v43
    v_fmac_f32 v39, v43, v43
    v_lshlrev_b32 v40, 16, v18
    v_and_b32 v41, s56, v18
    v_lshlrev_b32 v42, 16, v22
    v_and_b32 v43, s56, v22
    v_add_f32 v32, v32, v40
    v_fmac_f32 v33, v40, v40
    v_add_f32 v34, v34, v42
    v_fmac_f32 v35, v42, v42
    v_add_f32 v32, v32, v41
    v_fmac_f32 v33, v41, v41
    v_add_f32 v34, v34, v43
    v_fmac_f32 v35, v43, v43
    v_lshlrev_b32 v40, 16, v26
    v_and_b32 v41, s56, v26
    v_lshlrev_b32 v42, 16, v30
    v_and_b32 v43, s56, v30
    v_add_f32 v36, v36, v40
    s_add_u32 m0, s37, 35840
    s_nop 0
    buffer_load_dwordx4 v47, s[48:51], s39 offen lds
    s_add_u32 s39, s39, 221184
    s_cmp_eq_u32 s39, 2211840
    s_cselect_b32 s39, 0, s39
    v_fmac_f32 v37, v40, v40
    v_add_f32 v38, v38, v42
    v_fmac_f32 v39, v42, v42
    v_add_f32 v36, v36, v41
    v_fmac_f32 v37, v41, v41
    v_add_f32 v38, v38, v43
    v_fmac_f32 v39, v43, v43
    v_lshlrev_b32 v40, 16, v19
    v_and_b32 v41, s56, v19
    v_lshlrev_b32 v42, 16, v23
    v_and_b32 v43, s56, v23
    v_add_f32 v32, v32, v40
    v_fmac_f32 v33, v40, v40
    v_add_f32 v34, v34, v42
    v_fmac_f32 v35, v42, v42
    v_add_f32 v32, v32, v41
    v_fmac_f32 v33, v41, v41
    v_add_f32 v34, v34, v43
    v_fmac_f32 v35, v43, v43
    v_lshlrev_b32 v40, 16, v27
    v_and_b32 v41, s56, v27
    v_lshlrev_b32 v42, 16, v31
    v_and_b32 v43, s56, v31
    v_add_f32 v36, v36, v40
    v_fmac_f32 v37, v40, v40
    v_add_f32 v38, v38, v42
    v_fmac_f32 v39, v42, v42
    v_add_f32 v36, v36, v41
    v_fmac_f32 v37, v41, v41
    v_add_f32 v38, v38, v43
    v_fmac_f32 v39, v43, v43
    s_waitcnt vmcnt(4)
    s_barrier
    s_add_u32 m0, s37, 49152
    s_nop 0
    buffer_load_dwordx4 v44, s[48:51], s39 offen lds
    s_add_u32 m0, s37, 50176
    s_nop 0
    buffer_load_dwordx4 v45, s[48:51], s39 offen lds
    v_add_f32_dpp v32, v32, v32 quad_perm:[1,0,3,2] row_mask:0xf bank_mask:0xf
    v_add_f32_dpp v33, v33, v33 quad_perm:[1,0,3,2] row_mask:0xf bank_mask:0xf
    v_add_f32_dpp v34, v34, v34 quad_perm:[1,0,3,2] row_mask:0xf bank_mask:0xf
    v_add_f32_dpp v35, v35, v35 quad_perm:[1,0,3,2] row_mask:0xf bank_mask:0xf
    v_add_f32_dpp v36, v36, v36 quad_perm:[1,0,3,2] row_mask:0xf bank_mask:0xf
    v_add_f32_dpp v37, v37, v37 quad_perm:[1,0,3,2] row_mask:0xf bank_mask:0xf
    v_add_f32_dpp v38, v38, v38 quad_perm:[1,0,3,2] row_mask:0xf bank_mask:0xf
    v_add_f32_dpp v39, v39, v39 quad_perm:[1,0,3,2] row_mask:0xf bank_mask:0xf
    v_add_f32_dpp v32, v32, v32 quad_perm:[2,3,0,1] row_mask:0xf bank_mask:0xf
    v_add_f32_dpp v33, v33, v33 quad_perm:[2,3,0,1] row_mask:0xf bank_mask:0xf
    v_add_f32_dpp v34, v34, v34 quad_perm:[2,3,0,1] row_mask:0xf bank_mask:0xf
    v_add_f32_dpp v35, v35, v35 quad_perm:[2,3,0,1] row_mask:0xf bank_mask:0xf
    v_add_f32_dpp v36, v36, v36 quad_perm:[2,3,0,1] row_mask:0xf bank_mask:0xf
    v_add_f32_dpp v37, v37, v37 quad_perm:[2,3,0,1] row_mask:0xf bank_mask:0xf
    v_add_f32_dpp v38, v38, v38 quad_perm:[2,3,0,1] row_mask:0xf bank_mask:0xf
    v_add_f32_dpp v39, v39, v39 quad_perm:[2,3,0,1] row_mask:0xf bank_mask:0xf
    v_add_f32_dpp v32, v32, v32 row_half_mirror row_mask:0xf bank_mask:0xf
    s_add_u32 m0, s37, 51200
    s_nop 0
    buffer_load_dwordx4 v46, s[48:51], s39 offen lds
    v_add_f32_dpp v33, v33, v33 row_half_mirror row_mask:0xf bank_mask:0xf
    v_add_f32_dpp v34, v34, v34 row_half_mirror row_mask:0xf bank_mask:0xf
    v_add_f32_dpp v35, v35, v35 row_half_mirror row_mask:0xf bank_mask:0xf
    v_add_f32_dpp v36, v36, v36 row_half_mirror row_mask:0xf bank_mask:0xf
    v_add_f32_dpp v37, v37, v37 row_half_mirror row_mask:0xf bank_mask:0xf
    v_add_f32_dpp v38, v38, v38 row_half_mirror row_mask:0xf bank_mask:0xf
    v_add_f32_dpp v39, v39, v39 row_half_mirror row_mask:0xf bank_mask:0xf
    v_cmp_eq_u32 vcc, 1, v53
    s_nop 1
    v_cndmask_b32 v32, v32, v34, vcc
    v_cndmask_b32 v33, v33, v35, vcc
    v_cmp_eq_u32 vcc, 2, v53
    s_nop 1
    v_cndmask_b32 v32, v32, v36, vcc
    v_cndmask_b32 v33, v33, v37, vcc
    v_cmp_eq_u32 vcc, 3, v53
    s_nop 1
    v_cndmask_b32 v32, v32, v38, vcc
    v_cndmask_b32 v33, v33, v39, vcc
    s_mov_b32 s31, 0x3acccccd
    s_add_u32 m0, s37, 52224
    s_nop 0
    buffer_load_dwordx4 v47, s[48:51], s39 offen lds
    s_add_u32 s39, s39, 221184
    s_cmp_eq_u32 s39, 2211840
    s_cselect_b32 s39, 0, s39
    s_mov_b32 s32, 0x3727c5ac
    v_mul_f32 v32, s31, v32
    v_mul_f32 v34, v32, v32
    v_fma_f32 v33, v33, s31, -v34
    v_max_f32 v33, 0, v33
    v_cvt_pk_bf16_f32 v33, 0, v33
    v_add_f32 v33, s32, v33
    v_cvt_pk_bf16_f32 v33, 0, v33
    v_sqrt_f32 v33, v33
    ds_write_b32 v54, v32 offset:1024
    s_nop 0
    v_cvt_pk_bf16_f32 v33, 0, v33
    v_rcp_f32 v33, v33
    s_nop 0
    ds_write_b32 v54, v33 offset:1536
    s_waitcnt lgkmcnt(0)
    s_barrier
    s_add_u32 m0, s37, 16384
    s_nop 0
    buffer_load_dwordx4 v44, s[48:51], s39 offen lds
    s_add_u32 m0, s37, 17408
    s_nop 0
    buffer_load_dwordx4 v45, s[48:51], s39 offen lds
    s_add_u32 m0, s37, 18432
    s_nop 0
    buffer_load_dwordx4 v46, s[48:51], s39 offen lds
    s_add_u32 m0, s37, 19456
    s_nop 0
    buffer_load_dwordx4 v47, s[48:51], s39 offen lds
    s_add_u32 s39, s39, 221184
    s_cmp_eq_u32 s39, 2211840
    s_cselect_b32 s39, 0, s39
    s_waitcnt vmcnt(8)
    v_mov_b32 v0, 11
    ds_write_b32 v7, v0 offset:160
    s_waitcnt vmcnt(4)
    v_mov_b32 v0, 12
    ds_write_b32 v7, v0 offset:160
    s_waitcnt vmcnt(0)
    v_mov_b32 v0, 13
    ds_write_b32 v7, v0 offset:160
L_f_pbw:
    ds_read_b32 v0, v1 offset:192
    s_waitcnt lgkmcnt(0)
    v_cmp_eq_u32 vcc, 0, v0
    s_cbranch_vccz L_f_pbx
    s_sleep 1
    s_branch L_f_pbw
L_f_pbx:
L_f_dw0:
    ds_read_b32 v0, v1 offset:176
    s_waitcnt lgkmcnt(0)
    v_cmp_gt_u32 vcc, 13, v0
    s_cbranch_vccz L_f_dx0
    s_sleep 1
    s_branch L_f_dw0
L_f_dx0:
    s_add_u32 m0, s37, 65536
    s_nop 0
    buffer_load_dwordx4 v44, s[48:51], s39 offen lds
    s_add_u32 m0, s37, 66560
    s_nop 0
    buffer_load_dwordx4 v45, s[48:51], s39 offen lds
    s_add_u32 m0, s37, 67584
    s_nop 0
    buffer_load_dwordx4 v46, s[48:51], s39 offen lds
    s_add_u32 m0, s37, 68608
    s_nop 0
    buffer_load_dwordx4 v47, s[48:51], s39 offen lds
    s_add_u32 s39, s39, 221184
    s_cmp_eq_u32 s39, 2211840
    s_cselect_b32 s39, 0, s39
    buffer_load_dwordx2 v[100:101], v98, s[52:55], s62 offen offset:0
    buffer_load_dwordx2 v[102:103], v98, s[52:55], s62 offen offset:1280
    buffer_load_dwordx2 v[104:105], v98, s[52:55], s62 offen offset:2560
    buffer_load_dwordx2 v[106:107], v98, s[52:55], s62 offen offset:3840
    buffer_load_dwordx2 v[108:109], v98, s[52:55], s63 offen offset:0
    buffer_load_dwordx2 v[110:111], v98, s[52:55], s63 offen offset:1280
    buffer_load_dwordx2 v[112:113], v98, s[52:55], s63 offen offset:2560
    buffer_load_dwordx2 v[114:115], v98, s[52:55], s63 offen offset:3840
    s_waitcnt vmcnt(8)
    v_mov_b32 v0, 14
    ds_write_b32 v7, v0 offset:160
    s_mov_b32 s30, 0x05040100
    s_mov_b32 s31, 0x07060302
    s_waitcnt vmcnt(0)
    v_perm_b32 v56, v102, v100, s30
    v_perm_b32 v57, v106, v104, s30
    v_perm_b32 v58, v110, v108, s30
    v_perm_b32 v59, v114, v112, s30
    v_perm_b32 v60, v102, v100, s31
    v_perm_b32 v61, v106, v104, s31
    v_perm_b32 v62, v110, v108, s31
    v_perm_b32 v63, v114, v112, s31
    v_perm_b32 v64, v103, v101, s30
    v_perm_b32 v65, v107, v105, s30
    v_perm_b32 v66, v111, v109, s30
    v_perm_b32 v67, v115, v113, s30
    v_perm_b32 v68, v103, v101, s31
    v_perm_b32 v69, v107, v105, s31
    v_perm_b32 v70, v111, v109, s31
    v_perm_b32 v71, v115, v113, s31
    ds_write_b128 v48, v[56:59] offset:0
    ds_write_b128 v48, v[60:63] offset:16
    ds_write_b128 v48, v[64:67] offset:32
    ds_write_b128 v48, v[68:71] offset:48
    ds_read_b128 v[88:91], v49 offset:0
    ds_read_b128 v[92:95], v49 offset:1024
    ds_read_b128 v[96:99], v49 offset:2048
    ds_read_b128 v[100:103], v49 offset:3072
    s_branch L_f_ffn
L_f_comp:
    s_load_dwordx4 s[64:67], s[0:1], 48
    s_getpc_b64 s[42:43]
L_f_pc:
    s_lshl_b32 s3, s41, 3
    s_and_b32 s62, s29, 7
    s_add_u32 s3, s3, s62
    s_lshl_b32 s3, s3, 6
    s_sub_u32 s42, s42, L_f_pc-fused_kernel
    s_subb_u32 s43, s43, 0
    s_min_u32 s62, s3, L_f_end-fused_kernel
    s_load_dword s63, s[42:43], s62
    s_add_u32 s3, s3, 16384
    s_min_u32 s62, s3, L_f_end-fused_kernel
    s_load_dword s63, s[42:43], s62
    s_add_u32 s3, s3, 16384
    s_min_u32 s62, s3, L_f_end-fused_kernel
    s_load_dword s63, s[42:43], s62
    s_add_u32 s3, s3, 16384
    s_min_u32 s62, s3, L_f_end-fused_kernel
    s_load_dword s63, s[42:43], s62
    s_and_b32 s14, s40, 1
    s_lshl_b32 s14, s14, 3
    s_and_b32 s15, s41, 7
    s_add_u32 s14, s14, s15
    s_lshr_b32 s15, s40, 1
    s_lshl_b32 s15, s15, 2
    s_lshr_b32 s16, s41, 3
    s_add_u32 s15, s15, s16
    s_lshl_b32 s17, s15, 2
    s_mov_b32 s18, 0x32221000
    s_mov_b32 s19, 0x55554444
    s_lshr_b64 s[18:19], s[18:19], s17
    s_and_b32 s18, s18, 15
    s_lshl_b32 s17, s15, 1
    s_sub_u32 s19, s17, s18
    s_mov_b32 s18, 2252
    s_bitcmp1_b32 s18, s15
    s_cselect_b32 s18, 1, 2
    s_mov_b32 s46, 28311552
    s_mov_b32 s47, 0x20000
    v_lshrrev_b32 v3, 5, v2
    v_and_b32 v4, 31, v2
    s_and_b32 s52, s29, 1
    s_lshr_b32 s53, s29, 1
    s_lshl_b32 s30, s52, 1
    s_xor_b32 s30, s30, s53
    s_mov_b32 s56, 0x3f803f80
    s_lshl_b32 s31, s30, 1
    v_bfe_u32 v5, v2, 1, 3
    v_xor_b32 v5, v5, v3
    v_xor_b32 v5, s31, v5
    s_lshl_b32 s31, s52, 13
    s_add_u32 s31, s31, 81920
    v_lshlrev_b32 v6, 7, v4
    v_add_u32 v6, s31, v6
    v_xor_b32 v7, 0, v5
    v_lshl_add_u32 v16, v7, 4, v6
    v_xor_b32 v7, 2, v5
    v_lshl_add_u32 v17, v7, 4, v6
    v_xor_b32 v7, 4, v5
    v_lshl_add_u32 v18, v7, 4, v6
    v_xor_b32 v7, 6, v5
    v_lshl_add_u32 v19, v7, 4, v6
    v_bfe_u32 v5, v2, 2, 2
    v_lshl_add_u32 v6, v3, 3, v5
    v_lshlrev_b32 v6, 8, v6
    v_bfe_u32 v7, v2, 1, 1
    v_lshl_add_u32 v6, v7, 3, v6
    v_add_u32 v6, 16384, v6
    v_bfe_u32 v7, v2, 4, 1
    v_and_b32 v8, 1, v2
    v_lshl_add_u32 v7, v7, 1, v8
    s_and_b32 s55, s53, 1
    s_lshl_b32 s31, s55, 3
    v_add_u32 v7, s31, v7
    v_lshlrev_b32 v5, 2, v5
    v_xor_b32 v7, v7, v5
    v_lshl_add_u32 v6, v7, 4, v6
    v_xor_b32 v7, 64, v6
    s_xor_b32 s31, s30, 0
    s_lshl_b32 s31, s31, 12
    v_add_u32 v20, s31, v6
    v_add_u32 v21, s31, v7
    s_xor_b32 s31, s30, 1
    s_lshl_b32 s31, s31, 12
    v_add_u32 v22, s31, v6
    v_add_u32 v23, s31, v7
    s_xor_b32 s31, s30, 2
    s_lshl_b32 s31, s31, 12
    v_add_u32 v24, s31, v6
    v_add_u32 v25, s31, v7
    s_xor_b32 s31, s30, 3
    s_lshl_b32 s31, s31, 12
    v_add_u32 v26, s31, v6
    v_add_u32 v27, s31, v7
    v_and_b32 v5, 15, v2
    v_bfe_u32 v6, v2, 4, 1
    v_cmp_eq_u32 vcc, v5, v6
    v_mov_b32 v5, s56
    s_nop 0
    v_cndmask_b32 v88, 0, v5, vcc
    v_cndmask_b32 v89, 0, v5, vcc
    v_cndmask_b32 v90, 0, v5, vcc
    v_cndmask_b32 v91, 0, v5, vcc
    s_lshl_b32 s31, s52, 8
    v_lshl_add_u32 v48, v3, 4, s31
    s_add_u32 s31, s31, 1024
    v_lshl_add_u32 v9, v4, 2, s31
    v_add_u32 v12, 512, v9
    s_movk_i32 s32, 2048
    s_cmp_ge_u32 s29, 4
    s_cselect_b32 s32, 24576, s32
    s_lshl_b32 s33, s29, 11
    s_add_u32 s33, s33, s32
    v_lshl_add_u32 v7, v2, 4, s33
    s_lshl_b32 s33, s53, 12
    s_add_u32 s33, s33, s32
    v_lshl_add_u32 v8, v3, 11, s33
    v_bfe_u32 v5, v2, 4, 1
    v_lshl_add_u32 v8, v5, 4, v8
    v_bfe_u32 v5, v2, 2, 2
    v_lshl_add_u32 v8, v5, 8, v8
    v_and_b32 v5, 3, v2
    v_lshl_add_u32 v8, v5, 2, v8
    v_lshlrev_b32 v5, 4, v2
    s_lshl_b32 s31, s15, 3
    s_add_u32 s31, s31, s29
    s_cmp_eq_u32 s31, 120
    s_cselect_b32 s42, 1, 0
    s_mul_i32 s62, s14, 17920
    s_add_u32 s62, s62, 27328512
    s_mov_b32 s43, s18
    s_mov_b32 s69, s19
    s_lshl_b32 s39, s14, 2
    s_lshl_b32 s31, s52, 1
    s_add_u32 s39, s39, s31
    s_lshr_b32 s30, s39, 1
    s_mov_b32 s34, 0
    s_mov_b32 s35, 0x20000
    s_mov_b32 s8, 1.0
    s_cmp_ge_u32 s29, 4
    s_cbranch_scc1 L_f_ch
    s_add_u32 s54, s17, s55
    s_cmp_lt_u32 s54, 10
    s_cselect_b32 s8, 0x3ea52b5c, s8
    s_cselect_b32 s31, 0, 10
    s_cselect_b32 s10, 0, 4
    s_cmp_ge_u32 s54, 20
    s_cselect_b32 s31, 20, s31
    s_cselect_b32 s10, 8, s10
    s_cselect_b32 s9, 1, 0
    s_sub_u32 s31, s54, s31
    s_lshl_b32 s6, s31, 12
    s_add_u32 s10, s10, s6
    s_lshl_b32 s30, s30, 7
    s_add_u32 s10, s10, s30
    s_add_u32 s10, s10, 27394048
    s_mul_i32 s4, s39, 123520
    s_lshl_b32 s5, s54, 12
    s_lshl_b32 s6, s31, 10
    s_add_u32 s6, s6, 81920
    s_cmp_eq_u32 s9, 1
    s_cselect_b32 s5, s6, s5
    s_add_u32 s4, s4, s5
    s_add_u32 s4, s4, 0
    s_cmp_eq_u32 s9, 1
    s_mov_b32 s5, 123520
    s_cselect_b32 s5, 20736, s5
    s_add_u32 s5, s5, s4
    s_add_u32 s6, s4, 123520
    s_add_u32 s7, s5, 123520
    s_cmp_ge_u32 s54, 30
    s_cselect_b32 s9, 3, s9
    s_branch L_f_cj
L_f_ch:
    s_add_u32 s54, s19, s55
    s_mul_i32 s10, s30, 27
    s_add_u32 s10, s10, s54
    s_lshl_b32 s10, s10, 7
    s_lshl_b32 s31, s54, 2
    s_add_u32 s10, s10, 27435008
    s_mul_i32 s4, s39, 108
    s_add_u32 s4, s4, s31
    s_lshl_b32 s4, s4, 10
    s_add_u32 s4, s4, 10485760
    s_add_u32 s5, s4, 110592
    s_mov_b32 s6, 0
    s_mov_b32 s7, 0
    s_cmp_lt_u32 s55, s18
    s_cselect_b32 s9, 2, 3
    s_cselect_b32 s34, 28311552, 0
L_f_cj:
    s_lshl_b32 s14, s40, 2
    s_lshr_b32 s15, s41, 3
    s_add_u32 s14, s14, s15
    s_mul_i32 s16, s14, 5
    s_add_u32 s16, s16, 1
    s_lshr_b32 s16, s16, 1
    s_lshl_b32 s16, s16, 9
    s_add_u32 s16, s16, 0
    s_movk_i32 s17, 1024
    s_bitcmp1_b32 s14, 0
    s_cselect_b32 s17, -504, s17
    s_and_b32 s19, s41, 7
    s_lshl_b32 s15, s19, 3
    s_mul_i32 s19, s19, 0
    s_lshr_b32 s11, s15, 1
    s_add_u32 s15, s15, s29
    s_mul_i32 s20, s15, 123520
    s_add_u32 s20, s20, s16
    s_add_u32 s18, s20, s17
    s_add_u32 s21, s16, s19
    s_add_u32 s21, s21, 40960
    s_mul_i32 s60, s15, 40960
    s_mul_i32 s61, s14, 1280
    s_add_u32 s60, s60, s61
    s_add_u32 s60, s60, 20971520
    s_sub_u32 s3, s60, 3072
    s_lshl_b32 s61, s15, 10
    s_lshr_b32 s27, s14, 2
    s_lshl_b32 s27, s27, 7
    s_add_u32 s61, s61, s27
    s_and_b32 s27, s14, 3
    s_lshl_b32 s27, s27, 2
    s_add_u32 s61, s61, s27
    s_add_u32 s61, s61, 27328512
    s_lshr_b32 s50, s40, 1
    s_lshl_b32 s50, s50, 3
    s_and_b32 s51, s41, 7
    s_add_u32 s50, s50, s51
    s_lshl_b32 s50, s50, 1
    s_bfe_u32 s51, s41, 0x10003
    s_lshr_b32 s52, s29, 2
    s_xor_b32 s53, s51, s52
    s_add_u32 s50, s50, s53
    s_mul_i32 s54, s52, 2
    s_xor_b32 s54, s54, s29
    s_and_b32 s54, s54, 3
    s_lshl_b32 s56, s53, 2
    s_add_u32 s56, s56, s54
    s_lshl_b32 s56, s56, 3
    s_and_b32 s55, s40, 1
    s_lshl_b32 s55, s55, 1
    s_lshr_b32 s58, s41, 4
    s_add_u32 s55, s55, s58
    s_mul_i32 s55, s55, 320
    s_lshl_b32 s58, s51, 8
    s_add_u32 s55, s55, s58
    s_lshl_b32 s58, s54, 4
    s_add_u32 s55, s55, s58
    s_mul_i32 s57, s50, 40960
    s_add_u32 s55, s55, s57
    s_mul_i32 s59, s54, 10240
    s_add_u32 s57, s57, s59
    s_add_u32 s57, s57, 20971520
    s_mul_i32 s58, s54, 30720
    s_add_u32 s58, s58, 1024
    s_mul_i32 s59, s54, 5120
    s_add_u32 s59, s59, 143360
    s_lshl_b32 s53, s51, 7
    s_sub_u32 s53, 64, s53
    s_mov_b32 s50, 2621440
    s_mov_b32 s51, 0x20000
    s_waitcnt lgkmcnt(0)
    s_mov_b32 s44, s12
    s_mov_b32 s32, s12
    s_mov_b32 s33, s13
    s_mov_b32 s45, s13
    s_mov_b32 s48, s64
    s_mov_b32 s49, s65
    s_mov_b32 s64, s66
    s_mov_b32 s65, s67
    s_mov_b32 s67, 0x20000
    s_mov_b32 s66, 256
    v_mov_b32 v49, 1
    s_cmp_eq_u32 s42, 0
    s_cbranch_scc1 L_f_nclr
    s_mov_b32 s31, s62
    v_mov_b32 v92, 0
    v_mov_b32 v93, 0
    v_mov_b32 v94, 0
    v_mov_b32 v95, 0
    buffer_store_dwordx4 v[92:95], v5, s[44:47], s31 offen offset:0 sc1
    buffer_store_dwordx4 v[92:95], v5, s[44:47], s31 offen offset:1024 sc1
    buffer_store_dwordx4 v[92:95], v5, s[44:47], s31 offen offset:2048 sc1
    buffer_store_dwordx4 v[92:95], v5, s[44:47], s31 offen offset:3072 sc1
    s_add_u32 s31, s31, 4096
    buffer_store_dwordx4 v[92:95], v5, s[44:47], s31 offen offset:0 sc1
    buffer_store_dwordx4 v[92:95], v5, s[44:47], s31 offen offset:1024 sc1
    buffer_store_dwordx4 v[92:95], v5, s[44:47], s31 offen offset:2048 sc1
    buffer_store_dwordx4 v[92:95], v5, s[44:47], s31 offen offset:3072 sc1
    s_add_u32 s31, s31, 4096
    buffer_store_dwordx4 v[92:95], v5, s[44:47], s31 offen offset:0 sc1
    buffer_store_dwordx4 v[92:95], v5, s[44:47], s31 offen offset:1024 sc1
    buffer_store_dwordx4 v[92:95], v5, s[44:47], s31 offen offset:2048 sc1
    buffer_store_dwordx4 v[92:95], v5, s[44:47], s31 offen offset:3072 sc1
    s_add_u32 s31, s31, 4096
    buffer_store_dwordx4 v[92:95], v5, s[44:47], s31 offen offset:0 sc1
    buffer_store_dwordx4 v[92:95], v5, s[44:47], s31 offen offset:1024 sc1
    buffer_store_dwordx4 v[92:95], v5, s[44:47], s31 offen offset:2048 sc1
    buffer_store_dwordx4 v[92:95], v5, s[44:47], s31 offen offset:3072 sc1
    s_add_u32 s31, s31, 4096
    buffer_store_dwordx4 v[92:95], v5, s[44:47], s31 offen offset:0 sc1
    s_mov_b32 exec_hi, 0
    buffer_store_dwordx4 v[92:95], v5, s[44:47], s31 offen offset:1024 sc1
    s_mov_b64 exec, -1
L_f_nclr:
    v_cmp_gt_u32 s[22:23], 20, v4
    v_cmp_gt_u32 s[24:25], 32, v2
    s_cmp_ge_u32 s29, 4
    s_cbranch_scc1 L_f_hp
    s_setprio 1
    s_mul_i32 s30, s14, 20
    s_add_u32 s31, s30, 19
    s_lshr_b32 s30, s30, 6
    s_lshr_b32 s31, s31, 6
    s_sub_u32 s31, s31, s30
    s_lshl_b32 s30, s30, 12
    s_add_u32 s30, s30, 27394048
    s_lshl_b32 s31, s31, 12
    v_mul_u32_u24 v50, s31, v3
    v_lshl_add_u32 v50, v4, 7, v50
    v_add_u32 v50, s30, v50
    s_cmp_eq_u32 s9, 1
    s_cbranch_scc1 L_f_vloop
    s_barrier
    ds_read_b128 v[72:75], v16 offset:0
    ds_read_b64_tr_b16 v[80:81], v20 offset:0
    ds_read_b64_tr_b16 v[82:83], v20 offset:1024
    ds_read_b128 v[76:79], v16 offset:4096
    ds_read_b64_tr_b16 v[84:85], v21 offset:0
    ds_read_b64_tr_b16 v[86:87], v21 offset:1024
    ds_read_b128 v[56:59], v17 offset:0
    ds_read_b64_tr_b16 v[64:65], v22 offset:0
    ds_read_b64_tr_b16 v[66:67], v22 offset:1024
    ds_read_b128 v[60:63], v17 offset:4096
    ds_read_b64_tr_b16 v[68:69], v23 offset:0
    ds_read_b64_tr_b16 v[70:71], v23 offset:1024
    s_waitcnt lgkmcnt(9)
    v_mfma_f32_32x32x16_bf16 v[96:111], v[80:83], v[72:75], 0
    ds_read_b128 v[28:31], v18 offset:0
    ds_read_b64_tr_b16 v[36:37], v24 offset:0
    s_waitcnt lgkmcnt(10)
    v_mfma_f32_32x32x16_bf16 v[112:127], v[80:83], v[76:79], 0
    ds_read_b64_tr_b16 v[38:39], v24 offset:1024
    ds_read_b128 v[32:35], v18 offset:4096
    v_mfma_f32_16x16x32_bf16 v[40:43], v[80:83], v[88:91], 0
    s_waitcnt lgkmcnt(10)
    v_mfma_f32_32x32x16_bf16 v[144:159], v[84:87], v[76:79], 0
    ds_read_b64_tr_b16 v[164:165], v25 offset:0
    ds_read_b64_tr_b16 v[166:167], v25 offset:1024
    v_mfma_f32_32x32x16_bf16 v[128:143], v[84:87], v[72:75], 0
    v_mfma_f32_16x16x32_bf16 v[44:47], v[84:87], v[88:91], 0
    s_waitcnt lgkmcnt(9)
    v_mfma_f32_32x32x16_bf16 v[96:111], v[64:67], v[56:59], v[96:111]
    ds_read_b128 v[72:75], v19 offset:0
    ds_read_b64_tr_b16 v[80:81], v26 offset:0
    s_waitcnt lgkmcnt(10)
    v_mfma_f32_32x32x16_bf16 v[112:127], v[64:67], v[60:63], v[112:127]
    ds_read_b64_tr_b16 v[82:83], v26 offset:1024
    ds_read_b128 v[76:79], v19 offset:4096
    v_mfma_f32_16x16x32_bf16 v[40:43], v[64:67], v[88:91], v[40:43]
    s_waitcnt lgkmcnt(10)
    v_mfma_f32_32x32x16_bf16 v[144:159], v[68:71], v[60:63], v[144:159]
    ds_read_b64_tr_b16 v[84:85], v27 offset:0
    ds_read_b64_tr_b16 v[86:87], v27 offset:1024
    v_mfma_f32_32x32x16_bf16 v[128:143], v[68:71], v[56:59], v[128:143]
    v_mfma_f32_16x16x32_bf16 v[44:47], v[68:71], v[88:91], v[44:47]
    s_waitcnt lgkmcnt(9)
    v_mfma_f32_32x32x16_bf16 v[96:111], v[36:39], v[28:31], v[96:111]
    s_waitcnt lgkmcnt(0)
    s_barrier
    ds_read_b128 v[56:59], v16 offset:16384
    ds_read_b64_tr_b16 v[64:65], v20 offset:32768
    v_mfma_f32_32x32x16_bf16 v[112:127], v[36:39], v[32:35], v[112:127]
    ds_read_b64_tr_b16 v[66:67], v20 offset:33792
    ds_read_b128 v[60:63], v16 offset:20480
    v_mfma_f32_32x32x16_bf16 v[144:159], v[164:167], v[32:35], v[144:159]
    ds_read_b64_tr_b16 v[68:69], v21 offset:32768
    ds_read_b64_tr_b16 v[70:71], v21 offset:33792
    v_mfma_f32_32x32x16_bf16 v[128:143], v[164:167], v[28:31], v[128:143]
    v_mfma_f32_32x32x16_bf16 v[96:111], v[80:83], v[72:75], v[96:111]
    ds_read_b128 v[28:31], v17 offset:16384
    ds_read_b64_tr_b16 v[36:37], v22 offset:32768
    v_mfma_f32_32x32x16_bf16 v[112:127], v[80:83], v[76:79], v[112:127]
    ds_read_b64_tr_b16 v[38:39], v22 offset:33792
    ds_read_b128 v[32:35], v17 offset:20480
    v_mfma_f32_32x32x16_bf16 v[144:159], v[84:87], v[76:79], v[144:159]
    ds_read_b64_tr_b16 v[164:165], v23 offset:32768
    ds_read_b64_tr_b16 v[166:167], v23 offset:33792
    v_mfma_f32_32x32x16_bf16 v[128:143], v[84:87], v[72:75], v[128:143]
    s_waitcnt lgkmcnt(9)
    v_mfma_f32_32x32x16_bf16 v[96:111], v[64:67], v[56:59], v[96:111]
    ds_read_b128 v[72:75], v18 offset:16384
    ds_read_b64_tr_b16 v[80:81], v24 offset:32768
    s_waitcnt lgkmcnt(10)
    v_mfma_f32_32x32x16_bf16 v[112:127], v[64:67], v[60:63], v[112:127]
    ds_read_b64_tr_b16 v[82:83], v24 offset:33792
    ds_read_b128 v[76:79], v18 offset:20480
    v_mfma_f32_16x16x32_bf16 v[40:43], v[64:67], v[88:91], v[40:43]
    s_waitcnt lgkmcnt(10)
    v_mfma_f32_32x32x16_bf16 v[144:159], v[68:71], v[60:63], v[144:159]
    ds_read_b64_tr_b16 v[84:85], v25 offset:32768
    ds_read_b64_tr_b16 v[86:87], v25 offset:33792
    v_mfma_f32_32x32x16_bf16 v[128:143], v[68:71], v[56:59], v[128:143]
    v_mfma_f32_16x16x32_bf16 v[44:47], v[68:71], v[88:91], v[44:47]
    s_waitcnt lgkmcnt(9)
    v_mfma_f32_32x32x16_bf16 v[96:111], v[36:39], v[28:31], v[96:111]
    ds_read_b128 v[56:59], v19 offset:16384
    ds_read_b64_tr_b16 v[64:65], v26 offset:32768
    s_waitcnt lgkmcnt(10)
    v_mfma_f32_32x32x16_bf16 v[112:127], v[36:39], v[32:35], v[112:127]
    ds_read_b64_tr_b16 v[66:67], v26 offset:33792
    ds_read_b128 v[60:63], v19 offset:20480
    v_mfma_f32_16x16x32_bf16 v[40:43], v[36:39], v[88:91], v[40:43]
    s_waitcnt lgkmcnt(10)
    v_mfma_f32_32x32x16_bf16 v[144:159], v[164:167], v[32:35], v[144:159]
    ds_read_b64_tr_b16 v[68:69], v27 offset:32768
    ds_read_b64_tr_b16 v[70:71], v27 offset:33792
    v_mfma_f32_32x32x16_bf16 v[128:143], v[164:167], v[28:31], v[128:143]
    v_mfma_f32_16x16x32_bf16 v[44:47], v[164:167], v[88:91], v[44:47]
    s_waitcnt lgkmcnt(9)
    v_mfma_f32_32x32x16_bf16 v[96:111], v[80:83], v[72:75], v[96:111]
    s_waitcnt lgkmcnt(0)
    s_barrier
    ds_read_b128 v[28:31], v16 offset:32768
    v_add_u32 v20, 65536, v20
    ds_read_b64_tr_b16 v[36:37], v20 offset:49152
    v_mfma_f32_32x32x16_bf16 v[112:127], v[80:83], v[76:79], v[112:127]
    ds_read_b64_tr_b16 v[38:39], v20 offset:50176
    ds_read_b128 v[32:35], v16 offset:36864
    v_mfma_f32_32x32x16_bf16 v[144:159], v[84:87], v[76:79], v[144:159]
    v_add_u32 v21, 65536, v21
    ds_read_b64_tr_b16 v[164:165], v21 offset:49152
    ds_read_b64_tr_b16 v[166:167], v21 offset:50176
    v_mfma_f32_32x32x16_bf16 v[128:143], v[84:87], v[72:75], v[128:143]
    v_mfma_f32_32x32x16_bf16 v[96:111], v[64:67], v[56:59], v[96:111]
    ds_read_b128 v[72:75], v17 offset:32768
    v_add_u32 v22, 65536, v22
    ds_read_b64_tr_b16 v[80:81], v22 offset:49152
    v_mfma_f32_32x32x16_bf16 v[112:127], v[64:67], v[60:63], v[112:127]
    ds_read_b64_tr_b16 v[82:83], v22 offset:50176
    ds_read_b128 v[76:79], v17 offset:36864
    v_mfma_f32_32x32x16_bf16 v[144:159], v[68:71], v[60:63], v[144:159]
    v_add_u32 v23, 65536, v23
    ds_read_b64_tr_b16 v[84:85], v23 offset:49152
    ds_read_b64_tr_b16 v[86:87], v23 offset:50176
    v_mfma_f32_32x32x16_bf16 v[128:143], v[68:71], v[56:59], v[128:143]
    s_waitcnt lgkmcnt(9)
    v_mfma_f32_32x32x16_bf16 v[96:111], v[36:39], v[28:31], v[96:111]
    ds_read_b128 v[56:59], v18 offset:32768
    v_add_u32 v24, 65536, v24
    ds_read_b64_tr_b16 v[64:65], v24 offset:49152
    s_cmp_eq_u32 s42, 0
    s_cbranch_scc1 L_f_na
    s_waitcnt vmcnt(0)
    s_mov_b64 exec, 1
    buffer_atomic_add v49, off, s[64:67], 0 offset:192
    s_mov_b64 exec, -1
L_f_na:
    s_waitcnt lgkmcnt(10)
    v_mfma_f32_32x32x16_bf16 v[112:127], v[36:39], v[32:35], v[112:127]
    ds_read_b64_tr_b16 v[66:67], v24 offset:50176
    ds_read_b128 v[60:63], v18 offset:36864
    v_mfma_f32_16x16x32_bf16 v[40:43], v[36:39], v[88:91], v[40:43]
    s_waitcnt lgkmcnt(10)
    v_mfma_f32_32x32x16_bf16 v[144:159], v[164:167], v[32:35], v[144:159]
    v_add_u32 v25, 65536, v25
    ds_read_b64_tr_b16 v[68:69], v25 offset:49152
    ds_read_b64_tr_b16 v[70:71], v25 offset:50176
    v_mfma_f32_32x32x16_bf16 v[128:143], v[164:167], v[28:31], v[128:143]
    v_mfma_f32_16x16x32_bf16 v[44:47], v[164:167], v[88:91], v[44:47]
    s_waitcnt lgkmcnt(9)
    v_mfma_f32_32x32x16_bf16 v[96:111], v[80:83], v[72:75], v[96:111]
    ds_read_b128 v[28:31], v19 offset:32768
    v_add_u32 v26, 65536, v26
    ds_read_b64_tr_b16 v[36:37], v26 offset:49152
    s_waitcnt lgkmcnt(10)
    v_mfma_f32_32x32x16_bf16 v[112:127], v[80:83], v[76:79], v[112:127]
    ds_read_b64_tr_b16 v[38:39], v26 offset:50176
    ds_read_b128 v[32:35], v19 offset:36864
    v_mfma_f32_16x16x32_bf16 v[40:43], v[80:83], v[88:91], v[40:43]
    s_waitcnt lgkmcnt(10)
    v_mfma_f32_32x32x16_bf16 v[144:159], v[84:87], v[76:79], v[144:159]
    v_add_u32 v27, 65536, v27
    ds_read_b64_tr_b16 v[164:165], v27 offset:49152
    ds_read_b64_tr_b16 v[166:167], v27 offset:50176
    v_mfma_f32_32x32x16_bf16 v[128:143], v[84:87], v[72:75], v[128:143]
    v_mfma_f32_16x16x32_bf16 v[44:47], v[84:87], v[88:91], v[44:47]
    s_waitcnt lgkmcnt(9)
    v_mfma_f32_32x32x16_bf16 v[96:111], v[64:67], v[56:59], v[96:111]
    s_waitcnt lgkmcnt(0)
    s_barrier
    ds_read_b128 v[72:75], v16 offset:0
    v_add_u32 v20, 4294901760, v20
    ds_read_b64_tr_b16 v[80:81], v20 offset:0
    v_mfma_f32_32x32x16_bf16 v[112:127], v[64:67], v[60:63], v[112:127]
    ds_read_b64_tr_b16 v[82:83], v20 offset:1024
    ds_read_b128 v[76:79], v16 offset:4096
    v_mfma_f32_32x32x16_bf16 v[144:159], v[68:71], v[60:63], v[144:159]
    v_add_u32 v21, 4294901760, v21
    ds_read_b64_tr_b16 v[84:85], v21 offset:0
    ds_read_b64_tr_b16 v[86:87], v21 offset:1024
    v_mfma_f32_32x32x16_bf16 v[128:143], v[68:71], v[56:59], v[128:143]
    v_mfma_f32_32x32x16_bf16 v[96:111], v[36:39], v[28:31], v[96:111]
    ds_read_b128 v[56:59], v17 offset:0
    v_add_u32 v22, 4294901760, v22
    ds_read_b64_tr_b16 v[64:65], v22 offset:0
    v_mfma_f32_32x32x16_bf16 v[112:127], v[36:39], v[32:35], v[112:127]
    ds_read_b64_tr_b16 v[66:67], v22 offset:1024
    ds_read_b128 v[60:63], v17 offset:4096
    v_mfma_f32_32x32x16_bf16 v[144:159], v[164:167], v[32:35], v[144:159]
    v_add_u32 v23, 4294901760, v23
    ds_read_b64_tr_b16 v[68:69], v23 offset:0
    ds_read_b64_tr_b16 v[70:71], v23 offset:1024
    v_mfma_f32_32x32x16_bf16 v[128:143], v[164:167], v[28:31], v[128:143]
    s_waitcnt lgkmcnt(9)
    v_mfma_f32_32x32x16_bf16 v[96:111], v[80:83], v[72:75], v[96:111]
    ds_read_b128 v[28:31], v18 offset:0
    v_add_u32 v24, 4294901760, v24
    ds_read_b64_tr_b16 v[36:37], v24 offset:0
    s_waitcnt lgkmcnt(10)
    v_mfma_f32_32x32x16_bf16 v[112:127], v[80:83], v[76:79], v[112:127]
    ds_read_b64_tr_b16 v[38:39], v24 offset:1024
    ds_read_b128 v[32:35], v18 offset:4096
    v_mfma_f32_16x16x32_bf16 v[40:43], v[80:83], v[88:91], v[40:43]
    s_waitcnt lgkmcnt(10)
    v_mfma_f32_32x32x16_bf16 v[144:159], v[84:87], v[76:79], v[144:159]
    v_add_u32 v25, 4294901760, v25
    ds_read_b64_tr_b16 v[164:165], v25 offset:0
    ds_read_b64_tr_b16 v[166:167], v25 offset:1024
    v_mfma_f32_32x32x16_bf16 v[128:143], v[84:87], v[72:75], v[128:143]
    v_mfma_f32_16x16x32_bf16 v[44:47], v[84:87], v[88:91], v[44:47]
    s_waitcnt lgkmcnt(9)
    v_mfma_f32_32x32x16_bf16 v[96:111], v[64:67], v[56:59], v[96:111]
    ds_read_b128 v[72:75], v19 offset:0
    v_add_u32 v26, 4294901760, v26
    ds_read_b64_tr_b16 v[80:81], v26 offset:0
    s_waitcnt lgkmcnt(10)
    v_mfma_f32_32x32x16_bf16 v[112:127], v[64:67], v[60:63], v[112:127]
    ds_read_b64_tr_b16 v[82:83], v26 offset:1024
    ds_read_b128 v[76:79], v19 offset:4096
    v_mfma_f32_16x16x32_bf16 v[40:43], v[64:67], v[88:91], v[40:43]
    s_waitcnt lgkmcnt(10)
    v_mfma_f32_32x32x16_bf16 v[144:159], v[68:71], v[60:63], v[144:159]
    v_add_u32 v27, 4294901760, v27
    ds_read_b64_tr_b16 v[84:85], v27 offset:0
    ds_read_b64_tr_b16 v[86:87], v27 offset:1024
    v_mfma_f32_32x32x16_bf16 v[128:143], v[68:71], v[56:59], v[128:143]
    v_mfma_f32_16x16x32_bf16 v[44:47], v[68:71], v[88:91], v[44:47]
    s_waitcnt lgkmcnt(9)
    v_mfma_f32_32x32x16_bf16 v[96:111], v[36:39], v[28:31], v[96:111]
    s_waitcnt lgkmcnt(0)
    s_barrier
    ds_read_b128 v[56:59], v16 offset:16384
    ds_read_b64_tr_b16 v[64:65], v20 offset:32768
    v_mfma_f32_32x32x16_bf16 v[112:127], v[36:39], v[32:35], v[112:127]
    ds_read_b64_tr_b16 v[66:67], v20 offset:33792
    ds_read_b128 v[60:63], v16 offset:20480
    v_mfma_f32_32x32x16_bf16 v[144:159], v[164:167], v[32:35], v[144:159]
    ds_read_b64_tr_b16 v[68:69], v21 offset:32768
    ds_read_b64_tr_b16 v[70:71], v21 offset:33792
    v_mfma_f32_32x32x16_bf16 v[128:143], v[164:167], v[28:31], v[128:143]
    v_mfma_f32_32x32x16_bf16 v[96:111], v[80:83], v[72:75], v[96:111]
    ds_read_b128 v[28:31], v17 offset:16384
    ds_read_b64_tr_b16 v[36:37], v22 offset:32768
    v_mfma_f32_32x32x16_bf16 v[112:127], v[80:83], v[76:79], v[112:127]
    ds_read_b64_tr_b16 v[38:39], v22 offset:33792
    ds_read_b128 v[32:35], v17 offset:20480
    v_mfma_f32_32x32x16_bf16 v[144:159], v[84:87], v[76:79], v[144:159]
    ds_read_b64_tr_b16 v[164:165], v23 offset:32768
    ds_read_b64_tr_b16 v[166:167], v23 offset:33792
    v_mfma_f32_32x32x16_bf16 v[128:143], v[84:87], v[72:75], v[128:143]
    s_waitcnt lgkmcnt(9)
    v_mfma_f32_32x32x16_bf16 v[96:111], v[64:67], v[56:59], v[96:111]
    ds_read_b128 v[72:75], v18 offset:16384
    ds_read_b64_tr_b16 v[80:81], v24 offset:32768
    s_waitcnt lgkmcnt(10)
    v_mfma_f32_32x32x16_bf16 v[112:127], v[64:67], v[60:63], v[112:127]
    ds_read_b64_tr_b16 v[82:83], v24 offset:33792
    ds_read_b128 v[76:79], v18 offset:20480
    v_mfma_f32_16x16x32_bf16 v[40:43], v[64:67], v[88:91], v[40:43]
    s_waitcnt lgkmcnt(10)
    v_mfma_f32_32x32x16_bf16 v[144:159], v[68:71], v[60:63], v[144:159]
    ds_read_b64_tr_b16 v[84:85], v25 offset:32768
    ds_read_b64_tr_b16 v[86:87], v25 offset:33792
    v_mfma_f32_32x32x16_bf16 v[128:143], v[68:71], v[56:59], v[128:143]
    v_mfma_f32_16x16x32_bf16 v[44:47], v[68:71], v[88:91], v[44:47]
    s_waitcnt lgkmcnt(9)
    v_mfma_f32_32x32x16_bf16 v[96:111], v[36:39], v[28:31], v[96:111]
    ds_read_b128 v[56:59], v19 offset:16384
    ds_read_b64_tr_b16 v[64:65], v26 offset:32768
    s_waitcnt lgkmcnt(10)
    v_mfma_f32_32x32x16_bf16 v[112:127], v[36:39], v[32:35], v[112:127]
    ds_read_b64_tr_b16 v[66:67], v26 offset:33792
    ds_read_b128 v[60:63], v19 offset:20480
    v_mfma_f32_16x16x32_bf16 v[40:43], v[36:39], v[88:91], v[40:43]
    s_waitcnt lgkmcnt(10)
    v_mfma_f32_32x32x16_bf16 v[144:159], v[164:167], v[32:35], v[144:159]
    ds_read_b64_tr_b16 v[68:69], v27 offset:32768
    ds_read_b64_tr_b16 v[70:71], v27 offset:33792
    v_mfma_f32_32x32x16_bf16 v[128:143], v[164:167], v[28:31], v[128:143]
    v_mfma_f32_16x16x32_bf16 v[44:47], v[164:167], v[88:91], v[44:47]
    s_waitcnt lgkmcnt(9)
    v_mfma_f32_32x32x16_bf16 v[96:111], v[80:83], v[72:75], v[96:111]
    s_waitcnt lgkmcnt(0)
    s_barrier
    ds_read_b128 v[28:31], v16 offset:49152
    v_add_u32 v20, 49152, v20
    ds_read_b64_tr_b16 v[36:37], v20 offset:49152
    v_mfma_f32_32x32x16_bf16 v[112:127], v[80:83], v[76:79], v[112:127]
    ds_read_b64_tr_b16 v[38:39], v20 offset:50176
    ds_read_b128 v[32:35], v16 offset:53248
    v_mfma_f32_32x32x16_bf16 v[144:159], v[84:87], v[76:79], v[144:159]
    v_add_u32 v21, 49152, v21
    ds_read_b64_tr_b16 v[164:165], v21 offset:49152
    ds_read_b64_tr_b16 v[166:167], v21 offset:50176
    v_mfma_f32_32x32x16_bf16 v[128:143], v[84:87], v[72:75], v[128:143]
    v_mfma_f32_32x32x16_bf16 v[96:111], v[64:67], v[56:59], v[96:111]
    ds_read_b128 v[72:75], v17 offset:49152
    v_add_u32 v22, 49152, v22
    ds_read_b64_tr_b16 v[80:81], v22 offset:49152
    v_mfma_f32_32x32x16_bf16 v[112:127], v[64:67], v[60:63], v[112:127]
    ds_read_b64_tr_b16 v[82:83], v22 offset:50176
    ds_read_b128 v[76:79], v17 offset:53248
    v_mfma_f32_32x32x16_bf16 v[144:159], v[68:71], v[60:63], v[144:159]
    v_add_u32 v23, 49152, v23
    ds_read_b64_tr_b16 v[84:85], v23 offset:49152
    ds_read_b64_tr_b16 v[86:87], v23 offset:50176
    v_mfma_f32_32x32x16_bf16 v[128:143], v[68:71], v[56:59], v[128:143]
    s_waitcnt lgkmcnt(9)
    v_mfma_f32_32x32x16_bf16 v[96:111], v[36:39], v[28:31], v[96:111]
    ds_read_b128 v[56:59], v18 offset:49152
    v_add_u32 v24, 49152, v24
    ds_read_b64_tr_b16 v[64:65], v24 offset:49152
    s_waitcnt lgkmcnt(10)
    v_mfma_f32_32x32x16_bf16 v[112:127], v[36:39], v[32:35], v[112:127]
    ds_read_b64_tr_b16 v[66:67], v24 offset:50176
    ds_read_b128 v[60:63], v18 offset:53248
    v_mfma_f32_16x16x32_bf16 v[40:43], v[36:39], v[88:91], v[40:43]
    s_waitcnt lgkmcnt(10)
    v_mfma_f32_32x32x16_bf16 v[144:159], v[164:167], v[32:35], v[144:159]
    v_add_u32 v25, 49152, v25
    ds_read_b64_tr_b16 v[68:69], v25 offset:49152
    ds_read_b64_tr_b16 v[70:71], v25 offset:50176
    v_mfma_f32_32x32x16_bf16 v[128:143], v[164:167], v[28:31], v[128:143]
    v_mfma_f32_16x16x32_bf16 v[44:47], v[164:167], v[88:91], v[44:47]
    s_waitcnt lgkmcnt(9)
    v_mfma_f32_32x32x16_bf16 v[96:111], v[80:83], v[72:75], v[96:111]
    ds_read_b128 v[28:31], v19 offset:49152
    v_add_u32 v26, 49152, v26
    ds_read_b64_tr_b16 v[36:37], v26 offset:49152
    s_waitcnt lgkmcnt(10)
    v_mfma_f32_32x32x16_bf16 v[112:127], v[80:83], v[76:79], v[112:127]
    ds_read_b64_tr_b16 v[38:39], v26 offset:50176
    ds_read_b128 v[32:35], v19 offset:53248
    v_mfma_f32_16x16x32_bf16 v[40:43], v[80:83], v[88:91], v[40:43]
    s_waitcnt lgkmcnt(10)
    v_mfma_f32_32x32x16_bf16 v[144:159], v[84:87], v[76:79], v[144:159]
    v_add_u32 v27, 49152, v27
    ds_read_b64_tr_b16 v[164:165], v27 offset:49152
    ds_read_b64_tr_b16 v[166:167], v27 offset:50176
    v_mfma_f32_32x32x16_bf16 v[128:143], v[84:87], v[72:75], v[128:143]
    v_mfma_f32_16x16x32_bf16 v[44:47], v[84:87], v[88:91], v[44:47]
    s_waitcnt lgkmcnt(9)
    v_mfma_f32_32x32x16_bf16 v[96:111], v[64:67], v[56:59], v[96:111]
    s_waitcnt lgkmcnt(0)
    s_barrier
    v_add_u32 v16, 16384, v16
    ds_read_b128 v[72:75], v16 offset:49152
    v_add_u32 v20, 4294918144, v20
    ds_read_b64_tr_b16 v[80:81], v20 offset:0
    v_mfma_f32_32x32x16_bf16 v[112:127], v[64:67], v[60:63], v[112:127]
    ds_read_b64_tr_b16 v[82:83], v20 offset:1024
    ds_read_b128 v[76:79], v16 offset:53248
    v_mfma_f32_32x32x16_bf16 v[144:159], v[68:71], v[60:63], v[144:159]
    v_add_u32 v21, 4294918144, v21
    ds_read_b64_tr_b16 v[84:85], v21 offset:0
    ds_read_b64_tr_b16 v[86:87], v21 offset:1024
    v_mfma_f32_32x32x16_bf16 v[128:143], v[68:71], v[56:59], v[128:143]
    v_mfma_f32_32x32x16_bf16 v[96:111], v[36:39], v[28:31], v[96:111]
    v_add_u32 v17, 16384, v17
    ds_read_b128 v[56:59], v17 offset:49152
    v_add_u32 v22, 4294918144, v22
    ds_read_b64_tr_b16 v[64:65], v22 offset:0
    v_mfma_f32_32x32x16_bf16 v[112:127], v[36:39], v[32:35], v[112:127]
    ds_read_b64_tr_b16 v[66:67], v22 offset:1024
    ds_read_b128 v[60:63], v17 offset:53248
    v_mfma_f32_32x32x16_bf16 v[144:159], v[164:167], v[32:35], v[144:159]
    v_add_u32 v23, 4294918144, v23
    ds_read_b64_tr_b16 v[68:69], v23 offset:0
    ds_read_b64_tr_b16 v[70:71], v23 offset:1024
    v_mfma_f32_32x32x16_bf16 v[128:143], v[164:167], v[28:31], v[128:143]
    s_waitcnt lgkmcnt(9)
    v_mfma_f32_32x32x16_bf16 v[96:111], v[80:83], v[72:75], v[96:111]
    v_add_u32 v18, 16384, v18
    ds_read_b128 v[28:31], v18 offset:49152
    v_add_u32 v24, 4294918144, v24
    ds_read_b64_tr_b16 v[36:37], v24 offset:0
    s_waitcnt lgkmcnt(10)
    v_mfma_f32_32x32x16_bf16 v[112:127], v[80:83], v[76:79], v[112:127]
    ds_read_b64_tr_b16 v[38:39], v24 offset:1024
    ds_read_b128 v[32:35], v18 offset:53248
    v_mfma_f32_16x16x32_bf16 v[40:43], v[80:83], v[88:91], v[40:43]
    s_waitcnt lgkmcnt(10)
    v_mfma_f32_32x32x16_bf16 v[144:159], v[84:87], v[76:79], v[144:159]
    v_add_u32 v25, 4294918144, v25
    ds_read_b64_tr_b16 v[164:165], v25 offset:0
    ds_read_b64_tr_b16 v[166:167], v25 offset:1024
    v_mfma_f32_32x32x16_bf16 v[128:143], v[84:87], v[72:75], v[128:143]
    v_mfma_f32_16x16x32_bf16 v[44:47], v[84:87], v[88:91], v[44:47]
    s_waitcnt lgkmcnt(9)
    v_mfma_f32_32x32x16_bf16 v[96:111], v[64:67], v[56:59], v[96:111]
    v_add_u32 v19, 16384, v19
    ds_read_b128 v[72:75], v19 offset:49152
    v_add_u32 v26, 4294918144, v26
    ds_read_b64_tr_b16 v[80:81], v26 offset:0
    s_waitcnt lgkmcnt(10)
    v_mfma_f32_32x32x16_bf16 v[112:127], v[64:67], v[60:63], v[112:127]
    ds_read_b64_tr_b16 v[82:83], v26 offset:1024
    ds_read_b128 v[76:79], v19 offset:53248
    v_mfma_f32_16x16x32_bf16 v[40:43], v[64:67], v[88:91], v[40:43]
    s_waitcnt lgkmcnt(10)
    v_mfma_f32_32x32x16_bf16 v[144:159], v[68:71], v[60:63], v[144:159]
    v_add_u32 v27, 4294918144, v27
    ds_read_b64_tr_b16 v[84:85], v27 offset:0
    ds_read_b64_tr_b16 v[86:87], v27 offset:1024
    v_mfma_f32_32x32x16_bf16 v[128:143], v[68:71], v[56:59], v[128:143]
    v_mfma_f32_16x16x32_bf16 v[44:47], v[68:71], v[88:91], v[44:47]
    s_waitcnt lgkmcnt(9)
    v_mfma_f32_32x32x16_bf16 v[96:111], v[36:39], v[28:31], v[96:111]
    s_waitcnt lgkmcnt(0)
    s_barrier
    v_add_u32 v16, 4294950912, v16
    ds_read_b128 v[56:59], v16 offset:0
    ds_read_b64_tr_b16 v[64:65], v20 offset:16384
    v_mfma_f32_32x32x16_bf16 v[112:127], v[36:39], v[32:35], v[112:127]
    ds_read_b64_tr_b16 v[66:67], v20 offset:17408
    ds_read_b128 v[60:63], v16 offset:4096
    v_mfma_f32_32x32x16_bf16 v[144:159], v[164:167], v[32:35], v[144:159]
    ds_read_b64_tr_b16 v[68:69], v21 offset:16384
    ds_read_b64_tr_b16 v[70:71], v21 offset:17408
    v_mfma_f32_32x32x16_bf16 v[128:143], v[164:167], v[28:31], v[128:143]
    v_mfma_f32_32x32x16_bf16 v[96:111], v[80:83], v[72:75], v[96:111]
    v_add_u32 v17, 4294950912, v17
    ds_read_b128 v[28:31], v17 offset:0
    ds_read_b64_tr_b16 v[36:37], v22 offset:16384
    v_mfma_f32_32x32x16_bf16 v[112:127], v[80:83], v[76:79], v[112:127]
    ds_read_b64_tr_b16 v[38:39], v22 offset:17408
    ds_read_b128 v[32:35], v17 offset:4096
    v_mfma_f32_32x32x16_bf16 v[144:159], v[84:87], v[76:79], v[144:159]
    ds_read_b64_tr_b16 v[164:165], v23 offset:16384
    ds_read_b64_tr_b16 v[166:167], v23 offset:17408
    v_mfma_f32_32x32x16_bf16 v[128:143], v[84:87], v[72:75], v[128:143]
    s_waitcnt lgkmcnt(9)
    v_mfma_f32_32x32x16_bf16 v[96:111], v[64:67], v[56:59], v[96:111]
    v_add_u32 v18, 4294950912, v18
    ds_read_b128 v[72:75], v18 offset:0
    ds_read_b64_tr_b16 v[80:81], v24 offset:16384
    s_waitcnt lgkmcnt(10)
    v_mfma_f32_32x32x16_bf16 v[112:127], v[64:67], v[60:63], v[112:127]
    ds_read_b64_tr_b16 v[82:83], v24 offset:17408
    ds_read_b128 v[76:79], v18 offset:4096
    v_mfma_f32_16x16x32_bf16 v[40:43], v[64:67], v[88:91], v[40:43]
    s_waitcnt lgkmcnt(10)
    v_mfma_f32_32x32x16_bf16 v[144:159], v[68:71], v[60:63], v[144:159]
    ds_read_b64_tr_b16 v[84:85], v25 offset:16384
    ds_read_b64_tr_b16 v[86:87], v25 offset:17408
    v_mfma_f32_32x32x16_bf16 v[128:143], v[68:71], v[56:59], v[128:143]
    v_mfma_f32_16x16x32_bf16 v[44:47], v[68:71], v[88:91], v[44:47]
    s_waitcnt lgkmcnt(9)
    v_mfma_f32_32x32x16_bf16 v[96:111], v[36:39], v[28:31], v[96:111]
    v_add_u32 v19, 4294950912, v19
    ds_read_b128 v[56:59], v19 offset:0
    ds_read_b64_tr_b16 v[64:65], v26 offset:16384
    s_waitcnt lgkmcnt(10)
    v_mfma_f32_32x32x16_bf16 v[112:127], v[36:39], v[32:35], v[112:127]
    ds_read_b64_tr_b16 v[66:67], v26 offset:17408
    ds_read_b128 v[60:63], v19 offset:4096
    v_mfma_f32_16x16x32_bf16 v[40:43], v[36:39], v[88:91], v[40:43]
    s_waitcnt lgkmcnt(10)
    v_mfma_f32_32x32x16_bf16 v[144:159], v[164:167], v[32:35], v[144:159]
    ds_read_b64_tr_b16 v[68:69], v27 offset:16384
    ds_read_b64_tr_b16 v[70:71], v27 offset:17408
    v_mfma_f32_32x32x16_bf16 v[128:143], v[164:167], v[28:31], v[128:143]
    v_mfma_f32_16x16x32_bf16 v[44:47], v[164:167], v[88:91], v[44:47]
    s_waitcnt lgkmcnt(9)
    v_mfma_f32_32x32x16_bf16 v[96:111], v[80:83], v[72:75], v[96:111]
    s_waitcnt lgkmcnt(0)
    s_barrier
    ds_read_b128 v[28:31], v16 offset:16384
    ds_read_b64_tr_b16 v[36:37], v20 offset:32768
    v_mfma_f32_32x32x16_bf16 v[112:127], v[80:83], v[76:79], v[112:127]
    ds_read_b64_tr_b16 v[38:39], v20 offset:33792
    ds_read_b128 v[32:35], v16 offset:20480
    v_mfma_f32_32x32x16_bf16 v[144:159], v[84:87], v[76:79], v[144:159]
    ds_read_b64_tr_b16 v[164:165], v21 offset:32768
    ds_read_b64_tr_b16 v[166:167], v21 offset:33792
    v_mfma_f32_32x32x16_bf16 v[128:143], v[84:87], v[72:75], v[128:143]
    v_mfma_f32_32x32x16_bf16 v[96:111], v[64:67], v[56:59], v[96:111]
    ds_read_b128 v[72:75], v17 offset:16384
    ds_read_b64_tr_b16 v[80:81], v22 offset:32768
    v_mfma_f32_32x32x16_bf16 v[112:127], v[64:67], v[60:63], v[112:127]
    ds_read_b64_tr_b16 v[82:83], v22 offset:33792
    ds_read_b128 v[76:79], v17 offset:20480
    v_mfma_f32_32x32x16_bf16 v[144:159], v[68:71], v[60:63], v[144:159]
    ds_read_b64_tr_b16 v[84:85], v23 offset:32768
    ds_read_b64_tr_b16 v[86:87], v23 offset:33792
    v_mfma_f32_32x32x16_bf16 v[128:143], v[68:71], v[56:59], v[128:143]
    s_waitcnt lgkmcnt(9)
    v_mfma_f32_32x32x16_bf16 v[96:111], v[36:39], v[28:31], v[96:111]
    ds_read_b128 v[56:59], v18 offset:16384
    ds_read_b64_tr_b16 v[64:65], v24 offset:32768
    buffer_load_dword v13, off, s[64:67], 0 offset:192 sc1
    s_waitcnt lgkmcnt(10)
    v_mfma_f32_32x32x16_bf16 v[112:127], v[36:39], v[32:35], v[112:127]
    ds_read_b64_tr_b16 v[66:67], v24 offset:33792
    ds_read_b128 v[60:63], v18 offset:20480
    v_mfma_f32_16x16x32_bf16 v[40:43], v[36:39], v[88:91], v[40:43]
    s_waitcnt lgkmcnt(10)
    v_mfma_f32_32x32x16_bf16 v[144:159], v[164:167], v[32:35], v[144:159]
    ds_read_b64_tr_b16 v[68:69], v25 offset:32768
    ds_read_b64_tr_b16 v[70:71], v25 offset:33792
    v_mfma_f32_32x32x16_bf16 v[128:143], v[164:167], v[28:31], v[128:143]
    v_mfma_f32_16x16x32_bf16 v[44:47], v[164:167], v[88:91], v[44:47]
    s_waitcnt lgkmcnt(9)
    v_mfma_f32_32x32x16_bf16 v[96:111], v[80:83], v[72:75], v[96:111]
    ds_read_b128 v[28:31], v19 offset:16384
    ds_read_b64_tr_b16 v[36:37], v26 offset:32768
    s_waitcnt lgkmcnt(10)
    v_mfma_f32_32x32x16_bf16 v[112:127], v[80:83], v[76:79], v[112:127]
    ds_read_b64_tr_b16 v[38:39], v26 offset:33792
    ds_read_b128 v[32:35], v19 offset:20480
    v_mfma_f32_16x16x32_bf16 v[40:43], v[80:83], v[88:91], v[40:43]
    s_waitcnt lgkmcnt(10)
    v_mfma_f32_32x32x16_bf16 v[144:159], v[84:87], v[76:79], v[144:159]
    ds_read_b64_tr_b16 v[164:165], v27 offset:32768
    ds_read_b64_tr_b16 v[166:167], v27 offset:33792
    v_mfma_f32_32x32x16_bf16 v[128:143], v[84:87], v[72:75], v[128:143]
    v_mfma_f32_16x16x32_bf16 v[44:47], v[84:87], v[88:91], v[44:47]
    s_waitcnt lgkmcnt(9)
    v_mfma_f32_32x32x16_bf16 v[96:111], v[64:67], v[56:59], v[96:111]
    s_waitcnt lgkmcnt(0)
    s_barrier
    ds_read_b128 v[72:75], v16 offset:32768
    ds_read_b64_tr_b16 v[80:81], v20 offset:0
    v_mfma_f32_32x32x16_bf16 v[112:127], v[64:67], v[60:63], v[112:127]
    ds_read_b64_tr_b16 v[82:83], v20 offset:1024
    ds_read_b128 v[76:79], v16 offset:36864
    v_mfma_f32_32x32x16_bf16 v[144:159], v[68:71], v[60:63], v[144:159]
    ds_read_b64_tr_b16 v[84:85], v21 offset:0
    ds_read_b64_tr_b16 v[86:87], v21 offset:1024
    v_mfma_f32_32x32x16_bf16 v[128:143], v[68:71], v[56:59], v[128:143]
    v_mfma_f32_32x32x16_bf16 v[96:111], v[36:39], v[28:31], v[96:111]
    ds_read_b128 v[56:59], v17 offset:32768
    ds_read_b64_tr_b16 v[64:65], v22 offset:0
    v_mfma_f32_32x32x16_bf16 v[112:127], v[36:39], v[32:35], v[112:127]
    ds_read_b64_tr_b16 v[66:67], v22 offset:1024
    ds_read_b128 v[60:63], v17 offset:36864
    v_mfma_f32_32x32x16_bf16 v[144:159], v[164:167], v[32:35], v[144:159]
    ds_read_b64_tr_b16 v[68:69], v23 offset:0
    ds_read_b64_tr_b16 v[70:71], v23 offset:1024
    v_mfma_f32_32x32x16_bf16 v[128:143], v[164:167], v[28:31], v[128:143]
    s_waitcnt lgkmcnt(9)
    v_mfma_f32_32x32x16_bf16 v[96:111], v[80:83], v[72:75], v[96:111]
    ds_read_b128 v[28:31], v18 offset:32768
    ds_read_b64_tr_b16 v[36:37], v24 offset:0
    s_waitcnt lgkmcnt(10)
    v_mfma_f32_32x32x16_bf16 v[112:127], v[80:83], v[76:79], v[112:127]
    ds_read_b64_tr_b16 v[38:39], v24 offset:1024
    ds_read_b128 v[32:35], v18 offset:36864
    v_mfma_f32_16x16x32_bf16 v[40:43], v[80:83], v[88:91], v[40:43]
    s_waitcnt lgkmcnt(10)
    v_mfma_f32_32x32x16_bf16 v[144:159], v[84:87], v[76:79], v[144:159]
    ds_read_b64_tr_b16 v[164:165], v25 offset:0
    ds_read_b64_tr_b16 v[166:167], v25 offset:1024
    v_mfma_f32_32x32x16_bf16 v[128:143], v[84:87], v[72:75], v[128:143]
    v_mfma_f32_16x16x32_bf16 v[44:47], v[84:87], v[88:91], v[44:47]
    s_waitcnt lgkmcnt(9)
    v_mfma_f32_32x32x16_bf16 v[96:111], v[64:67], v[56:59], v[96:111]
    ds_read_b128 v[72:75], v19 offset:32768
    ds_read_b64_tr_b16 v[80:81], v26 offset:0
    s_waitcnt lgkmcnt(10)
    v_mfma_f32_32x32x16_bf16 v[112:127], v[64:67], v[60:63], v[112:127]
    ds_read_b64_tr_b16 v[82:83], v26 offset:1024
    ds_read_b128 v[76:79], v19 offset:36864
    v_mfma_f32_16x16x32_bf16 v[40:43], v[64:67], v[88:91], v[40:43]
    s_waitcnt lgkmcnt(10)
    v_mfma_f32_32x32x16_bf16 v[144:159], v[68:71], v[60:63], v[144:159]
    ds_read_b64_tr_b16 v[84:85], v27 offset:0
    ds_read_b64_tr_b16 v[86:87], v27 offset:1024
    v_mfma_f32_32x32x16_bf16 v[128:143], v[68:71], v[56:59], v[128:143]
    v_mfma_f32_16x16x32_bf16 v[44:47], v[68:71], v[88:91], v[44:47]
    s_waitcnt lgkmcnt(9)
    v_mfma_f32_32x32x16_bf16 v[96:111], v[36:39], v[28:31], v[96:111]
    ds_write_b128 v7, v[40:43]
    s_nop 4
    ds_write_b128 v7, v[44:47] offset:1024
    s_waitcnt lgkmcnt(10)
    v_mfma_f32_32x32x16_bf16 v[112:127], v[36:39], v[32:35], v[112:127]
    s_waitcnt lgkmcnt(0)
    s_barrier
    ds_read_b32 v10, v8
    ds_read_b32 v11, v8 offset:1024
    ds_read2_b32 v[160:161], v9 offset0:0 offset1:32
    ds_read2_b32 v[162:163], v12 offset0:0 offset1:32
    v_mfma_f32_32x32x16_bf16 v[144:159], v[164:167], v[32:35], v[144:159]
    v_mfma_f32_32x32x16_bf16 v[128:143], v[164:167], v[28:31], v[128:143]
    v_mfma_f32_32x32x16_bf16 v[96:111], v[80:83], v[72:75], v[96:111]
    s_waitcnt lgkmcnt(0)
    v_cvt_pk_bf16_f32 v58, 0, v10
    v_cvt_pk_bf16_f32 v62, 0, v11
    v_cvt_pk_bf16_f32 v64, -v160, -v160
    v_cvt_pk_bf16_f32 v66, -v161, -v161
    v_sub_f32 v58, v10, v58
    v_mfma_f32_32x32x16_bf16 v[112:127], v[80:83], v[76:79], v[112:127]
    v_sub_f32 v62, v11, v62
    v_cvt_pk_bf16_f32 v65, -v160, 0
    v_cvt_pk_bf16_f32 v67, -v161, 0
    v_cvt_pk_bf16_f32 v59, 0, v58
    v_cvt_pk_bf16_f32 v63, 0, v62
    v_mfma_f32_32x32x16_bf16 v[144:159], v[84:87], v[76:79], v[144:159]
    v_cvt_pk_bf16_f32 v56, v10, v58
    v_cvt_pk_bf16_f32 v60, v11, v62
    v_sub_f32 v59, v58, v59
    v_sub_f32 v63, v62, v63
    v_cvt_pk_bf16_f32 v57, v59, 0
    v_cvt_pk_bf16_f32 v61, v63, 0
    v_mfma_f32_32x32x16_bf16 v[128:143], v[84:87], v[72:75], v[128:143]
    v_mfma_f32_32x32x8_bf16 v[96:111], v[56:57], v[64:65], v[96:111]
    v_mfma_f32_32x32x8_bf16 v[112:127], v[56:57], v[66:67], v[112:127]
    v_mfma_f32_32x32x8_bf16 v[144:159], v[60:61], v[66:67], v[144:159]
    v_mfma_f32_32x32x8_bf16 v[128:143], v[60:61], v[64:65], v[128:143]
    s_cmp_eq_u32 s9, 3
    s_nop 7
    s_cbranch_scc1 L_f_pub
    s_setprio 3
    v_mul_f32 v162, s8, v162
    v_mul_f32 v164, s8, v163
    s_nop 3
    v_mul_f32 v96, v96, v162
    v_mul_f32 v97, v97, v162
    v_mul_f32 v98, v98, v162
    v_mul_f32 v99, v99, v162
    v_mul_f32 v100, v100, v162
    v_mul_f32 v101, v101, v162
    v_mul_f32 v102, v102, v162
    v_mul_f32 v103, v103, v162
    v_mul_f32 v104, v104, v162
    v_mul_f32 v105, v105, v162
    v_mul_f32 v106, v106, v162
    v_mul_f32 v107, v107, v162
    v_mul_f32 v108, v108, v162
    v_mul_f32 v109, v109, v162
    v_mul_f32 v110, v110, v162
    v_mul_f32 v111, v111, v162
    v_cvt_pk_bf16_f32 v96, v96, v97
    v_cvt_pk_bf16_f32 v97, v98, v99
    v_cvt_pk_bf16_f32 v98, v100, v101
    v_cvt_pk_bf16_f32 v99, v102, v103
    v_cvt_pk_bf16_f32 v100, v104, v105
    v_cvt_pk_bf16_f32 v101, v106, v107
    v_cvt_pk_bf16_f32 v102, v108, v109
    v_cvt_pk_bf16_f32 v103, v110, v111
    buffer_store_dwordx4 v[96:99], v5, s[44:47], s4 offen offset:0 sc1
    buffer_store_dwordx4 v[100:103], v5, s[44:47], s4 offen offset:1024 sc1
    v_mul_f32 v112, v112, v164
    v_mul_f32 v113, v113, v164
    v_mul_f32 v114, v114, v164
    v_mul_f32 v115, v115, v164
    v_mul_f32 v116, v116, v164
    v_mul_f32 v117, v117, v164
    v_mul_f32 v118, v118, v164
    v_mul_f32 v119, v119, v164
    v_mul_f32 v120, v120, v164
    v_mul_f32 v121, v121, v164
    v_mul_f32 v122, v122, v164
    v_mul_f32 v123, v123, v164
    v_mul_f32 v124, v124, v164
    v_mul_f32 v125, v125, v164
    v_mul_f32 v126, v126, v164
    v_mul_f32 v127, v127, v164
    v_cvt_pk_bf16_f32 v112, v112, v113
    v_cvt_pk_bf16_f32 v113, v114, v115
    v_cvt_pk_bf16_f32 v114, v116, v117
    v_cvt_pk_bf16_f32 v115, v118, v119
    v_cvt_pk_bf16_f32 v116, v120, v121
    v_cvt_pk_bf16_f32 v117, v122, v123
    v_cvt_pk_bf16_f32 v118, v124, v125
    v_cvt_pk_bf16_f32 v119, v126, v127
    buffer_store_dwordx4 v[112:115], v5, s[44:47], s5 offen offset:0 sc1
    buffer_store_dwordx4 v[116:119], v5, s[44:47], s5 offen offset:1024 sc1
    v_mul_f32 v144, v144, v164
    v_mul_f32 v145, v145, v164
    v_mul_f32 v146, v146, v164
    v_mul_f32 v147, v147, v164
    v_mul_f32 v148, v148, v164
    v_mul_f32 v149, v149, v164
    v_mul_f32 v150, v150, v164
    v_mul_f32 v151, v151, v164
    v_mul_f32 v152, v152, v164
    v_mul_f32 v153, v153, v164
    v_mul_f32 v154, v154, v164
    v_mul_f32 v155, v155, v164
    v_mul_f32 v156, v156, v164
    v_mul_f32 v157, v157, v164
    v_mul_f32 v158, v158, v164
    v_mul_f32 v159, v159, v164
    v_cvt_pk_bf16_f32 v144, v144, v145
    v_cvt_pk_bf16_f32 v145, v146, v147
    v_cvt_pk_bf16_f32 v146, v148, v149
    v_cvt_pk_bf16_f32 v147, v150, v151
    v_cvt_pk_bf16_f32 v148, v152, v153
    v_cvt_pk_bf16_f32 v149, v154, v155
    v_cvt_pk_bf16_f32 v150, v156, v157
    v_cvt_pk_bf16_f32 v151, v158, v159
    buffer_store_dwordx4 v[144:147], v5, s[44:47], s5 offen offset:2048 sc1
    buffer_store_dwordx4 v[148:151], v5, s[44:47], s5 offen offset:3072 sc1
    v_mul_f32 v128, v128, v162
    v_mul_f32 v129, v129, v162
    v_mul_f32 v130, v130, v162
    v_mul_f32 v131, v131, v162
    v_mul_f32 v132, v132, v162
    v_mul_f32 v133, v133, v162
    v_mul_f32 v134, v134, v162
    v_mul_f32 v135, v135, v162
    v_mul_f32 v136, v136, v162
    v_mul_f32 v137, v137, v162
    v_mul_f32 v138, v138, v162
    v_mul_f32 v139, v139, v162
    v_mul_f32 v140, v140, v162
    v_mul_f32 v141, v141, v162
    v_mul_f32 v142, v142, v162
    v_mul_f32 v143, v143, v162
    v_cvt_pk_bf16_f32 v128, v128, v129
    v_cvt_pk_bf16_f32 v129, v130, v131
    v_cvt_pk_bf16_f32 v130, v132, v133
    v_cvt_pk_bf16_f32 v131, v134, v135
    v_cvt_pk_bf16_f32 v132, v136, v137
    v_cvt_pk_bf16_f32 v133, v138, v139
    v_cvt_pk_bf16_f32 v134, v140, v141
    v_cvt_pk_bf16_f32 v135, v142, v143
    buffer_store_dwordx4 v[128:131], v5, s[44:47], s4 offen offset:2048 sc1
    buffer_store_dwordx4 v[132:135], v5, s[44:47], s4 offen offset:3072 sc1
    s_branch L_f_pub
L_f_hp:
    s_load_dwordx4 s[36:39], s[0:1], 32
    s_setprio 1
    s_sub_u32 s31, s29, 4
    s_lshl_b32 s30, s31, 2
    s_add_u32 s30, s30, 176
    v_mov_b32 v50, s30
    v_xor_b32 v51, 4, v50
    v_and_b32 v48, 7, v2
    v_lshlrev_b32 v48, 2, v48
    v_add_u32 v48, 160, v48
    v_mov_b32 v1, 224
    v_cmp_eq_u32 vcc, 63, v2
    s_nop 1
    v_cndmask_b32 v48, v48, v1, vcc
    v_lshlrev_b32 v6, 4, v4
    s_lshr_b32 s30, s29, 1
    s_lshl_b32 s68, 1, s30
    s_waitcnt lgkmcnt(0)
    s_barrier
    ds_read_b128 v[72:75], v16 offset:0
    ds_read_b64_tr_b16 v[80:81], v20 offset:16384
    ds_read_b64_tr_b16 v[82:83], v20 offset:17408
    ds_read_b128 v[76:79], v16 offset:4096
    ds_read_b64_tr_b16 v[84:85], v21 offset:16384
    ds_read_b64_tr_b16 v[86:87], v21 offset:17408
    ds_read_b128 v[56:59], v17 offset:0
    ds_read_b64_tr_b16 v[64:65], v22 offset:16384
    ds_read_b64_tr_b16 v[66:67], v22 offset:17408
    ds_read_b128 v[60:63], v17 offset:4096
    ds_read_b64_tr_b16 v[68:69], v23 offset:16384
    ds_read_b64_tr_b16 v[70:71], v23 offset:17408
    s_waitcnt lgkmcnt(9)
    v_mfma_f32_32x32x16_bf16 v[96:111], v[80:83], v[72:75], 0
    ds_read_b128 v[28:31], v18 offset:0
    ds_read_b64_tr_b16 v[36:37], v24 offset:16384
    s_waitcnt lgkmcnt(10)
    v_mfma_f32_32x32x16_bf16 v[112:127], v[80:83], v[76:79], 0
    ds_read_b64_tr_b16 v[38:39], v24 offset:17408
    ds_read_b128 v[32:35], v18 offset:4096
    v_mfma_f32_16x16x32_bf16 v[40:43], v[80:83], v[88:91], 0
    s_waitcnt lgkmcnt(10)
    v_mfma_f32_32x32x16_bf16 v[144:159], v[84:87], v[76:79], 0
    ds_read_b64_tr_b16 v[164:165], v25 offset:16384
    ds_read_b64_tr_b16 v[166:167], v25 offset:17408
    v_mfma_f32_32x32x16_bf16 v[128:143], v[84:87], v[72:75], 0
    v_mfma_f32_16x16x32_bf16 v[44:47], v[84:87], v[88:91], 0
    s_waitcnt lgkmcnt(9)
    v_mfma_f32_32x32x16_bf16 v[96:111], v[64:67], v[56:59], v[96:111]
    ds_read_b128 v[72:75], v19 offset:0
    ds_read_b64_tr_b16 v[80:81], v26 offset:16384
    s_waitcnt lgkmcnt(10)
    v_mfma_f32_32x32x16_bf16 v[112:127], v[64:67], v[60:63], v[112:127]
    ds_read_b64_tr_b16 v[82:83], v26 offset:17408
    ds_read_b128 v[76:79], v19 offset:4096
    v_mfma_f32_16x16x32_bf16 v[40:43], v[64:67], v[88:91], v[40:43]
    s_waitcnt lgkmcnt(10)
    v_mfma_f32_32x32x16_bf16 v[144:159], v[68:71], v[60:63], v[144:159]
    ds_read_b64_tr_b16 v[84:85], v27 offset:16384
    ds_read_b64_tr_b16 v[86:87], v27 offset:17408
    v_mfma_f32_32x32x16_bf16 v[128:143], v[68:71], v[56:59], v[128:143]
    v_mfma_f32_16x16x32_bf16 v[44:47], v[68:71], v[88:91], v[44:47]
    s_waitcnt lgkmcnt(9)
    v_mfma_f32_32x32x16_bf16 v[96:111], v[36:39], v[28:31], v[96:111]
    s_waitcnt lgkmcnt(0)
    s_barrier
    ds_read_b128 v[56:59], v16 offset:16384
    ds_read_b64_tr_b16 v[64:65], v20 offset:49152
    v_mfma_f32_32x32x16_bf16 v[112:127], v[36:39], v[32:35], v[112:127]
    ds_read_b64_tr_b16 v[66:67], v20 offset:50176
    ds_read_b128 v[60:63], v16 offset:20480
    v_mfma_f32_32x32x16_bf16 v[144:159], v[164:167], v[32:35], v[144:159]
    ds_read_b64_tr_b16 v[68:69], v21 offset:49152
    ds_read_b64_tr_b16 v[70:71], v21 offset:50176
    v_mfma_f32_32x32x16_bf16 v[128:143], v[164:167], v[28:31], v[128:143]
    v_mfma_f32_32x32x16_bf16 v[96:111], v[80:83], v[72:75], v[96:111]
    ds_read_b128 v[28:31], v17 offset:16384
    ds_read_b64_tr_b16 v[36:37], v22 offset:49152
    v_mfma_f32_32x32x16_bf16 v[112:127], v[80:83], v[76:79], v[112:127]
    ds_read_b64_tr_b16 v[38:39], v22 offset:50176
    ds_read_b128 v[32:35], v17 offset:20480
    v_mfma_f32_32x32x16_bf16 v[144:159], v[84:87], v[76:79], v[144:159]
    ds_read_b64_tr_b16 v[164:165], v23 offset:49152
    ds_read_b64_tr_b16 v[166:167], v23 offset:50176
    v_mfma_f32_32x32x16_bf16 v[128:143], v[84:87], v[72:75], v[128:143]
    s_waitcnt lgkmcnt(9)
    v_mfma_f32_32x32x16_bf16 v[96:111], v[64:67], v[56:59], v[96:111]
    ds_read_b128 v[72:75], v18 offset:16384
    ds_read_b64_tr_b16 v[80:81], v24 offset:49152
    s_waitcnt lgkmcnt(10)
    v_mfma_f32_32x32x16_bf16 v[112:127], v[64:67], v[60:63], v[112:127]
    ds_read_b64_tr_b16 v[82:83], v24 offset:50176
    ds_read_b128 v[76:79], v18 offset:20480
    v_mfma_f32_16x16x32_bf16 v[40:43], v[64:67], v[88:91], v[40:43]
    s_waitcnt lgkmcnt(10)
    v_mfma_f32_32x32x16_bf16 v[144:159], v[68:71], v[60:63], v[144:159]
    ds_read_b64_tr_b16 v[84:85], v25 offset:49152
    ds_read_b64_tr_b16 v[86:87], v25 offset:50176
    v_mfma_f32_32x32x16_bf16 v[128:143], v[68:71], v[56:59], v[128:143]
    v_mfma_f32_16x16x32_bf16 v[44:47], v[68:71], v[88:91], v[44:47]
    s_waitcnt lgkmcnt(9)
    v_mfma_f32_32x32x16_bf16 v[96:111], v[36:39], v[28:31], v[96:111]
    ds_read_b128 v[56:59], v19 offset:16384
    ds_read_b64_tr_b16 v[64:65], v26 offset:49152
    s_waitcnt lgkmcnt(10)
    v_mfma_f32_32x32x16_bf16 v[112:127], v[36:39], v[32:35], v[112:127]
    ds_read_b64_tr_b16 v[66:67], v26 offset:50176
    ds_read_b128 v[60:63], v19 offset:20480
    v_mfma_f32_16x16x32_bf16 v[40:43], v[36:39], v[88:91], v[40:43]
    s_waitcnt lgkmcnt(10)
    v_mfma_f32_32x32x16_bf16 v[144:159], v[164:167], v[32:35], v[144:159]
    ds_read_b64_tr_b16 v[68:69], v27 offset:49152
    ds_read_b64_tr_b16 v[70:71], v27 offset:50176
    v_mfma_f32_32x32x16_bf16 v[128:143], v[164:167], v[28:31], v[128:143]
    v_mfma_f32_16x16x32_bf16 v[44:47], v[164:167], v[88:91], v[44:47]
    s_waitcnt lgkmcnt(9)
    v_mfma_f32_32x32x16_bf16 v[96:111], v[80:83], v[72:75], v[96:111]
    s_waitcnt lgkmcnt(0)
    s_barrier
    ds_read_b128 v[28:31], v16 offset:32768
    v_add_u32 v20, 81920, v20
    ds_read_b64_tr_b16 v[36:37], v20 offset:49152
    v_mfma_f32_32x32x16_bf16 v[112:127], v[80:83], v[76:79], v[112:127]
    ds_read_b64_tr_b16 v[38:39], v20 offset:50176
    ds_read_b128 v[32:35], v16 offset:36864
    v_mfma_f32_32x32x16_bf16 v[144:159], v[84:87], v[76:79], v[144:159]
    v_add_u32 v21, 81920, v21
    ds_read_b64_tr_b16 v[164:165], v21 offset:49152
    ds_read_b64_tr_b16 v[166:167], v21 offset:50176
    v_mfma_f32_32x32x16_bf16 v[128:143], v[84:87], v[72:75], v[128:143]
    v_mfma_f32_32x32x16_bf16 v[96:111], v[64:67], v[56:59], v[96:111]
    ds_read_b128 v[72:75], v17 offset:32768
    v_add_u32 v22, 81920, v22
    ds_read_b64_tr_b16 v[80:81], v22 offset:49152
    v_mfma_f32_32x32x16_bf16 v[112:127], v[64:67], v[60:63], v[112:127]
    ds_read_b64_tr_b16 v[82:83], v22 offset:50176
    ds_read_b128 v[76:79], v17 offset:36864
    v_mfma_f32_32x32x16_bf16 v[144:159], v[68:71], v[60:63], v[144:159]
    v_add_u32 v23, 81920, v23
    ds_read_b64_tr_b16 v[84:85], v23 offset:49152
    ds_read_b64_tr_b16 v[86:87], v23 offset:50176
    v_mfma_f32_32x32x16_bf16 v[128:143], v[68:71], v[56:59], v[128:143]
    s_waitcnt lgkmcnt(9)
    v_mfma_f32_32x32x16_bf16 v[96:111], v[36:39], v[28:31], v[96:111]
    ds_read_b128 v[56:59], v18 offset:32768
    v_add_u32 v24, 81920, v24
    ds_read_b64_tr_b16 v[64:65], v24 offset:49152
    s_waitcnt lgkmcnt(10)
    v_mfma_f32_32x32x16_bf16 v[112:127], v[36:39], v[32:35], v[112:127]
    ds_read_b64_tr_b16 v[66:67], v24 offset:50176
    ds_read_b128 v[60:63], v18 offset:36864
    v_mfma_f32_16x16x32_bf16 v[40:43], v[36:39], v[88:91], v[40:43]
    s_waitcnt lgkmcnt(10)
    v_mfma_f32_32x32x16_bf16 v[144:159], v[164:167], v[32:35], v[144:159]
    v_add_u32 v25, 81920, v25
    ds_read_b64_tr_b16 v[68:69], v25 offset:49152
    ds_read_b64_tr_b16 v[70:71], v25 offset:50176
    v_mfma_f32_32x32x16_bf16 v[128:143], v[164:167], v[28:31], v[128:143]
    v_mfma_f32_16x16x32_bf16 v[44:47], v[164:167], v[88:91], v[44:47]
    s_waitcnt lgkmcnt(9)
    v_mfma_f32_32x32x16_bf16 v[96:111], v[80:83], v[72:75], v[96:111]
    ds_read_b128 v[28:31], v19 offset:32768
    v_add_u32 v26, 81920, v26
    ds_read_b64_tr_b16 v[36:37], v26 offset:49152
    s_waitcnt lgkmcnt(10)
    v_mfma_f32_32x32x16_bf16 v[112:127], v[80:83], v[76:79], v[112:127]
    ds_read_b64_tr_b16 v[38:39], v26 offset:50176
    ds_read_b128 v[32:35], v19 offset:36864
    v_mfma_f32_16x16x32_bf16 v[40:43], v[80:83], v[88:91], v[40:43]
    s_waitcnt lgkmcnt(10)
    v_mfma_f32_32x32x16_bf16 v[144:159], v[84:87], v[76:79], v[144:159]
    v_add_u32 v27, 81920, v27
    ds_read_b64_tr_b16 v[164:165], v27 offset:49152
    ds_read_b64_tr_b16 v[166:167], v27 offset:50176
    v_mfma_f32_32x32x16_bf16 v[128:143], v[84:87], v[72:75], v[128:143]
    v_mfma_f32_16x16x32_bf16 v[44:47], v[84:87], v[88:91], v[44:47]
    s_waitcnt lgkmcnt(9)
    v_mfma_f32_32x32x16_bf16 v[96:111], v[64:67], v[56:59], v[96:111]
    s_waitcnt lgkmcnt(0)
    s_barrier
    ds_read_b128 v[72:75], v16 offset:0
    v_add_u32 v20, 4294901760, v20
    ds_read_b64_tr_b16 v[80:81], v20 offset:0
    v_mfma_f32_32x32x16_bf16 v[112:127], v[64:67], v[60:63], v[112:127]
    ds_read_b64_tr_b16 v[82:83], v20 offset:1024
    ds_read_b128 v[76:79], v16 offset:4096
    v_mfma_f32_32x32x16_bf16 v[144:159], v[68:71], v[60:63], v[144:159]
    v_add_u32 v21, 4294901760, v21
    ds_read_b64_tr_b16 v[84:85], v21 offset:0
    ds_read_b64_tr_b16 v[86:87], v21 offset:1024
    v_mfma_f32_32x32x16_bf16 v[128:143], v[68:71], v[56:59], v[128:143]
    v_mfma_f32_32x32x16_bf16 v[96:111], v[36:39], v[28:31], v[96:111]
    ds_read_b128 v[56:59], v17 offset:0
    v_add_u32 v22, 4294901760, v22
    ds_read_b64_tr_b16 v[64:65], v22 offset:0
    v_mfma_f32_32x32x16_bf16 v[112:127], v[36:39], v[32:35], v[112:127]
    ds_read_b64_tr_b16 v[66:67], v22 offset:1024
    ds_read_b128 v[60:63], v17 offset:4096
    v_mfma_f32_32x32x16_bf16 v[144:159], v[164:167], v[32:35], v[144:159]
    v_add_u32 v23, 4294901760, v23
    ds_read_b64_tr_b16 v[68:69], v23 offset:0
    ds_read_b64_tr_b16 v[70:71], v23 offset:1024
    v_mfma_f32_32x32x16_bf16 v[128:143], v[164:167], v[28:31], v[128:143]
    s_waitcnt lgkmcnt(9)
    v_mfma_f32_32x32x16_bf16 v[96:111], v[80:83], v[72:75], v[96:111]
    ds_read_b128 v[28:31], v18 offset:0
    v_add_u32 v24, 4294901760, v24
    ds_read_b64_tr_b16 v[36:37], v24 offset:0
    s_waitcnt lgkmcnt(10)
    v_mfma_f32_32x32x16_bf16 v[112:127], v[80:83], v[76:79], v[112:127]
    ds_read_b64_tr_b16 v[38:39], v24 offset:1024
    ds_read_b128 v[32:35], v18 offset:4096
    v_mfma_f32_16x16x32_bf16 v[40:43], v[80:83], v[88:91], v[40:43]
    s_waitcnt lgkmcnt(10)
    v_mfma_f32_32x32x16_bf16 v[144:159], v[84:87], v[76:79], v[144:159]
    v_add_u32 v25, 4294901760, v25
    ds_read_b64_tr_b16 v[164:165], v25 offset:0
    ds_read_b64_tr_b16 v[166:167], v25 offset:1024
    v_mfma_f32_32x32x16_bf16 v[128:143], v[84:87], v[72:75], v[128:143]
    v_mfma_f32_16x16x32_bf16 v[44:47], v[84:87], v[88:91], v[44:47]
    s_waitcnt lgkmcnt(9)
    v_mfma_f32_32x32x16_bf16 v[96:111], v[64:67], v[56:59], v[96:111]
    ds_read_b128 v[72:75], v19 offset:0
    v_add_u32 v26, 4294901760, v26
    ds_read_b64_tr_b16 v[80:81], v26 offset:0
    s_waitcnt lgkmcnt(10)
    v_mfma_f32_32x32x16_bf16 v[112:127], v[64:67], v[60:63], v[112:127]
    ds_read_b64_tr_b16 v[82:83], v26 offset:1024
    ds_read_b128 v[76:79], v19 offset:4096
    v_mfma_f32_16x16x32_bf16 v[40:43], v[64:67], v[88:91], v[40:43]
    s_waitcnt lgkmcnt(10)
    v_mfma_f32_32x32x16_bf16 v[144:159], v[68:71], v[60:63], v[144:159]
    v_add_u32 v27, 4294901760, v27
    ds_read_b64_tr_b16 v[84:85], v27 offset:0
    ds_read_b64_tr_b16 v[86:87], v27 offset:1024
    v_mfma_f32_32x32x16_bf16 v[128:143], v[68:71], v[56:59], v[128:143]
    v_mfma_f32_16x16x32_bf16 v[44:47], v[68:71], v[88:91], v[44:47]
    s_waitcnt lgkmcnt(9)
    v_mfma_f32_32x32x16_bf16 v[96:111], v[36:39], v[28:31], v[96:111]
    s_waitcnt lgkmcnt(0)
    s_barrier
    ds_read_b128 v[56:59], v16 offset:16384
    ds_read_b64_tr_b16 v[64:65], v20 offset:32768
    v_mfma_f32_32x32x16_bf16 v[112:127], v[36:39], v[32:35], v[112:127]
    ds_read_b64_tr_b16 v[66:67], v20 offset:33792
    ds_read_b128 v[60:63], v16 offset:20480
    v_mfma_f32_32x32x16_bf16 v[144:159], v[164:167], v[32:35], v[144:159]
    ds_read_b64_tr_b16 v[68:69], v21 offset:32768
    ds_read_b64_tr_b16 v[70:71], v21 offset:33792
    v_mfma_f32_32x32x16_bf16 v[128:143], v[164:167], v[28:31], v[128:143]
    v_mfma_f32_32x32x16_bf16 v[96:111], v[80:83], v[72:75], v[96:111]
    ds_read_b128 v[28:31], v17 offset:16384
    ds_read_b64_tr_b16 v[36:37], v22 offset:32768
    v_mfma_f32_32x32x16_bf16 v[112:127], v[80:83], v[76:79], v[112:127]
    ds_read_b64_tr_b16 v[38:39], v22 offset:33792
    ds_read_b128 v[32:35], v17 offset:20480
    v_mfma_f32_32x32x16_bf16 v[144:159], v[84:87], v[76:79], v[144:159]
    ds_read_b64_tr_b16 v[164:165], v23 offset:32768
    ds_read_b64_tr_b16 v[166:167], v23 offset:33792
    v_mfma_f32_32x32x16_bf16 v[128:143], v[84:87], v[72:75], v[128:143]
    s_waitcnt lgkmcnt(9)
    v_mfma_f32_32x32x16_bf16 v[96:111], v[64:67], v[56:59], v[96:111]
    ds_read_b128 v[72:75], v18 offset:16384
    ds_read_b64_tr_b16 v[80:81], v24 offset:32768
    s_waitcnt lgkmcnt(10)
    v_mfma_f32_32x32x16_bf16 v[112:127], v[64:67], v[60:63], v[112:127]
    ds_read_b64_tr_b16 v[82:83], v24 offset:33792
    ds_read_b128 v[76:79], v18 offset:20480
    v_mfma_f32_16x16x32_bf16 v[40:43], v[64:67], v[88:91], v[40:43]
    s_waitcnt lgkmcnt(10)
    v_mfma_f32_32x32x16_bf16 v[144:159], v[68:71], v[60:63], v[144:159]
    ds_read_b64_tr_b16 v[84:85], v25 offset:32768
    ds_read_b64_tr_b16 v[86:87], v25 offset:33792
    v_mfma_f32_32x32x16_bf16 v[128:143], v[68:71], v[56:59], v[128:143]
    v_mfma_f32_16x16x32_bf16 v[44:47], v[68:71], v[88:91], v[44:47]
    s_waitcnt lgkmcnt(9)
    v_mfma_f32_32x32x16_bf16 v[96:111], v[36:39], v[28:31], v[96:111]
    ds_read_b128 v[56:59], v19 offset:16384
    ds_read_b64_tr_b16 v[64:65], v26 offset:32768
    s_waitcnt lgkmcnt(10)
    v_mfma_f32_32x32x16_bf16 v[112:127], v[36:39], v[32:35], v[112:127]
    ds_read_b64_tr_b16 v[66:67], v26 offset:33792
    ds_read_b128 v[60:63], v19 offset:20480
    v_mfma_f32_16x16x32_bf16 v[40:43], v[36:39], v[88:91], v[40:43]
    s_waitcnt lgkmcnt(10)
    v_mfma_f32_32x32x16_bf16 v[144:159], v[164:167], v[32:35], v[144:159]
    ds_read_b64_tr_b16 v[68:69], v27 offset:32768
    ds_read_b64_tr_b16 v[70:71], v27 offset:33792
    v_mfma_f32_32x32x16_bf16 v[128:143], v[164:167], v[28:31], v[128:143]
    v_mfma_f32_16x16x32_bf16 v[44:47], v[164:167], v[88:91], v[44:47]
    s_waitcnt lgkmcnt(9)
    v_mfma_f32_32x32x16_bf16 v[96:111], v[80:83], v[72:75], v[96:111]
    s_waitcnt lgkmcnt(0)
    s_barrier
    v_mfma_f32_32x32x16_bf16 v[112:127], v[80:83], v[76:79], v[112:127]
    v_mfma_f32_32x32x16_bf16 v[144:159], v[84:87], v[76:79], v[144:159]
    v_mfma_f32_32x32x16_bf16 v[128:143], v[84:87], v[72:75], v[128:143]
    v_mfma_f32_32x32x16_bf16 v[96:111], v[64:67], v[56:59], v[96:111]
    v_mfma_f32_32x32x16_bf16 v[112:127], v[64:67], v[60:63], v[112:127]
    v_mfma_f32_32x32x16_bf16 v[144:159], v[68:71], v[60:63], v[144:159]
    v_mfma_f32_32x32x16_bf16 v[128:143], v[68:71], v[56:59], v[128:143]
    s_waitcnt lgkmcnt(0)
    s_barrier
    s_barrier
    s_barrier
    s_barrier
    s_barrier
    ds_read_b128 v[28:31], v16 offset:49152
    ds_read_b64_tr_b16 v[36:37], v20 offset:32768
    ds_read_b64_tr_b16 v[38:39], v20 offset:33792
    ds_read_b128 v[32:35], v16 offset:53248
    ds_read_b64_tr_b16 v[164:165], v21 offset:32768
    ds_read_b64_tr_b16 v[166:167], v21 offset:33792
    ds_read_b128 v[72:75], v17 offset:49152
    ds_read_b64_tr_b16 v[80:81], v22 offset:32768
    ds_read_b64_tr_b16 v[82:83], v22 offset:33792
    ds_read_b128 v[76:79], v17 offset:53248
    ds_read_b64_tr_b16 v[84:85], v23 offset:32768
    ds_read_b64_tr_b16 v[86:87], v23 offset:33792
    ds_read2_b32 v[160:161], v9 offset0:0 offset1:32
    ds_read2_b32 v[162:163], v12 offset0:0 offset1:32
    s_waitcnt lgkmcnt(11)
    v_mfma_f32_32x32x16_bf16 v[96:111], v[36:39], v[28:31], v[96:111]
    ds_read_b128 v[56:59], v18 offset:49152
    ds_read_b64_tr_b16 v[64:65], v24 offset:32768
    s_waitcnt lgkmcnt(12)
    v_mfma_f32_32x32x16_bf16 v[112:127], v[36:39], v[32:35], v[112:127]
    ds_read_b64_tr_b16 v[66:67], v24 offset:33792
    ds_read_b128 v[60:63], v18 offset:53248
    v_mfma_f32_16x16x32_bf16 v[40:43], v[36:39], v[88:91], v[40:43]
    s_waitcnt lgkmcnt(12)
    v_mfma_f32_32x32x16_bf16 v[144:159], v[164:167], v[32:35], v[144:159]
    ds_read_b64_tr_b16 v[68:69], v25 offset:32768
    ds_read_b64_tr_b16 v[70:71], v25 offset:33792
    v_mfma_f32_32x32x16_bf16 v[128:143], v[164:167], v[28:31], v[128:143]
    v_mfma_f32_16x16x32_bf16 v[44:47], v[164:167], v[88:91], v[44:47]
    s_waitcnt lgkmcnt(11)
    v_mfma_f32_32x32x16_bf16 v[96:111], v[80:83], v[72:75], v[96:111]
    ds_read_b32 v13, v48
    ds_read_b128 v[28:31], v19 offset:49152
    ds_read_b64_tr_b16 v[36:37], v26 offset:32768
    s_waitcnt lgkmcnt(13)
    v_mfma_f32_32x32x16_bf16 v[112:127], v[80:83], v[76:79], v[112:127]
    ds_read_b64_tr_b16 v[38:39], v26 offset:33792
    ds_read_b128 v[32:35], v19 offset:53248
    v_mfma_f32_16x16x32_bf16 v[40:43], v[80:83], v[88:91], v[40:43]
    s_waitcnt lgkmcnt(13)
    v_mfma_f32_32x32x16_bf16 v[144:159], v[84:87], v[76:79], v[144:159]
    ds_read_b64_tr_b16 v[164:165], v27 offset:32768
    ds_read_b64_tr_b16 v[166:167], v27 offset:33792
    v_mfma_f32_32x32x16_bf16 v[128:143], v[84:87], v[72:75], v[128:143]
    v_mfma_f32_16x16x32_bf16 v[44:47], v[84:87], v[88:91], v[44:47]
    s_waitcnt lgkmcnt(10)
    v_mfma_f32_32x32x16_bf16 v[96:111], v[64:67], v[56:59], v[96:111]
    s_waitcnt lgkmcnt(0)
    v_mov_b32 v1, 13
    ds_write_b32 v50, v1
    v_cmp_gt_u32 vcc, 11, v13
    s_cbranch_vccz L_f_hk10
L_f_hl10:
    ds_read_b32 v13, v48
    s_waitcnt lgkmcnt(0)
    v_cmp_gt_u32 vcc, 11, v13
    s_cbranch_vccnz L_f_hl10
L_f_hk10:
    v_add_u32 v16, 16384, v16
    ds_read_b128 v[72:75], v16 offset:49152
    ds_read_b64_tr_b16 v[80:81], v20 offset:0
    v_mfma_f32_32x32x16_bf16 v[112:127], v[64:67], v[60:63], v[112:127]
    ds_read_b64_tr_b16 v[82:83], v20 offset:1024
    ds_read_b128 v[76:79], v16 offset:53248
    v_mfma_f32_32x32x16_bf16 v[144:159], v[68:71], v[60:63], v[144:159]
    ds_read_b64_tr_b16 v[84:85], v21 offset:0
    ds_read_b64_tr_b16 v[86:87], v21 offset:1024
    v_mfma_f32_32x32x16_bf16 v[128:143], v[68:71], v[56:59], v[128:143]
    v_mfma_f32_32x32x16_bf16 v[96:111], v[36:39], v[28:31], v[96:111]
    v_add_u32 v17, 16384, v17
    ds_read_b128 v[56:59], v17 offset:49152
    ds_read_b64_tr_b16 v[64:65], v22 offset:0
    v_mfma_f32_32x32x16_bf16 v[112:127], v[36:39], v[32:35], v[112:127]
    ds_read_b64_tr_b16 v[66:67], v22 offset:1024
    ds_read_b128 v[60:63], v17 offset:53248
    v_mfma_f32_32x32x16_bf16 v[144:159], v[164:167], v[32:35], v[144:159]
    ds_read_b64_tr_b16 v[68:69], v23 offset:0
    ds_read_b64_tr_b16 v[70:71], v23 offset:1024
    v_mfma_f32_32x32x16_bf16 v[128:143], v[164:167], v[28:31], v[128:143]
    s_waitcnt lgkmcnt(9)
    v_mfma_f32_32x32x16_bf16 v[96:111], v[80:83], v[72:75], v[96:111]
    v_add_u32 v18, 16384, v18
    ds_read_b128 v[28:31], v18 offset:49152
    ds_read_b64_tr_b16 v[36:37], v24 offset:0
    s_waitcnt lgkmcnt(10)
    v_mfma_f32_32x32x16_bf16 v[112:127], v[80:83], v[76:79], v[112:127]
    ds_read_b64_tr_b16 v[38:39], v24 offset:1024
    ds_read_b128 v[32:35], v18 offset:53248
    v_mfma_f32_16x16x32_bf16 v[40:43], v[80:83], v[88:91], v[40:43]
    s_waitcnt lgkmcnt(10)
    v_mfma_f32_32x32x16_bf16 v[144:159], v[84:87], v[76:79], v[144:159]
    ds_read_b64_tr_b16 v[164:165], v25 offset:0
    ds_read_b64_tr_b16 v[166:167], v25 offset:1024
    v_mfma_f32_32x32x16_bf16 v[128:143], v[84:87], v[72:75], v[128:143]
    v_mfma_f32_16x16x32_bf16 v[44:47], v[84:87], v[88:91], v[44:47]
    s_waitcnt lgkmcnt(9)
    v_mfma_f32_32x32x16_bf16 v[96:111], v[64:67], v[56:59], v[96:111]
    ds_read_b32 v13, v48
    v_add_u32 v19, 16384, v19
    ds_read_b128 v[72:75], v19 offset:49152
    ds_read_b64_tr_b16 v[80:81], v26 offset:0
    s_waitcnt lgkmcnt(11)
    v_mfma_f32_32x32x16_bf16 v[112:127], v[64:67], v[60:63], v[112:127]
    ds_read_b64_tr_b16 v[82:83], v26 offset:1024
    ds_read_b128 v[76:79], v19 offset:53248
    v_mfma_f32_16x16x32_bf16 v[40:43], v[64:67], v[88:91], v[40:43]
    s_waitcnt lgkmcnt(11)
    v_mfma_f32_32x32x16_bf16 v[144:159], v[68:71], v[60:63], v[144:159]
    ds_read_b64_tr_b16 v[84:85], v27 offset:0
    ds_read_b64_tr_b16 v[86:87], v27 offset:1024
    v_mfma_f32_32x32x16_bf16 v[128:143], v[68:71], v[56:59], v[128:143]
    v_mfma_f32_16x16x32_bf16 v[44:47], v[68:71], v[88:91], v[44:47]
    s_waitcnt lgkmcnt(10)
    v_mfma_f32_32x32x16_bf16 v[96:111], v[36:39], v[28:31], v[96:111]
    s_waitcnt lgkmcnt(0)
    v_mov_b32 v1, 14
    ds_write_b32 v50, v1
    v_cmp_gt_u32 vcc, 12, v13
    s_cbranch_vccz L_f_hk11
L_f_hl11:
    ds_read_b32 v13, v48
    s_waitcnt lgkmcnt(0)
    v_cmp_gt_u32 vcc, 12, v13
    s_cbranch_vccnz L_f_hl11
L_f_hk11:
    v_add_u32 v16, 4294950912, v16
    ds_read_b128 v[56:59], v16 offset:0
    ds_read_b64_tr_b16 v[64:65], v20 offset:16384
    v_mfma_f32_32x32x16_bf16 v[112:127], v[36:39], v[32:35], v[112:127]
    ds_read_b64_tr_b16 v[66:67], v20 offset:17408
    ds_read_b128 v[60:63], v16 offset:4096
    v_mfma_f32_32x32x16_bf16 v[144:159], v[164:167], v[32:35], v[144:159]
    ds_read_b64_tr_b16 v[68:69], v21 offset:16384
    ds_read_b64_tr_b16 v[70:71], v21 offset:17408
    v_mfma_f32_32x32x16_bf16 v[128:143], v[164:167], v[28:31], v[128:143]
    v_mfma_f32_32x32x16_bf16 v[96:111], v[80:83], v[72:75], v[96:111]
    v_add_u32 v17, 4294950912, v17
    ds_read_b128 v[28:31], v17 offset:0
    ds_read_b64_tr_b16 v[36:37], v22 offset:16384
    v_mfma_f32_32x32x16_bf16 v[112:127], v[80:83], v[76:79], v[112:127]
    ds_read_b64_tr_b16 v[38:39], v22 offset:17408
    ds_read_b128 v[32:35], v17 offset:4096
    v_mfma_f32_32x32x16_bf16 v[144:159], v[84:87], v[76:79], v[144:159]
    ds_read_b64_tr_b16 v[164:165], v23 offset:16384
    ds_read_b64_tr_b16 v[166:167], v23 offset:17408
    v_mfma_f32_32x32x16_bf16 v[128:143], v[84:87], v[72:75], v[128:143]
    s_waitcnt lgkmcnt(9)
    v_mfma_f32_32x32x16_bf16 v[96:111], v[64:67], v[56:59], v[96:111]
    v_add_u32 v18, 4294950912, v18
    ds_read_b128 v[72:75], v18 offset:0
    ds_read_b64_tr_b16 v[80:81], v24 offset:16384
    s_waitcnt lgkmcnt(10)
    v_mfma_f32_32x32x16_bf16 v[112:127], v[64:67], v[60:63], v[112:127]
    ds_read_b64_tr_b16 v[82:83], v24 offset:17408
    ds_read_b128 v[76:79], v18 offset:4096
    v_mfma_f32_16x16x32_bf16 v[40:43], v[64:67], v[88:91], v[40:43]
    s_waitcnt lgkmcnt(10)
    v_mfma_f32_32x32x16_bf16 v[144:159], v[68:71], v[60:63], v[144:159]
    ds_read_b64_tr_b16 v[84:85], v25 offset:16384
    ds_read_b64_tr_b16 v[86:87], v25 offset:17408
    v_mfma_f32_32x32x16_bf16 v[128:143], v[68:71], v[56:59], v[128:143]
    v_mfma_f32_16x16x32_bf16 v[44:47], v[68:71], v[88:91], v[44:47]
    s_waitcnt lgkmcnt(9)
    v_mfma_f32_32x32x16_bf16 v[96:111], v[36:39], v[28:31], v[96:111]
    ds_read_b32 v13, v48
    v_add_u32 v19, 4294950912, v19
    ds_read_b128 v[56:59], v19 offset:0
    ds_read_b64_tr_b16 v[64:65], v26 offset:16384
    s_waitcnt lgkmcnt(11)
    v_mfma_f32_32x32x16_bf16 v[112:127], v[36:39], v[32:35], v[112:127]
    ds_read_b64_tr_b16 v[66:67], v26 offset:17408
    ds_read_b128 v[60:63], v19 offset:4096
    v_mfma_f32_16x16x32_bf16 v[40:43], v[36:39], v[88:91], v[40:43]
    s_waitcnt lgkmcnt(11)
    v_mfma_f32_32x32x16_bf16 v[144:159], v[164:167], v[32:35], v[144:159]
    ds_read_b64_tr_b16 v[68:69], v27 offset:16384
    ds_read_b64_tr_b16 v[70:71], v27 offset:17408
    v_mfma_f32_32x32x16_bf16 v[128:143], v[164:167], v[28:31], v[128:143]
    v_mfma_f32_16x16x32_bf16 v[44:47], v[164:167], v[88:91], v[44:47]
    s_waitcnt lgkmcnt(10)
    v_mfma_f32_32x32x16_bf16 v[96:111], v[80:83], v[72:75], v[96:111]
    s_waitcnt lgkmcnt(0)
    v_mov_b32 v1, 15
    ds_write_b32 v50, v1
    v_cmp_gt_u32 vcc, 13, v13
    s_cbranch_vccz L_f_hk12
L_f_hl12:
    ds_read_b32 v13, v48
    s_waitcnt lgkmcnt(0)
    v_cmp_gt_u32 vcc, 13, v13
    s_cbranch_vccnz L_f_hl12
L_f_hk12:
    ds_read_b128 v[28:31], v16 offset:16384
    v_add_u32 v20, 4294950912, v20
    ds_read_b64_tr_b16 v[36:37], v20 offset:0
    v_mfma_f32_32x32x16_bf16 v[112:127], v[80:83], v[76:79], v[112:127]
    ds_read_b64_tr_b16 v[38:39], v20 offset:1024
    ds_read_b128 v[32:35], v16 offset:20480
    v_mfma_f32_32x32x16_bf16 v[144:159], v[84:87], v[76:79], v[144:159]
    v_add_u32 v21, 4294950912, v21
    ds_read_b64_tr_b16 v[164:165], v21 offset:0
    ds_read_b64_tr_b16 v[166:167], v21 offset:1024
    v_mfma_f32_32x32x16_bf16 v[128:143], v[84:87], v[72:75], v[128:143]
    v_mfma_f32_32x32x16_bf16 v[96:111], v[64:67], v[56:59], v[96:111]
    ds_read_b128 v[72:75], v17 offset:16384
    v_add_u32 v22, 4294950912, v22
    ds_read_b64_tr_b16 v[80:81], v22 offset:0
    v_mfma_f32_32x32x16_bf16 v[112:127], v[64:67], v[60:63], v[112:127]
    ds_read_b64_tr_b16 v[82:83], v22 offset:1024
    ds_read_b128 v[76:79], v17 offset:20480
    v_mfma_f32_32x32x16_bf16 v[144:159], v[68:71], v[60:63], v[144:159]
    v_add_u32 v23, 4294950912, v23
    ds_read_b64_tr_b16 v[84:85], v23 offset:0
    ds_read_b64_tr_b16 v[86:87], v23 offset:1024
    v_mfma_f32_32x32x16_bf16 v[128:143], v[68:71], v[56:59], v[128:143]
    s_waitcnt lgkmcnt(9)
    v_mfma_f32_32x32x16_bf16 v[96:111], v[36:39], v[28:31], v[96:111]
    ds_read_b128 v[56:59], v18 offset:16384
    v_add_u32 v24, 4294950912, v24
    ds_read_b64_tr_b16 v[64:65], v24 offset:0
    s_waitcnt lgkmcnt(10)
    v_mfma_f32_32x32x16_bf16 v[112:127], v[36:39], v[32:35], v[112:127]
    ds_read_b64_tr_b16 v[66:67], v24 offset:1024
    ds_read_b128 v[60:63], v18 offset:20480
    v_mfma_f32_16x16x32_bf16 v[40:43], v[36:39], v[88:91], v[40:43]
    s_waitcnt lgkmcnt(10)
    v_mfma_f32_32x32x16_bf16 v[144:159], v[164:167], v[32:35], v[144:159]
    v_add_u32 v25, 4294950912, v25
    ds_read_b64_tr_b16 v[68:69], v25 offset:0
    ds_read_b64_tr_b16 v[70:71], v25 offset:1024
    v_mfma_f32_32x32x16_bf16 v[128:143], v[164:167], v[28:31], v[128:143]
    v_mfma_f32_16x16x32_bf16 v[44:47], v[164:167], v[88:91], v[44:47]
    s_waitcnt lgkmcnt(9)
    v_mfma_f32_32x32x16_bf16 v[96:111], v[80:83], v[72:75], v[96:111]
    ds_read_b32 v13, v48
    ds_read_b128 v[28:31], v19 offset:16384
    v_add_u32 v26, 4294950912, v26
    ds_read_b64_tr_b16 v[36:37], v26 offset:0
    s_waitcnt lgkmcnt(11)
    v_mfma_f32_32x32x16_bf16 v[112:127], v[80:83], v[76:79], v[112:127]
    ds_read_b64_tr_b16 v[38:39], v26 offset:1024
    ds_read_b128 v[32:35], v19 offset:20480
    v_mfma_f32_16x16x32_bf16 v[40:43], v[80:83], v[88:91], v[40:43]
    s_waitcnt lgkmcnt(11)
    v_mfma_f32_32x32x16_bf16 v[144:159], v[84:87], v[76:79], v[144:159]
    v_add_u32 v27, 4294950912, v27
    ds_read_b64_tr_b16 v[164:165], v27 offset:0
    ds_read_b64_tr_b16 v[166:167], v27 offset:1024
    v_mfma_f32_32x32x16_bf16 v[128:143], v[84:87], v[72:75], v[128:143]
    v_mfma_f32_16x16x32_bf16 v[44:47], v[84:87], v[88:91], v[44:47]
    s_waitcnt lgkmcnt(10)
    v_mfma_f32_32x32x16_bf16 v[96:111], v[64:67], v[56:59], v[96:111]
    s_waitcnt lgkmcnt(0)
    v_mov_b32 v1, 16
    ds_write_b32 v50, v1
    v_cmp_gt_u32 vcc, 14, v13
    s_cbranch_vccz L_f_hk13
L_f_hl13:
    ds_read_b32 v13, v48
    s_waitcnt lgkmcnt(0)
    v_cmp_gt_u32 vcc, 14, v13
    s_cbranch_vccnz L_f_hl13
L_f_hk13:
    ds_read_b128 v[72:75], v16 offset:32768
    ds_read_b64_tr_b16 v[80:81], v20 offset:49152
    v_mfma_f32_32x32x16_bf16 v[112:127], v[64:67], v[60:63], v[112:127]
    ds_read_b64_tr_b16 v[82:83], v20 offset:50176
    ds_read_b128 v[76:79], v16 offset:36864
    v_mfma_f32_32x32x16_bf16 v[144:159], v[68:71], v[60:63], v[144:159]
    ds_read_b64_tr_b16 v[84:85], v21 offset:49152
    ds_read_b64_tr_b16 v[86:87], v21 offset:50176
    v_mfma_f32_32x32x16_bf16 v[128:143], v[68:71], v[56:59], v[128:143]
    v_mfma_f32_32x32x16_bf16 v[96:111], v[36:39], v[28:31], v[96:111]
    ds_read_b128 v[56:59], v17 offset:32768
    ds_read_b64_tr_b16 v[64:65], v22 offset:49152
    v_mfma_f32_32x32x16_bf16 v[112:127], v[36:39], v[32:35], v[112:127]
    ds_read_b64_tr_b16 v[66:67], v22 offset:50176
    ds_read_b128 v[60:63], v17 offset:36864
    v_mfma_f32_32x32x16_bf16 v[144:159], v[164:167], v[32:35], v[144:159]
    ds_read_b64_tr_b16 v[68:69], v23 offset:49152
    ds_read_b64_tr_b16 v[70:71], v23 offset:50176
    v_mfma_f32_32x32x16_bf16 v[128:143], v[164:167], v[28:31], v[128:143]
    s_waitcnt lgkmcnt(9)
    v_mfma_f32_32x32x16_bf16 v[96:111], v[80:83], v[72:75], v[96:111]
    ds_read_b128 v[28:31], v18 offset:32768
    ds_read_b64_tr_b16 v[36:37], v24 offset:49152
    s_waitcnt lgkmcnt(10)
    v_mfma_f32_32x32x16_bf16 v[112:127], v[80:83], v[76:79], v[112:127]
    ds_read_b64_tr_b16 v[38:39], v24 offset:50176
    ds_read_b128 v[32:35], v18 offset:36864
    v_mfma_f32_16x16x32_bf16 v[40:43], v[80:83], v[88:91], v[40:43]
    s_waitcnt lgkmcnt(10)
    v_mfma_f32_32x32x16_bf16 v[144:159], v[84:87], v[76:79], v[144:159]
    ds_read_b64_tr_b16 v[164:165], v25 offset:49152
    ds_read_b64_tr_b16 v[166:167], v25 offset:50176
    v_mfma_f32_32x32x16_bf16 v[128:143], v[84:87], v[72:75], v[128:143]
    v_mfma_f32_16x16x32_bf16 v[44:47], v[84:87], v[88:91], v[44:47]
    s_waitcnt lgkmcnt(9)
    v_mfma_f32_32x32x16_bf16 v[96:111], v[64:67], v[56:59], v[96:111]
    ds_read_b128 v[72:75], v19 offset:32768
    ds_read_b64_tr_b16 v[80:81], v26 offset:49152
    s_waitcnt lgkmcnt(10)
    v_mfma_f32_32x32x16_bf16 v[112:127], v[64:67], v[60:63], v[112:127]
    ds_read_b64_tr_b16 v[82:83], v26 offset:50176
    ds_read_b128 v[76:79], v19 offset:36864
    v_mfma_f32_16x16x32_bf16 v[40:43], v[64:67], v[88:91], v[40:43]
    s_waitcnt lgkmcnt(10)
    v_mfma_f32_32x32x16_bf16 v[144:159], v[68:71], v[60:63], v[144:159]
    ds_read_b64_tr_b16 v[84:85], v27 offset:49152
    ds_read_b64_tr_b16 v[86:87], v27 offset:50176
    v_mfma_f32_32x32x16_bf16 v[128:143], v[68:71], v[56:59], v[128:143]
    v_mfma_f32_16x16x32_bf16 v[44:47], v[68:71], v[88:91], v[44:47]
    s_waitcnt lgkmcnt(9)
    v_mfma_f32_32x32x16_bf16 v[96:111], v[36:39], v[28:31], v[96:111]
    ds_write_b128 v7, v[40:43]
    s_nop 4
    ds_write_b128 v7, v[44:47] offset:1024
    s_waitcnt lgkmcnt(10)
    v_mfma_f32_32x32x16_bf16 v[112:127], v[36:39], v[32:35], v[112:127]
    s_waitcnt lgkmcnt(0)
    ds_write_b32 v50, v49 offset:32
L_f_hc:
    ds_read_b32 v13, v51 offset:32
    s_waitcnt lgkmcnt(0)
    v_cmp_eq_u32 vcc, 0, v13
    s_cbranch_vccnz L_f_hc
    ds_read_b32 v10, v8
    ds_read_b32 v11, v8 offset:1024
    v_mfma_f32_32x32x16_bf16 v[144:159], v[164:167], v[32:35], v[144:159]
    v_mfma_f32_32x32x16_bf16 v[128:143], v[164:167], v[28:31], v[128:143]
    v_mfma_f32_32x32x16_bf16 v[96:111], v[80:83], v[72:75], v[96:111]
    s_waitcnt lgkmcnt(0)
    v_cvt_pk_bf16_f32 v58, 0, v10
    v_cvt_pk_bf16_f32 v62, 0, v11
    v_cvt_pk_bf16_f32 v64, -v160, -v160
    v_cvt_pk_bf16_f32 v66, -v161, -v161
    v_sub_f32 v58, v10, v58
    v_mfma_f32_32x32x16_bf16 v[112:127], v[80:83], v[76:79], v[112:127]
    v_sub_f32 v62, v11, v62
    v_cvt_pk_bf16_f32 v65, -v160, 0
    v_cvt_pk_bf16_f32 v67, -v161, 0
    v_cvt_pk_bf16_f32 v59, 0, v58
    v_cvt_pk_bf16_f32 v63, 0, v62
    v_mfma_f32_32x32x16_bf16 v[144:159], v[84:87], v[76:79], v[144:159]
    v_cvt_pk_bf16_f32 v56, v10, v58
    v_cvt_pk_bf16_f32 v60, v11, v62
    v_sub_f32 v59, v58, v59
    v_sub_f32 v63, v62, v63
    v_cvt_pk_bf16_f32 v57, v59, 0
    v_cvt_pk_bf16_f32 v61, v63, 0
    v_mfma_f32_32x32x16_bf16 v[128:143], v[84:87], v[72:75], v[128:143]
    v_mfma_f32_32x32x8_bf16 v[96:111], v[56:57], v[64:65], v[96:111]
    v_mfma_f32_32x32x8_bf16 v[112:127], v[56:57], v[66:67], v[112:127]
    v_mfma_f32_32x32x8_bf16 v[144:159], v[60:61], v[66:67], v[144:159]
    v_mfma_f32_32x32x8_bf16 v[128:143], v[60:61], v[64:65], v[128:143]
    s_cmp_eq_u32 s9, 3
    s_nop 7
    s_cbranch_scc1 L_f_hd
    v_mov_b32 v164, v163
    s_nop 5
    v_pk_mul_f32 v[96:97], v[96:97], v[162:163] op_sel_hi:[1,0]
    v_pk_mul_f32 v[98:99], v[98:99], v[162:163] op_sel_hi:[1,0]
    v_pk_mul_f32 v[100:101], v[100:101], v[162:163] op_sel_hi:[1,0]
    v_pk_mul_f32 v[102:103], v[102:103], v[162:163] op_sel_hi:[1,0]
    v_pk_mul_f32 v[104:105], v[104:105], v[162:163] op_sel_hi:[1,0]
    v_pk_mul_f32 v[106:107], v[106:107], v[162:163] op_sel_hi:[1,0]
    v_pk_mul_f32 v[108:109], v[108:109], v[162:163] op_sel_hi:[1,0]
    v_pk_mul_f32 v[110:111], v[110:111], v[162:163] op_sel_hi:[1,0]
    v_cvt_pk_bf16_f32 v111, v110, v111
    v_cvt_pk_bf16_f32 v110, v108, v109
    v_cvt_pk_bf16_f32 v109, v106, v107
    v_cvt_pk_bf16_f32 v108, v104, v105
    v_cvt_pk_bf16_f32 v107, v102, v103
    v_cvt_pk_bf16_f32 v106, v100, v101
    v_cvt_pk_bf16_f32 v105, v98, v99
    v_cvt_pk_bf16_f32 v104, v96, v97
    v_pk_max_i16 v104, v104, 0
    v_pk_max_i16 v105, v105, 0
    v_pk_max_i16 v106, v106, 0
    v_pk_max_i16 v107, v107, 0
    v_pk_max_i16 v108, v108, 0
    v_pk_max_i16 v109, v109, 0
    v_pk_max_i16 v110, v110, 0
    v_pk_max_i16 v111, v111, 0
    v_pk_mul_f32 v[112:113], v[112:113], v[164:165] op_sel_hi:[1,0]
    v_pk_mul_f32 v[114:115], v[114:115], v[164:165] op_sel_hi:[1,0]
    v_pk_mul_f32 v[116:117], v[116:117], v[164:165] op_sel_hi:[1,0]
    v_pk_mul_f32 v[118:119], v[118:119], v[164:165] op_sel_hi:[1,0]
    v_pk_mul_f32 v[120:121], v[120:121], v[164:165] op_sel_hi:[1,0]
    v_pk_mul_f32 v[122:123], v[122:123], v[164:165] op_sel_hi:[1,0]
    v_pk_mul_f32 v[124:125], v[124:125], v[164:165] op_sel_hi:[1,0]
    v_pk_mul_f32 v[126:127], v[126:127], v[164:165] op_sel_hi:[1,0]
    v_cvt_pk_bf16_f32 v112, v112, v113
    v_cvt_pk_bf16_f32 v113, v114, v115
    v_cvt_pk_bf16_f32 v114, v116, v117
    v_cvt_pk_bf16_f32 v115, v118, v119
    v_cvt_pk_bf16_f32 v116, v120, v121
    v_cvt_pk_bf16_f32 v117, v122, v123
    v_cvt_pk_bf16_f32 v118, v124, v125
    v_cvt_pk_bf16_f32 v119, v126, v127
    v_pk_max_i16 v112, v112, 0
    v_pk_max_i16 v113, v113, 0
    v_pk_max_i16 v114, v114, 0
    v_pk_max_i16 v115, v115, 0
    v_pk_max_i16 v116, v116, 0
    v_pk_max_i16 v117, v117, 0
    v_pk_max_i16 v118, v118, 0
    v_pk_max_i16 v119, v119, 0
    v_pk_mul_f32 v[144:145], v[144:145], v[164:165] op_sel_hi:[1,0]
    v_pk_mul_f32 v[146:147], v[146:147], v[164:165] op_sel_hi:[1,0]
    v_pk_mul_f32 v[148:149], v[148:149], v[164:165] op_sel_hi:[1,0]
    v_pk_mul_f32 v[150:151], v[150:151], v[164:165] op_sel_hi:[1,0]
    v_pk_mul_f32 v[152:153], v[152:153], v[164:165] op_sel_hi:[1,0]
    v_pk_mul_f32 v[154:155], v[154:155], v[164:165] op_sel_hi:[1,0]
    v_pk_mul_f32 v[156:157], v[156:157], v[164:165] op_sel_hi:[1,0]
    v_pk_mul_f32 v[158:159], v[158:159], v[164:165] op_sel_hi:[1,0]
    v_cvt_pk_bf16_f32 v144, v144, v145
    v_cvt_pk_bf16_f32 v145, v146, v147
    v_cvt_pk_bf16_f32 v146, v148, v149
    v_cvt_pk_bf16_f32 v147, v150, v151
    v_cvt_pk_bf16_f32 v148, v152, v153
    v_cvt_pk_bf16_f32 v149, v154, v155
    v_cvt_pk_bf16_f32 v150, v156, v157
    v_cvt_pk_bf16_f32 v151, v158, v159
    v_pk_max_i16 v144, v144, 0
    v_pk_max_i16 v145, v145, 0
    v_pk_max_i16 v146, v146, 0
    v_pk_max_i16 v147, v147, 0
    v_pk_max_i16 v148, v148, 0
    v_pk_max_i16 v149, v149, 0
    v_pk_max_i16 v150, v150, 0
    v_pk_max_i16 v151, v151, 0
    v_pk_mul_f32 v[128:129], v[128:129], v[162:163] op_sel_hi:[1,0]
    v_pk_mul_f32 v[130:131], v[130:131], v[162:163] op_sel_hi:[1,0]
    v_pk_mul_f32 v[132:133], v[132:133], v[162:163] op_sel_hi:[1,0]
    v_pk_mul_f32 v[134:135], v[134:135], v[162:163] op_sel_hi:[1,0]
    v_pk_mul_f32 v[136:137], v[136:137], v[162:163] op_sel_hi:[1,0]
    v_pk_mul_f32 v[138:139], v[138:139], v[162:163] op_sel_hi:[1,0]
    v_pk_mul_f32 v[140:141], v[140:141], v[162:163] op_sel_hi:[1,0]
    v_pk_mul_f32 v[142:143], v[142:143], v[162:163] op_sel_hi:[1,0]
    v_cvt_pk_bf16_f32 v152, v128, v129
    v_cvt_pk_bf16_f32 v153, v130, v131
    v_cvt_pk_bf16_f32 v154, v132, v133
    v_cvt_pk_bf16_f32 v155, v134, v135
    v_cvt_pk_bf16_f32 v156, v136, v137
    v_cvt_pk_bf16_f32 v157, v138, v139
    v_cvt_pk_bf16_f32 v158, v140, v141
    v_cvt_pk_bf16_f32 v159, v142, v143
    v_pk_max_i16 v152, v152, 0
    v_pk_max_i16 v153, v153, 0
    v_pk_max_i16 v154, v154, 0
    v_pk_max_i16 v155, v155, 0
    v_pk_max_i16 v156, v156, 0
    v_pk_max_i16 v157, v157, 0
    v_pk_max_i16 v158, v158, 0
    v_pk_max_i16 v159, v159, 0
L_f_hd:
    v_and_b32 v121, 3, v2
    v_lshlrev_b32 v121, 2, v121
    s_lshl_b32 s26, s29, 2
    s_add_u32 s26, s26, 64
    v_mov_b32 v122, s26
    v_mul_u32_u24 v7, 320, v3
    v_lshl_add_u32 v7, v4, 4, v7
    v_add_u32 v7, 5120, v7
    v_lshlrev_b32 v6, 4, v4
    v_mov_b32 v1, 0x3f803f80
    v_cmp_eq_u32 vcc, 20, v4
    v_mov_b32 v56, 0
    s_nop 0
    v_cndmask_b32 v24, 0, v1, vcc
    v_cndmask_b32 v25, 0, v1, vcc
    v_cndmask_b32 v26, 0, v1, vcc
    v_cndmask_b32 v27, 0, v1, vcc
    v_cndmask_b32 v28, 0, v1, vcc
    v_cndmask_b32 v29, 0, v1, vcc
    v_cndmask_b32 v30, 0, v1, vcc
    v_cndmask_b32 v31, 0, v1, vcc
    s_cmp_eq_u32 s68, 0
    s_cbranch_scc1 L_f_at2
L_f_hw0:
    ds_read_b32 v57, v56 offset:224
    s_waitcnt lgkmcnt(0)
    v_readfirstlane_b32 s30, v57
    s_and_b32 s30, s30, s68
    s_cbranch_scc1 L_f_hw1
    s_sleep 1
    s_branch L_f_hw0
L_f_hw1:
    buffer_load_dwordx4 v[52:55], v5, s[44:47], s20 offen sc1
    buffer_load_dwordx2 v[14:15], v6, s[44:47], s18 offen sc1
    buffer_load_dwordx4 v[92:95], v5, s[44:47], s21 offen sc1
    s_branch L_f_at2
L_f_vloop:
    v_and_b32 v1, 19, v2
    v_bfe_u32 v6, v2, 2, 1
    v_lshl_add_u32 v1, v6, 3, v1
    v_bfe_u32 v6, v2, 3, 1
    v_lshl_add_u32 v1, v6, 2, v1
    v_mul_u32_u24 v6, 10368, v3
    v_lshl_add_u32 v51, v1, 4, v6
    s_barrier
    ds_read_b128 v[72:75], v16 offset:0
    ds_read_b64_tr_b16 v[80:81], v20 offset:0
    ds_read_b64_tr_b16 v[82:83], v20 offset:1024
    ds_read_b128 v[76:79], v16 offset:4096
    ds_read_b64_tr_b16 v[84:85], v21 offset:0
    ds_read_b64_tr_b16 v[86:87], v21 offset:1024
    ds_read_b128 v[56:59], v17 offset:0
    ds_read_b64_tr_b16 v[64:65], v22 offset:0
    ds_read_b64_tr_b16 v[66:67], v22 offset:1024
    ds_read_b128 v[60:63], v17 offset:4096
    ds_read_b64_tr_b16 v[68:69], v23 offset:0
    ds_read_b64_tr_b16 v[70:71], v23 offset:1024
    s_waitcnt lgkmcnt(9)
    v_mfma_f32_32x32x16_bf16 v[96:111], v[72:75], v[80:83], 0
    ds_read_b128 v[28:31], v18 offset:0
    ds_read_b64_tr_b16 v[36:37], v24 offset:0
    s_waitcnt lgkmcnt(10)
    v_mfma_f32_32x32x16_bf16 v[112:127], v[76:79], v[80:83], 0
    ds_read_b64_tr_b16 v[38:39], v24 offset:1024
    ds_read_b128 v[32:35], v18 offset:4096
    v_mfma_f32_16x16x32_bf16 v[40:43], v[80:83], v[88:91], 0
    s_waitcnt lgkmcnt(10)
    v_mfma_f32_32x32x16_bf16 v[144:159], v[76:79], v[84:87], 0
    ds_read_b64_tr_b16 v[164:165], v25 offset:0
    ds_read_b64_tr_b16 v[166:167], v25 offset:1024
    v_mfma_f32_32x32x16_bf16 v[128:143], v[72:75], v[84:87], 0
    v_mfma_f32_16x16x32_bf16 v[44:47], v[84:87], v[88:91], 0
    s_waitcnt lgkmcnt(9)
    v_mfma_f32_32x32x16_bf16 v[96:111], v[56:59], v[64:67], v[96:111]
    ds_read_b128 v[72:75], v19 offset:0
    ds_read_b64_tr_b16 v[80:81], v26 offset:0
    s_waitcnt lgkmcnt(10)
    v_mfma_f32_32x32x16_bf16 v[112:127], v[60:63], v[64:67], v[112:127]
    ds_read_b64_tr_b16 v[82:83], v26 offset:1024
    ds_read_b128 v[76:79], v19 offset:4096
    v_mfma_f32_16x16x32_bf16 v[40:43], v[64:67], v[88:91], v[40:43]
    s_waitcnt lgkmcnt(10)
    v_mfma_f32_32x32x16_bf16 v[144:159], v[60:63], v[68:71], v[144:159]
    ds_read_b64_tr_b16 v[84:85], v27 offset:0
    ds_read_b64_tr_b16 v[86:87], v27 offset:1024
    v_mfma_f32_32x32x16_bf16 v[128:143], v[56:59], v[68:71], v[128:143]
    v_mfma_f32_16x16x32_bf16 v[44:47], v[68:71], v[88:91], v[44:47]
    s_waitcnt lgkmcnt(9)
    v_mfma_f32_32x32x16_bf16 v[96:111], v[28:31], v[36:39], v[96:111]
    s_waitcnt lgkmcnt(0)
    s_barrier
    ds_read_b128 v[56:59], v16 offset:16384
    ds_read_b64_tr_b16 v[64:65], v20 offset:32768
    v_mfma_f32_32x32x16_bf16 v[112:127], v[32:35], v[36:39], v[112:127]
    ds_read_b64_tr_b16 v[66:67], v20 offset:33792
    ds_read_b128 v[60:63], v16 offset:20480
    v_mfma_f32_32x32x16_bf16 v[144:159], v[32:35], v[164:167], v[144:159]
    ds_read_b64_tr_b16 v[68:69], v21 offset:32768
    ds_read_b64_tr_b16 v[70:71], v21 offset:33792
    v_mfma_f32_32x32x16_bf16 v[128:143], v[28:31], v[164:167], v[128:143]
    v_mfma_f32_32x32x16_bf16 v[96:111], v[72:75], v[80:83], v[96:111]
    ds_read_b128 v[28:31], v17 offset:16384
    ds_read_b64_tr_b16 v[36:37], v22 offset:32768
    v_mfma_f32_32x32x16_bf16 v[112:127], v[76:79], v[80:83], v[112:127]
    ds_read_b64_tr_b16 v[38:39], v22 offset:33792
    ds_read_b128 v[32:35], v17 offset:20480
    v_mfma_f32_32x32x16_bf16 v[144:159], v[76:79], v[84:87], v[144:159]
    ds_read_b64_tr_b16 v[164:165], v23 offset:32768
    ds_read_b64_tr_b16 v[166:167], v23 offset:33792
    v_mfma_f32_32x32x16_bf16 v[128:143], v[72:75], v[84:87], v[128:143]
    s_waitcnt lgkmcnt(9)
    v_mfma_f32_32x32x16_bf16 v[96:111], v[56:59], v[64:67], v[96:111]
    ds_read_b128 v[72:75], v18 offset:16384
    ds_read_b64_tr_b16 v[80:81], v24 offset:32768
    s_waitcnt lgkmcnt(10)
    v_mfma_f32_32x32x16_bf16 v[112:127], v[60:63], v[64:67], v[112:127]
    ds_read_b64_tr_b16 v[82:83], v24 offset:33792
    ds_read_b128 v[76:79], v18 offset:20480
    v_mfma_f32_16x16x32_bf16 v[40:43], v[64:67], v[88:91], v[40:43]
    s_waitcnt lgkmcnt(10)
    v_mfma_f32_32x32x16_bf16 v[144:159], v[60:63], v[68:71], v[144:159]
    ds_read_b64_tr_b16 v[84:85], v25 offset:32768
    ds_read_b64_tr_b16 v[86:87], v25 offset:33792
    v_mfma_f32_32x32x16_bf16 v[128:143], v[56:59], v[68:71], v[128:143]
    v_mfma_f32_16x16x32_bf16 v[44:47], v[68:71], v[88:91], v[44:47]
    s_waitcnt lgkmcnt(9)
    v_mfma_f32_32x32x16_bf16 v[96:111], v[28:31], v[36:39], v[96:111]
    ds_read_b128 v[56:59], v19 offset:16384
    ds_read_b64_tr_b16 v[64:65], v26 offset:32768
    s_waitcnt lgkmcnt(10)
    v_mfma_f32_32x32x16_bf16 v[112:127], v[32:35], v[36:39], v[112:127]
    ds_read_b64_tr_b16 v[66:67], v26 offset:33792
    ds_read_b128 v[60:63], v19 offset:20480
    v_mfma_f32_16x16x32_bf16 v[40:43], v[36:39], v[88:91], v[40:43]
    s_waitcnt lgkmcnt(10)
    v_mfma_f32_32x32x16_bf16 v[144:159], v[32:35], v[164:167], v[144:159]
    ds_read_b64_tr_b16 v[68:69], v27 offset:32768
    ds_read_b64_tr_b16 v[70:71], v27 offset:33792
    v_mfma_f32_32x32x16_bf16 v[128:143], v[28:31], v[164:167], v[128:143]
    v_mfma_f32_16x16x32_bf16 v[44:47], v[164:167], v[88:91], v[44:47]
    s_waitcnt lgkmcnt(9)
    v_mfma_f32_32x32x16_bf16 v[96:111], v[72:75], v[80:83], v[96:111]
    s_waitcnt lgkmcnt(0)
    s_barrier
    ds_read_b128 v[28:31], v16 offset:32768
    v_add_u32 v20, 65536, v20
    ds_read_b64_tr_b16 v[36:37], v20 offset:49152
    v_mfma_f32_32x32x16_bf16 v[112:127], v[76:79], v[80:83], v[112:127]
    ds_read_b64_tr_b16 v[38:39], v20 offset:50176
    ds_read_b128 v[32:35], v16 offset:36864
    v_mfma_f32_32x32x16_bf16 v[144:159], v[76:79], v[84:87], v[144:159]
    v_add_u32 v21, 65536, v21
    ds_read_b64_tr_b16 v[164:165], v21 offset:49152
    ds_read_b64_tr_b16 v[166:167], v21 offset:50176
    v_mfma_f32_32x32x16_bf16 v[128:143], v[72:75], v[84:87], v[128:143]
    v_mfma_f32_32x32x16_bf16 v[96:111], v[56:59], v[64:67], v[96:111]
    ds_read_b128 v[72:75], v17 offset:32768
    v_add_u32 v22, 65536, v22
    ds_read_b64_tr_b16 v[80:81], v22 offset:49152
    v_mfma_f32_32x32x16_bf16 v[112:127], v[60:63], v[64:67], v[112:127]
    ds_read_b64_tr_b16 v[82:83], v22 offset:50176
    ds_read_b128 v[76:79], v17 offset:36864
    v_mfma_f32_32x32x16_bf16 v[144:159], v[60:63], v[68:71], v[144:159]
    v_add_u32 v23, 65536, v23
    ds_read_b64_tr_b16 v[84:85], v23 offset:49152
    ds_read_b64_tr_b16 v[86:87], v23 offset:50176
    v_mfma_f32_32x32x16_bf16 v[128:143], v[56:59], v[68:71], v[128:143]
    s_waitcnt lgkmcnt(9)
    v_mfma_f32_32x32x16_bf16 v[96:111], v[28:31], v[36:39], v[96:111]
    ds_read_b128 v[56:59], v18 offset:32768
    v_add_u32 v24, 65536, v24
    ds_read_b64_tr_b16 v[64:65], v24 offset:49152
    s_waitcnt lgkmcnt(10)
    v_mfma_f32_32x32x16_bf16 v[112:127], v[32:35], v[36:39], v[112:127]
    ds_read_b64_tr_b16 v[66:67], v24 offset:50176
    ds_read_b128 v[60:63], v18 offset:36864
    v_mfma_f32_16x16x32_bf16 v[40:43], v[36:39], v[88:91], v[40:43]
    s_waitcnt lgkmcnt(10)
    v_mfma_f32_32x32x16_bf16 v[144:159], v[32:35], v[164:167], v[144:159]
    v_add_u32 v25, 65536, v25
    ds_read_b64_tr_b16 v[68:69], v25 offset:49152
    ds_read_b64_tr_b16 v[70:71], v25 offset:50176
    v_mfma_f32_32x32x16_bf16 v[128:143], v[28:31], v[164:167], v[128:143]
    v_mfma_f32_16x16x32_bf16 v[44:47], v[164:167], v[88:91], v[44:47]
    s_waitcnt lgkmcnt(9)
    v_mfma_f32_32x32x16_bf16 v[96:111], v[72:75], v[80:83], v[96:111]
    ds_read_b128 v[28:31], v19 offset:32768
    v_add_u32 v26, 65536, v26
    ds_read_b64_tr_b16 v[36:37], v26 offset:49152
    s_waitcnt lgkmcnt(10)
    v_mfma_f32_32x32x16_bf16 v[112:127], v[76:79], v[80:83], v[112:127]
    ds_read_b64_tr_b16 v[38:39], v26 offset:50176
    ds_read_b128 v[32:35], v19 offset:36864
    v_mfma_f32_16x16x32_bf16 v[40:43], v[80:83], v[88:91], v[40:43]
    s_waitcnt lgkmcnt(10)
    v_mfma_f32_32x32x16_bf16 v[144:159], v[76:79], v[84:87], v[144:159]
    v_add_u32 v27, 65536, v27
    ds_read_b64_tr_b16 v[164:165], v27 offset:49152
    ds_read_b64_tr_b16 v[166:167], v27 offset:50176
    v_mfma_f32_32x32x16_bf16 v[128:143], v[72:75], v[84:87], v[128:143]
    v_mfma_f32_16x16x32_bf16 v[44:47], v[84:87], v[88:91], v[44:47]
    s_waitcnt lgkmcnt(9)
    v_mfma_f32_32x32x16_bf16 v[96:111], v[56:59], v[64:67], v[96:111]
    s_waitcnt lgkmcnt(0)
    s_barrier
    ds_read_b128 v[72:75], v16 offset:0
    v_add_u32 v20, 4294901760, v20
    ds_read_b64_tr_b16 v[80:81], v20 offset:0
    v_mfma_f32_32x32x16_bf16 v[112:127], v[60:63], v[64:67], v[112:127]
    ds_read_b64_tr_b16 v[82:83], v20 offset:1024
    ds_read_b128 v[76:79], v16 offset:4096
    v_mfma_f32_32x32x16_bf16 v[144:159], v[60:63], v[68:71], v[144:159]
    v_add_u32 v21, 4294901760, v21
    ds_read_b64_tr_b16 v[84:85], v21 offset:0
    ds_read_b64_tr_b16 v[86:87], v21 offset:1024
    v_mfma_f32_32x32x16_bf16 v[128:143], v[56:59], v[68:71], v[128:143]
    v_mfma_f32_32x32x16_bf16 v[96:111], v[28:31], v[36:39], v[96:111]
    ds_read_b128 v[56:59], v17 offset:0
    v_add_u32 v22, 4294901760, v22
    ds_read_b64_tr_b16 v[64:65], v22 offset:0
    v_mfma_f32_32x32x16_bf16 v[112:127], v[32:35], v[36:39], v[112:127]
    ds_read_b64_tr_b16 v[66:67], v22 offset:1024
    ds_read_b128 v[60:63], v17 offset:4096
    v_mfma_f32_32x32x16_bf16 v[144:159], v[32:35], v[164:167], v[144:159]
    v_add_u32 v23, 4294901760, v23
    ds_read_b64_tr_b16 v[68:69], v23 offset:0
    ds_read_b64_tr_b16 v[70:71], v23 offset:1024
    v_mfma_f32_32x32x16_bf16 v[128:143], v[28:31], v[164:167], v[128:143]
    s_waitcnt lgkmcnt(9)
    v_mfma_f32_32x32x16_bf16 v[96:111], v[72:75], v[80:83], v[96:111]
    ds_read_b128 v[28:31], v18 offset:0
    v_add_u32 v24, 4294901760, v24
    ds_read_b64_tr_b16 v[36:37], v24 offset:0
    s_waitcnt lgkmcnt(10)
    v_mfma_f32_32x32x16_bf16 v[112:127], v[76:79], v[80:83], v[112:127]
    ds_read_b64_tr_b16 v[38:39], v24 offset:1024
    ds_read_b128 v[32:35], v18 offset:4096
    v_mfma_f32_16x16x32_bf16 v[40:43], v[80:83], v[88:91], v[40:43]
    s_waitcnt lgkmcnt(10)
    v_mfma_f32_32x32x16_bf16 v[144:159], v[76:79], v[84:87], v[144:159]
    v_add_u32 v25, 4294901760, v25
    ds_read_b64_tr_b16 v[164:165], v25 offset:0
    ds_read_b64_tr_b16 v[166:167], v25 offset:1024
    v_mfma_f32_32x32x16_bf16 v[128:143], v[72:75], v[84:87], v[128:143]
    v_mfma_f32_16x16x32_bf16 v[44:47], v[84:87], v[88:91], v[44:47]
    s_waitcnt lgkmcnt(9)
    v_mfma_f32_32x32x16_bf16 v[96:111], v[56:59], v[64:67], v[96:111]
    ds_read_b128 v[72:75], v19 offset:0
    v_add_u32 v26, 4294901760, v26
    ds_read_b64_tr_b16 v[80:81], v26 offset:0
    s_waitcnt lgkmcnt(10)
    v_mfma_f32_32x32x16_bf16 v[112:127], v[60:63], v[64:67], v[112:127]
    ds_read_b64_tr_b16 v[82:83], v26 offset:1024
    ds_read_b128 v[76:79], v19 offset:4096
    v_mfma_f32_16x16x32_bf16 v[40:43], v[64:67], v[88:91], v[40:43]
    s_waitcnt lgkmcnt(10)
    v_mfma_f32_32x32x16_bf16 v[144:159], v[60:63], v[68:71], v[144:159]
    v_add_u32 v27, 4294901760, v27
    ds_read_b64_tr_b16 v[84:85], v27 offset:0
    ds_read_b64_tr_b16 v[86:87], v27 offset:1024
    v_mfma_f32_32x32x16_bf16 v[128:143], v[56:59], v[68:71], v[128:143]
    v_mfma_f32_16x16x32_bf16 v[44:47], v[68:71], v[88:91], v[44:47]
    s_waitcnt lgkmcnt(9)
    v_mfma_f32_32x32x16_bf16 v[96:111], v[28:31], v[36:39], v[96:111]
    s_waitcnt lgkmcnt(0)
    s_barrier
    ds_read_b128 v[56:59], v16 offset:16384
    ds_read_b64_tr_b16 v[64:65], v20 offset:32768
    v_mfma_f32_32x32x16_bf16 v[112:127], v[32:35], v[36:39], v[112:127]
    ds_read_b64_tr_b16 v[66:67], v20 offset:33792
    ds_read_b128 v[60:63], v16 offset:20480
    v_mfma_f32_32x32x16_bf16 v[144:159], v[32:35], v[164:167], v[144:159]
    ds_read_b64_tr_b16 v[68:69], v21 offset:32768
    ds_read_b64_tr_b16 v[70:71], v21 offset:33792
    v_mfma_f32_32x32x16_bf16 v[128:143], v[28:31], v[164:167], v[128:143]
    v_mfma_f32_32x32x16_bf16 v[96:111], v[72:75], v[80:83], v[96:111]
    ds_read_b128 v[28:31], v17 offset:16384
    ds_read_b64_tr_b16 v[36:37], v22 offset:32768
    v_mfma_f32_32x32x16_bf16 v[112:127], v[76:79], v[80:83], v[112:127]
    ds_read_b64_tr_b16 v[38:39], v22 offset:33792
    ds_read_b128 v[32:35], v17 offset:20480
    v_mfma_f32_32x32x16_bf16 v[144:159], v[76:79], v[84:87], v[144:159]
    ds_read_b64_tr_b16 v[164:165], v23 offset:32768
    ds_read_b64_tr_b16 v[166:167], v23 offset:33792
    v_mfma_f32_32x32x16_bf16 v[128:143], v[72:75], v[84:87], v[128:143]
    s_waitcnt lgkmcnt(9)
    v_mfma_f32_32x32x16_bf16 v[96:111], v[56:59], v[64:67], v[96:111]
    ds_read_b128 v[72:75], v18 offset:16384
    ds_read_b64_tr_b16 v[80:81], v24 offset:32768
    s_waitcnt lgkmcnt(10)
    v_mfma_f32_32x32x16_bf16 v[112:127], v[60:63], v[64:67], v[112:127]
    ds_read_b64_tr_b16 v[82:83], v24 offset:33792
    ds_read_b128 v[76:79], v18 offset:20480
    v_mfma_f32_16x16x32_bf16 v[40:43], v[64:67], v[88:91], v[40:43]
    s_waitcnt lgkmcnt(10)
    v_mfma_f32_32x32x16_bf16 v[144:159], v[60:63], v[68:71], v[144:159]
    ds_read_b64_tr_b16 v[84:85], v25 offset:32768
    ds_read_b64_tr_b16 v[86:87], v25 offset:33792
    v_mfma_f32_32x32x16_bf16 v[128:143], v[56:59], v[68:71], v[128:143]
    v_mfma_f32_16x16x32_bf16 v[44:47], v[68:71], v[88:91], v[44:47]
    s_waitcnt lgkmcnt(9)
    v_mfma_f32_32x32x16_bf16 v[96:111], v[28:31], v[36:39], v[96:111]
    ds_read_b128 v[56:59], v19 offset:16384
    ds_read_b64_tr_b16 v[64:65], v26 offset:32768
    s_waitcnt lgkmcnt(10)
    v_mfma_f32_32x32x16_bf16 v[112:127], v[32:35], v[36:39], v[112:127]
    ds_read_b64_tr_b16 v[66:67], v26 offset:33792
    ds_read_b128 v[60:63], v19 offset:20480
    v_mfma_f32_16x16x32_bf16 v[40:43], v[36:39], v[88:91], v[40:43]
    s_waitcnt lgkmcnt(10)
    v_mfma_f32_32x32x16_bf16 v[144:159], v[32:35], v[164:167], v[144:159]
    ds_read_b64_tr_b16 v[68:69], v27 offset:32768
    ds_read_b64_tr_b16 v[70:71], v27 offset:33792
    v_mfma_f32_32x32x16_bf16 v[128:143], v[28:31], v[164:167], v[128:143]
    v_mfma_f32_16x16x32_bf16 v[44:47], v[164:167], v[88:91], v[44:47]
    s_waitcnt lgkmcnt(9)
    v_mfma_f32_32x32x16_bf16 v[96:111], v[72:75], v[80:83], v[96:111]
    s_waitcnt lgkmcnt(0)
    s_barrier
    ds_read_b128 v[28:31], v16 offset:49152
    v_add_u32 v20, 49152, v20
    ds_read_b64_tr_b16 v[36:37], v20 offset:49152
    v_mfma_f32_32x32x16_bf16 v[112:127], v[76:79], v[80:83], v[112:127]
    ds_read_b64_tr_b16 v[38:39], v20 offset:50176
    ds_read_b128 v[32:35], v16 offset:53248
    v_mfma_f32_32x32x16_bf16 v[144:159], v[76:79], v[84:87], v[144:159]
    v_add_u32 v21, 49152, v21
    ds_read_b64_tr_b16 v[164:165], v21 offset:49152
    ds_read_b64_tr_b16 v[166:167], v21 offset:50176
    v_mfma_f32_32x32x16_bf16 v[128:143], v[72:75], v[84:87], v[128:143]
    v_mfma_f32_32x32x16_bf16 v[96:111], v[56:59], v[64:67], v[96:111]
    ds_read_b128 v[72:75], v17 offset:49152
    v_add_u32 v22, 49152, v22
    ds_read_b64_tr_b16 v[80:81], v22 offset:49152
    v_mfma_f32_32x32x16_bf16 v[112:127], v[60:63], v[64:67], v[112:127]
    ds_read_b64_tr_b16 v[82:83], v22 offset:50176
    ds_read_b128 v[76:79], v17 offset:53248
    v_mfma_f32_32x32x16_bf16 v[144:159], v[60:63], v[68:71], v[144:159]
    v_add_u32 v23, 49152, v23
    ds_read_b64_tr_b16 v[84:85], v23 offset:49152
    ds_read_b64_tr_b16 v[86:87], v23 offset:50176
    v_mfma_f32_32x32x16_bf16 v[128:143], v[56:59], v[68:71], v[128:143]
    s_waitcnt lgkmcnt(9)
    v_mfma_f32_32x32x16_bf16 v[96:111], v[28:31], v[36:39], v[96:111]
    ds_read_b128 v[56:59], v18 offset:49152
    v_add_u32 v24, 49152, v24
    ds_read_b64_tr_b16 v[64:65], v24 offset:49152
    s_waitcnt lgkmcnt(10)
    v_mfma_f32_32x32x16_bf16 v[112:127], v[32:35], v[36:39], v[112:127]
    ds_read_b64_tr_b16 v[66:67], v24 offset:50176
    ds_read_b128 v[60:63], v18 offset:53248
    v_mfma_f32_16x16x32_bf16 v[40:43], v[36:39], v[88:91], v[40:43]
    s_waitcnt lgkmcnt(10)
    v_mfma_f32_32x32x16_bf16 v[144:159], v[32:35], v[164:167], v[144:159]
    v_add_u32 v25, 49152, v25
    ds_read_b64_tr_b16 v[68:69], v25 offset:49152
    ds_read_b64_tr_b16 v[70:71], v25 offset:50176
    v_mfma_f32_32x32x16_bf16 v[128:143], v[28:31], v[164:167], v[128:143]
    v_mfma_f32_16x16x32_bf16 v[44:47], v[164:167], v[88:91], v[44:47]
    s_waitcnt lgkmcnt(9)
    v_mfma_f32_32x32x16_bf16 v[96:111], v[72:75], v[80:83], v[96:111]
    ds_read_b128 v[28:31], v19 offset:49152
    v_add_u32 v26, 49152, v26
    ds_read_b64_tr_b16 v[36:37], v26 offset:49152
    s_waitcnt lgkmcnt(10)
    v_mfma_f32_32x32x16_bf16 v[112:127], v[76:79], v[80:83], v[112:127]
    ds_read_b64_tr_b16 v[38:39], v26 offset:50176
    ds_read_b128 v[32:35], v19 offset:53248
    v_mfma_f32_16x16x32_bf16 v[40:43], v[80:83], v[88:91], v[40:43]
    s_waitcnt lgkmcnt(10)
    v_mfma_f32_32x32x16_bf16 v[144:159], v[76:79], v[84:87], v[144:159]
    v_add_u32 v27, 49152, v27
    ds_read_b64_tr_b16 v[164:165], v27 offset:49152
    ds_read_b64_tr_b16 v[166:167], v27 offset:50176
    v_mfma_f32_32x32x16_bf16 v[128:143], v[72:75], v[84:87], v[128:143]
    v_mfma_f32_16x16x32_bf16 v[44:47], v[84:87], v[88:91], v[44:47]
    s_waitcnt lgkmcnt(9)
    v_mfma_f32_32x32x16_bf16 v[96:111], v[56:59], v[64:67], v[96:111]
    s_waitcnt lgkmcnt(0)
    s_barrier
    v_add_u32 v16, 16384, v16
    ds_read_b128 v[72:75], v16 offset:49152
    v_add_u32 v20, 4294918144, v20
    ds_read_b64_tr_b16 v[80:81], v20 offset:0
    v_mfma_f32_32x32x16_bf16 v[112:127], v[60:63], v[64:67], v[112:127]
    ds_read_b64_tr_b16 v[82:83], v20 offset:1024
    ds_read_b128 v[76:79], v16 offset:53248
    v_mfma_f32_32x32x16_bf16 v[144:159], v[60:63], v[68:71], v[144:159]
    v_add_u32 v21, 4294918144, v21
    ds_read_b64_tr_b16 v[84:85], v21 offset:0
    ds_read_b64_tr_b16 v[86:87], v21 offset:1024
    v_mfma_f32_32x32x16_bf16 v[128:143], v[56:59], v[68:71], v[128:143]
    v_mfma_f32_32x32x16_bf16 v[96:111], v[28:31], v[36:39], v[96:111]
    v_add_u32 v17, 16384, v17
    ds_read_b128 v[56:59], v17 offset:49152
    v_add_u32 v22, 4294918144, v22
    ds_read_b64_tr_b16 v[64:65], v22 offset:0
    v_mfma_f32_32x32x16_bf16 v[112:127], v[32:35], v[36:39], v[112:127]
    ds_read_b64_tr_b16 v[66:67], v22 offset:1024
    ds_read_b128 v[60:63], v17 offset:53248
    v_mfma_f32_32x32x16_bf16 v[144:159], v[32:35], v[164:167], v[144:159]
    v_add_u32 v23, 4294918144, v23
    ds_read_b64_tr_b16 v[68:69], v23 offset:0
    ds_read_b64_tr_b16 v[70:71], v23 offset:1024
    v_mfma_f32_32x32x16_bf16 v[128:143], v[28:31], v[164:167], v[128:143]
    s_waitcnt lgkmcnt(9)
    v_mfma_f32_32x32x16_bf16 v[96:111], v[72:75], v[80:83], v[96:111]
    v_add_u32 v18, 16384, v18
    ds_read_b128 v[28:31], v18 offset:49152
    v_add_u32 v24, 4294918144, v24
    ds_read_b64_tr_b16 v[36:37], v24 offset:0
    s_waitcnt lgkmcnt(10)
    v_mfma_f32_32x32x16_bf16 v[112:127], v[76:79], v[80:83], v[112:127]
    ds_read_b64_tr_b16 v[38:39], v24 offset:1024
    ds_read_b128 v[32:35], v18 offset:53248
    v_mfma_f32_16x16x32_bf16 v[40:43], v[80:83], v[88:91], v[40:43]
    s_waitcnt lgkmcnt(10)
    v_mfma_f32_32x32x16_bf16 v[144:159], v[76:79], v[84:87], v[144:159]
    v_add_u32 v25, 4294918144, v25
    ds_read_b64_tr_b16 v[164:165], v25 offset:0
    ds_read_b64_tr_b16 v[166:167], v25 offset:1024
    v_mfma_f32_32x32x16_bf16 v[128:143], v[72:75], v[84:87], v[128:143]
    v_mfma_f32_16x16x32_bf16 v[44:47], v[84:87], v[88:91], v[44:47]
    s_waitcnt lgkmcnt(9)
    v_mfma_f32_32x32x16_bf16 v[96:111], v[56:59], v[64:67], v[96:111]
    v_add_u32 v19, 16384, v19
    ds_read_b128 v[72:75], v19 offset:49152
    v_add_u32 v26, 4294918144, v26
    ds_read_b64_tr_b16 v[80:81], v26 offset:0
    s_waitcnt lgkmcnt(10)
    v_mfma_f32_32x32x16_bf16 v[112:127], v[60:63], v[64:67], v[112:127]
    ds_read_b64_tr_b16 v[82:83], v26 offset:1024
    ds_read_b128 v[76:79], v19 offset:53248
    v_mfma_f32_16x16x32_bf16 v[40:43], v[64:67], v[88:91], v[40:43]
    s_waitcnt lgkmcnt(10)
    v_mfma_f32_32x32x16_bf16 v[144:159], v[60:63], v[68:71], v[144:159]
    v_add_u32 v27, 4294918144, v27
    ds_read_b64_tr_b16 v[84:85], v27 offset:0
    ds_read_b64_tr_b16 v[86:87], v27 offset:1024
    v_mfma_f32_32x32x16_bf16 v[128:143], v[56:59], v[68:71], v[128:143]
    v_mfma_f32_16x16x32_bf16 v[44:47], v[68:71], v[88:91], v[44:47]
    s_waitcnt lgkmcnt(9)
    v_mfma_f32_32x32x16_bf16 v[96:111], v[28:31], v[36:39], v[96:111]
    s_waitcnt lgkmcnt(0)
    s_barrier
    v_add_u32 v16, 4294950912, v16
    ds_read_b128 v[56:59], v16 offset:0
    ds_read_b64_tr_b16 v[64:65], v20 offset:16384
    v_mfma_f32_32x32x16_bf16 v[112:127], v[32:35], v[36:39], v[112:127]
    ds_read_b64_tr_b16 v[66:67], v20 offset:17408
    ds_read_b128 v[60:63], v16 offset:4096
    v_mfma_f32_32x32x16_bf16 v[144:159], v[32:35], v[164:167], v[144:159]
    ds_read_b64_tr_b16 v[68:69], v21 offset:16384
    ds_read_b64_tr_b16 v[70:71], v21 offset:17408
    v_mfma_f32_32x32x16_bf16 v[128:143], v[28:31], v[164:167], v[128:143]
    v_mfma_f32_32x32x16_bf16 v[96:111], v[72:75], v[80:83], v[96:111]
    v_add_u32 v17, 4294950912, v17
    ds_read_b128 v[28:31], v17 offset:0
    ds_read_b64_tr_b16 v[36:37], v22 offset:16384
    v_mfma_f32_32x32x16_bf16 v[112:127], v[76:79], v[80:83], v[112:127]
    ds_read_b64_tr_b16 v[38:39], v22 offset:17408
    ds_read_b128 v[32:35], v17 offset:4096
    v_mfma_f32_32x32x16_bf16 v[144:159], v[76:79], v[84:87], v[144:159]
    ds_read_b64_tr_b16 v[164:165], v23 offset:16384
    ds_read_b64_tr_b16 v[166:167], v23 offset:17408
    v_mfma_f32_32x32x16_bf16 v[128:143], v[72:75], v[84:87], v[128:143]
    s_waitcnt lgkmcnt(9)
    v_mfma_f32_32x32x16_bf16 v[96:111], v[56:59], v[64:67], v[96:111]
    v_add_u32 v18, 4294950912, v18
    ds_read_b128 v[72:75], v18 offset:0
    ds_read_b64_tr_b16 v[80:81], v24 offset:16384
    s_waitcnt lgkmcnt(10)
    v_mfma_f32_32x32x16_bf16 v[112:127], v[60:63], v[64:67], v[112:127]
    ds_read_b64_tr_b16 v[82:83], v24 offset:17408
    ds_read_b128 v[76:79], v18 offset:4096
    v_mfma_f32_16x16x32_bf16 v[40:43], v[64:67], v[88:91], v[40:43]
    s_waitcnt lgkmcnt(10)
    v_mfma_f32_32x32x16_bf16 v[144:159], v[60:63], v[68:71], v[144:159]
    ds_read_b64_tr_b16 v[84:85], v25 offset:16384
    ds_read_b64_tr_b16 v[86:87], v25 offset:17408
    v_mfma_f32_32x32x16_bf16 v[128:143], v[56:59], v[68:71], v[128:143]
    v_mfma_f32_16x16x32_bf16 v[44:47], v[68:71], v[88:91], v[44:47]
    s_waitcnt lgkmcnt(9)
    v_mfma_f32_32x32x16_bf16 v[96:111], v[28:31], v[36:39], v[96:111]
    v_add_u32 v19, 4294950912, v19
    ds_read_b128 v[56:59], v19 offset:0
    ds_read_b64_tr_b16 v[64:65], v26 offset:16384
    s_waitcnt lgkmcnt(10)
    v_mfma_f32_32x32x16_bf16 v[112:127], v[32:35], v[36:39], v[112:127]
    ds_read_b64_tr_b16 v[66:67], v26 offset:17408
    ds_read_b128 v[60:63], v19 offset:4096
    v_mfma_f32_16x16x32_bf16 v[40:43], v[36:39], v[88:91], v[40:43]
    s_waitcnt lgkmcnt(10)
    v_mfma_f32_32x32x16_bf16 v[144:159], v[32:35], v[164:167], v[144:159]
    ds_read_b64_tr_b16 v[68:69], v27 offset:16384
    ds_read_b64_tr_b16 v[70:71], v27 offset:17408
    v_mfma_f32_32x32x16_bf16 v[128:143], v[28:31], v[164:167], v[128:143]
    v_mfma_f32_16x16x32_bf16 v[44:47], v[164:167], v[88:91], v[44:47]
    s_waitcnt lgkmcnt(9)
    v_mfma_f32_32x32x16_bf16 v[96:111], v[72:75], v[80:83], v[96:111]
    s_waitcnt lgkmcnt(0)
    s_barrier
    ds_read_b128 v[28:31], v16 offset:16384
    ds_read_b64_tr_b16 v[36:37], v20 offset:32768
    v_mfma_f32_32x32x16_bf16 v[112:127], v[76:79], v[80:83], v[112:127]
    ds_read_b64_tr_b16 v[38:39], v20 offset:33792
    ds_read_b128 v[32:35], v16 offset:20480
    v_mfma_f32_32x32x16_bf16 v[144:159], v[76:79], v[84:87], v[144:159]
    ds_read_b64_tr_b16 v[164:165], v21 offset:32768
    ds_read_b64_tr_b16 v[166:167], v21 offset:33792
    v_mfma_f32_32x32x16_bf16 v[128:143], v[72:75], v[84:87], v[128:143]
    v_mfma_f32_32x32x16_bf16 v[96:111], v[56:59], v[64:67], v[96:111]
    ds_read_b128 v[72:75], v17 offset:16384
    ds_read_b64_tr_b16 v[80:81], v22 offset:32768
    v_mfma_f32_32x32x16_bf16 v[112:127], v[60:63], v[64:67], v[112:127]
    ds_read_b64_tr_b16 v[82:83], v22 offset:33792
    ds_read_b128 v[76:79], v17 offset:20480
    v_mfma_f32_32x32x16_bf16 v[144:159], v[60:63], v[68:71], v[144:159]
    ds_read_b64_tr_b16 v[84:85], v23 offset:32768
    ds_read_b64_tr_b16 v[86:87], v23 offset:33792
    v_mfma_f32_32x32x16_bf16 v[128:143], v[56:59], v[68:71], v[128:143]
    s_waitcnt lgkmcnt(9)
    v_mfma_f32_32x32x16_bf16 v[96:111], v[28:31], v[36:39], v[96:111]
    ds_read_b128 v[56:59], v18 offset:16384
    ds_read_b64_tr_b16 v[64:65], v24 offset:32768
    buffer_load_dword v13, off, s[64:67], 0 offset:192 sc1
    s_waitcnt lgkmcnt(10)
    v_mfma_f32_32x32x16_bf16 v[112:127], v[32:35], v[36:39], v[112:127]
    ds_read_b64_tr_b16 v[66:67], v24 offset:33792
    ds_read_b128 v[60:63], v18 offset:20480
    v_mfma_f32_16x16x32_bf16 v[40:43], v[36:39], v[88:91], v[40:43]
    s_waitcnt lgkmcnt(10)
    v_mfma_f32_32x32x16_bf16 v[144:159], v[32:35], v[164:167], v[144:159]
    ds_read_b64_tr_b16 v[68:69], v25 offset:32768
    ds_read_b64_tr_b16 v[70:71], v25 offset:33792
    v_mfma_f32_32x32x16_bf16 v[128:143], v[28:31], v[164:167], v[128:143]
    v_mfma_f32_16x16x32_bf16 v[44:47], v[164:167], v[88:91], v[44:47]
    s_waitcnt lgkmcnt(9)
    v_mfma_f32_32x32x16_bf16 v[96:111], v[72:75], v[80:83], v[96:111]
    ds_read_b128 v[28:31], v19 offset:16384
    ds_read_b64_tr_b16 v[36:37], v26 offset:32768
    s_waitcnt lgkmcnt(10)
    v_mfma_f32_32x32x16_bf16 v[112:127], v[76:79], v[80:83], v[112:127]
    ds_read_b64_tr_b16 v[38:39], v26 offset:33792
    ds_read_b128 v[32:35], v19 offset:20480
    v_mfma_f32_16x16x32_bf16 v[40:43], v[80:83], v[88:91], v[40:43]
    s_waitcnt lgkmcnt(10)
    v_mfma_f32_32x32x16_bf16 v[144:159], v[76:79], v[84:87], v[144:159]
    ds_read_b64_tr_b16 v[164:165], v27 offset:32768
    ds_read_b64_tr_b16 v[166:167], v27 offset:33792
    v_mfma_f32_32x32x16_bf16 v[128:143], v[72:75], v[84:87], v[128:143]
    v_mfma_f32_16x16x32_bf16 v[44:47], v[84:87], v[88:91], v[44:47]
    s_waitcnt lgkmcnt(9)
    v_mfma_f32_32x32x16_bf16 v[96:111], v[56:59], v[64:67], v[96:111]
    s_waitcnt lgkmcnt(0)
    s_barrier
    ds_read_b128 v[72:75], v16 offset:32768
    ds_read_b64_tr_b16 v[80:81], v20 offset:0
    v_mfma_f32_32x32x16_bf16 v[112:127], v[60:63], v[64:67], v[112:127]
    ds_read_b64_tr_b16 v[82:83], v20 offset:1024
    ds_read_b128 v[76:79], v16 offset:36864
    v_mfma_f32_32x32x16_bf16 v[144:159], v[60:63], v[68:71], v[144:159]
    ds_read_b64_tr_b16 v[84:85], v21 offset:0
    ds_read_b64_tr_b16 v[86:87], v21 offset:1024
    v_mfma_f32_32x32x16_bf16 v[128:143], v[56:59], v[68:71], v[128:143]
    v_mfma_f32_32x32x16_bf16 v[96:111], v[28:31], v[36:39], v[96:111]
    ds_read_b128 v[56:59], v17 offset:32768
    ds_read_b64_tr_b16 v[64:65], v22 offset:0
    v_mfma_f32_32x32x16_bf16 v[112:127], v[32:35], v[36:39], v[112:127]
    ds_read_b64_tr_b16 v[66:67], v22 offset:1024
    ds_read_b128 v[60:63], v17 offset:36864
    v_mfma_f32_32x32x16_bf16 v[144:159], v[32:35], v[164:167], v[144:159]
    ds_read_b64_tr_b16 v[68:69], v23 offset:0
    ds_read_b64_tr_b16 v[70:71], v23 offset:1024
    v_mfma_f32_32x32x16_bf16 v[128:143], v[28:31], v[164:167], v[128:143]
    s_waitcnt lgkmcnt(9)
    v_mfma_f32_32x32x16_bf16 v[96:111], v[72:75], v[80:83], v[96:111]
    ds_read_b128 v[28:31], v18 offset:32768
    ds_read_b64_tr_b16 v[36:37], v24 offset:0
    s_waitcnt lgkmcnt(10)
    v_mfma_f32_32x32x16_bf16 v[112:127], v[76:79], v[80:83], v[112:127]
    ds_read_b64_tr_b16 v[38:39], v24 offset:1024
    ds_read_b128 v[32:35], v18 offset:36864
    v_mfma_f32_16x16x32_bf16 v[40:43], v[80:83], v[88:91], v[40:43]
    s_waitcnt lgkmcnt(10)
    v_mfma_f32_32x32x16_bf16 v[144:159], v[76:79], v[84:87], v[144:159]
    ds_read_b64_tr_b16 v[164:165], v25 offset:0
    ds_read_b64_tr_b16 v[166:167], v25 offset:1024
    v_mfma_f32_32x32x16_bf16 v[128:143], v[72:75], v[84:87], v[128:143]
    v_mfma_f32_16x16x32_bf16 v[44:47], v[84:87], v[88:91], v[44:47]
    s_waitcnt lgkmcnt(9)
    v_mfma_f32_32x32x16_bf16 v[96:111], v[56:59], v[64:67], v[96:111]
    ds_read_b128 v[72:75], v19 offset:32768
    ds_read_b64_tr_b16 v[80:81], v26 offset:0
    s_waitcnt lgkmcnt(10)
    v_mfma_f32_32x32x16_bf16 v[112:127], v[60:63], v[64:67], v[112:127]
    ds_read_b64_tr_b16 v[82:83], v26 offset:1024
    ds_read_b128 v[76:79], v19 offset:36864
    v_mfma_f32_16x16x32_bf16 v[40:43], v[64:67], v[88:91], v[40:43]
    s_waitcnt lgkmcnt(10)
    v_mfma_f32_32x32x16_bf16 v[144:159], v[60:63], v[68:71], v[144:159]
    ds_read_b64_tr_b16 v[84:85], v27 offset:0
    ds_read_b64_tr_b16 v[86:87], v27 offset:1024
    v_mfma_f32_32x32x16_bf16 v[128:143], v[56:59], v[68:71], v[128:143]
    v_mfma_f32_16x16x32_bf16 v[44:47], v[68:71], v[88:91], v[44:47]
    s_waitcnt lgkmcnt(9)
    v_mfma_f32_32x32x16_bf16 v[96:111], v[28:31], v[36:39], v[96:111]
    ds_write_b128 v7, v[40:43]
    s_nop 4
    ds_write_b128 v7, v[44:47] offset:1024
    s_waitcnt lgkmcnt(10)
    v_mfma_f32_32x32x16_bf16 v[112:127], v[32:35], v[36:39], v[112:127]
    s_waitcnt lgkmcnt(0)
    s_barrier
    ds_read_b32 v10, v8
    ds_read_b32 v11, v8 offset:1024
    ds_read2_b32 v[160:161], v9 offset0:0 offset1:32
    ds_read2_b32 v[162:163], v12 offset0:0 offset1:32
    v_mfma_f32_32x32x16_bf16 v[144:159], v[32:35], v[164:167], v[144:159]
    v_mfma_f32_32x32x16_bf16 v[128:143], v[28:31], v[164:167], v[128:143]
    v_mfma_f32_32x32x16_bf16 v[96:111], v[72:75], v[80:83], v[96:111]
    s_waitcnt lgkmcnt(0)
    v_cvt_pk_bf16_f32 v58, 0, v10
    v_cvt_pk_bf16_f32 v62, 0, v11
    v_cvt_pk_bf16_f32 v64, -v160, -v160
    v_cvt_pk_bf16_f32 v66, -v161, -v161
    v_sub_f32 v58, v10, v58
    v_mfma_f32_32x32x16_bf16 v[112:127], v[76:79], v[80:83], v[112:127]
    v_sub_f32 v62, v11, v62
    v_cvt_pk_bf16_f32 v65, -v160, 0
    v_cvt_pk_bf16_f32 v67, -v161, 0
    v_cvt_pk_bf16_f32 v59, 0, v58
    v_cvt_pk_bf16_f32 v63, 0, v62
    v_mfma_f32_32x32x16_bf16 v[144:159], v[76:79], v[84:87], v[144:159]
    v_cvt_pk_bf16_f32 v56, v10, v58
    v_cvt_pk_bf16_f32 v60, v11, v62
    v_sub_f32 v59, v58, v59
    v_sub_f32 v63, v62, v63
    v_cvt_pk_bf16_f32 v57, v59, 0
    v_cvt_pk_bf16_f32 v61, v63, 0
    v_mfma_f32_32x32x16_bf16 v[128:143], v[72:75], v[84:87], v[128:143]
    v_mfma_f32_32x32x8_bf16 v[96:111], v[64:65], v[56:57], v[96:111]
    v_mfma_f32_32x32x8_bf16 v[112:127], v[66:67], v[56:57], v[112:127]
    v_mfma_f32_32x32x8_bf16 v[144:159], v[66:67], v[60:61], v[144:159]
    v_mfma_f32_32x32x8_bf16 v[128:143], v[64:65], v[60:61], v[128:143]
    s_setprio 3
    ds_read_b128 v[16:19], v48 offset:1536
    ds_read_b128 v[20:23], v48 offset:1568
    ds_read_b128 v[24:27], v48 offset:1600
    ds_read_b128 v[28:31], v48 offset:1632
    ds_read_b128 v[32:35], v48 offset:1664
    ds_read_b128 v[36:39], v48 offset:1696
    ds_read_b128 v[40:43], v48 offset:1728
    ds_read_b128 v[44:47], v48 offset:1760
    s_waitcnt lgkmcnt(4)
    v_mul_f32 v96, v96, v16
    v_mul_f32 v97, v97, v17
    v_mul_f32 v98, v98, v18
    v_mul_f32 v99, v99, v19
    v_mul_f32 v100, v100, v20
    v_mul_f32 v101, v101, v21
    v_mul_f32 v102, v102, v22
    v_mul_f32 v103, v103, v23
    v_mul_f32 v104, v104, v24
    v_mul_f32 v105, v105, v25
    v_mul_f32 v106, v106, v26
    v_mul_f32 v107, v107, v27
    v_mul_f32 v108, v108, v28
    v_mul_f32 v109, v109, v29
    v_mul_f32 v110, v110, v30
    v_mul_f32 v111, v111, v31
    v_cvt_pk_bf16_f32 v96, v96, v97
    v_cvt_pk_bf16_f32 v97, v98, v99
    v_cvt_pk_bf16_f32 v98, v100, v101
    v_cvt_pk_bf16_f32 v99, v102, v103
    v_cvt_pk_bf16_f32 v100, v104, v105
    v_cvt_pk_bf16_f32 v101, v106, v107
    v_cvt_pk_bf16_f32 v102, v108, v109
    v_cvt_pk_bf16_f32 v103, v110, v111
    buffer_store_dwordx4 v[96:99], v51, s[44:47], s4 offen offset:0 sc1
    buffer_store_dwordx4 v[100:103], v51, s[44:47], s5 offen offset:0 sc1
    s_waitcnt lgkmcnt(0)
    v_mul_f32 v112, v112, v32
    v_mul_f32 v113, v113, v33
    v_mul_f32 v114, v114, v34
    v_mul_f32 v115, v115, v35
    v_mul_f32 v116, v116, v36
    v_mul_f32 v117, v117, v37
    v_mul_f32 v118, v118, v38
    v_mul_f32 v119, v119, v39
    v_mul_f32 v120, v120, v40
    v_mul_f32 v121, v121, v41
    v_mul_f32 v122, v122, v42
    v_mul_f32 v123, v123, v43
    v_mul_f32 v124, v124, v44
    v_mul_f32 v125, v125, v45
    v_mul_f32 v126, v126, v46
    v_mul_f32 v127, v127, v47
    v_cvt_pk_bf16_f32 v112, v112, v113
    v_cvt_pk_bf16_f32 v113, v114, v115
    v_cvt_pk_bf16_f32 v114, v116, v117
    v_cvt_pk_bf16_f32 v115, v118, v119
    v_cvt_pk_bf16_f32 v116, v120, v121
    v_cvt_pk_bf16_f32 v117, v122, v123
    v_cvt_pk_bf16_f32 v118, v124, v125
    v_cvt_pk_bf16_f32 v119, v126, v127
    buffer_store_dwordx4 v[112:115], v51, s[44:47], s6 offen offset:0 sc1
    buffer_store_dwordx4 v[116:119], v51, s[44:47], s7 offen offset:0 sc1
    v_mul_f32 v144, v144, v32
    v_mul_f32 v145, v145, v33
    v_mul_f32 v146, v146, v34
    v_mul_f32 v147, v147, v35
    v_mul_f32 v148, v148, v36
    v_mul_f32 v149, v149, v37
    v_mul_f32 v150, v150, v38
    v_mul_f32 v151, v151, v39
    v_mul_f32 v152, v152, v40
    v_mul_f32 v153, v153, v41
    v_mul_f32 v154, v154, v42
    v_mul_f32 v155, v155, v43
    v_mul_f32 v156, v156, v44
    v_mul_f32 v157, v157, v45
    v_mul_f32 v158, v158, v46
    v_mul_f32 v159, v159, v47
    v_cvt_pk_bf16_f32 v144, v144, v145
    v_cvt_pk_bf16_f32 v145, v146, v147
    v_cvt_pk_bf16_f32 v146, v148, v149
    v_cvt_pk_bf16_f32 v147, v150, v151
    v_cvt_pk_bf16_f32 v148, v152, v153
    v_cvt_pk_bf16_f32 v149, v154, v155
    v_cvt_pk_bf16_f32 v150, v156, v157
    v_cvt_pk_bf16_f32 v151, v158, v159
    buffer_store_dwordx4 v[144:147], v51, s[44:47], s6 offen offset:512 sc1
    buffer_store_dwordx4 v[148:151], v51, s[44:47], s7 offen offset:512 sc1
    v_mul_f32 v128, v128, v16
    v_mul_f32 v129, v129, v17
    v_mul_f32 v130, v130, v18
    v_mul_f32 v131, v131, v19
    v_mul_f32 v132, v132, v20
    v_mul_f32 v133, v133, v21
    v_mul_f32 v134, v134, v22
    v_mul_f32 v135, v135, v23
    v_mul_f32 v136, v136, v24
    v_mul_f32 v137, v137, v25
    v_mul_f32 v138, v138, v26
    v_mul_f32 v139, v139, v27
    v_mul_f32 v140, v140, v28
    v_mul_f32 v141, v141, v29
    v_mul_f32 v142, v142, v30
    v_mul_f32 v143, v143, v31
    v_cvt_pk_bf16_f32 v128, v128, v129
    v_cvt_pk_bf16_f32 v129, v130, v131
    v_cvt_pk_bf16_f32 v130, v132, v133
    v_cvt_pk_bf16_f32 v131, v134, v135
    v_cvt_pk_bf16_f32 v132, v136, v137
    v_cvt_pk_bf16_f32 v133, v138, v139
    v_cvt_pk_bf16_f32 v134, v140, v141
    v_cvt_pk_bf16_f32 v135, v142, v143
    buffer_store_dwordx4 v[128:131], v51, s[44:47], s4 offen offset:512 sc1
    buffer_store_dwordx4 v[132:135], v51, s[44:47], s5 offen offset:512 sc1
L_f_pub:
    v_and_b32 v121, 3, v2
    v_lshlrev_b32 v121, 2, v121
    s_lshl_b32 s26, s29, 2
    s_add_u32 s26, s26, 64
    v_mov_b32 v122, s26
    v_mul_u32_u24 v7, 320, v3
    v_lshl_add_u32 v7, v4, 4, v7
    v_add_u32 v7, 5120, v7
    v_lshlrev_b32 v6, 4, v4
    v_mov_b32 v1, 0x3f803f80
    v_cmp_eq_u32 vcc, 20, v4
    v_mov_b32 v56, 0
    s_nop 0
    v_cndmask_b32 v24, 0, v1, vcc
    v_cndmask_b32 v25, 0, v1, vcc
    v_cndmask_b32 v26, 0, v1, vcc
    v_cndmask_b32 v27, 0, v1, vcc
    v_cndmask_b32 v28, 0, v1, vcc
    v_cndmask_b32 v29, 0, v1, vcc
    v_cndmask_b32 v30, 0, v1, vcc
    v_cndmask_b32 v31, 0, v1, vcc
    s_mul_i32 s30, s29, 123520
    s_add_u32 s30, s30, s16
    s_add_u32 s30, s30, 40960
    v_add_u32 v60, s30, v5
    s_add_u32 s30, s30, s17
    v_lshrrev_b32 v8, 1, v2
    v_and_b32 v9, 1, v2
    v_lshlrev_b32 v9, 2, v9
    v_lshl_add_u32 v8, v8, 4, v9
    v_add_u32 v61, s30, v8
    s_lshl_b32 s36, s29, 10
    s_lshl_b32 s37, s29, 8
    s_mul_i32 s30, s14, 320
    s_add_u32 s30, s30, 81920
    s_lshl_b32 s31, s29, 6
    s_lshl_b32 s26, s29, 4
    s_add_u32 s26, s26, 256
    v_add_u32 v11, s31, v2
    v_mul_u32_u24 v8, 3277, v11
    v_lshrrev_b32 v8, 16, v8
    v_mul_u32_u24 v9, 20, v8
    v_sub_u32 v9, v11, v9
    v_lshrrev_b32 v10, 2, v8
    v_and_b32 v8, 3, v8
    v_mul_u32_u24 v10, 123520, v10
    v_mul_u32_u24 v8, 10368, v8
    v_lshl_add_u32 v9, v9, 4, s30
    v_add3_u32 v62, v8, v9, v10
    v_lshrrev_b32 v11, 2, v2
    v_add_u32 v11, s26, v11
    v_mul_u32_u24 v8, 3277, v11
    v_lshrrev_b32 v8, 16, v8
    v_mul_u32_u24 v9, 20, v8
    v_sub_u32 v9, v11, v9
    v_lshrrev_b32 v10, 2, v8
    v_and_b32 v8, 3, v8
    v_mul_u32_u24 v10, 123520, v10
    v_mul_u32_u24 v8, 10368, v8
    v_lshl_add_u32 v9, v9, 4, s30
    v_add3_u32 v63, v8, v9, v10
    v_and_b32 v11, 3, v2
    v_lshl_add_u32 v63, v11, 2, v63
    s_lshl_b32 s26, s29, 2
    v_mov_b32 v57, s26
    v_mov_b32 v58, 16
    s_mov_b32 s38, 494080
    ds_write_b32 v57, v58 offset:192
    s_cmp_eq_u32 s9, 3
    s_cbranch_scc1 L_f_pb2
    s_mov_b32 s26, 300000
    s_waitcnt vmcnt(0)
L_f_cw:
    v_readfirstlane_b32 s30, v13
    s_cmp_ge_u32 s30, 16
    s_cbranch_scc1 L_f_cd
    s_sub_u32 s26, s26, 1
    s_cbranch_scc1 L_f_cd
    s_sleep 2
    buffer_load_dword v13, off, s[64:67], 0 offset:192 sc1
    s_waitcnt vmcnt(0)
    s_branch L_f_cw
L_f_cd:
    s_mov_b64 exec, 1
    buffer_store_dword v49, off, s[44:47], s10 sc1
    s_mov_b64 exec, -1
L_f_pb2:
    s_setprio 0
    s_cmp_lg_u32 s29, 3
    s_cbranch_scc1 L_f_at1
    v_and_b32 v57, 7, v2
    v_lshlrev_b32 v57, 2, v57
L_f_pq:
    ds_read_b32 v58, v57 offset:176
    s_waitcnt lgkmcnt(0)
    s_sleep 1
    v_cmp_gt_u32 vcc, 16, v58
    s_cbranch_vccnz L_f_pq
    s_mov_b32 s26, 300000
    s_lshl_b32 s30, 15, s11
    s_or_b32 s30, s30, 15
    s_mov_b32 exec_lo, s30
    s_mov_b32 exec_hi, s30
L_f_qp:
    buffer_load_dwordx4 v[52:55], v50, s[44:47], 0 offen sc1
    s_waitcnt vmcnt(0)
    v_min_u32 v53, v53, v54
    v_cmp_ne_u32 s[30:31], 0, v52
    v_cmp_ne_u32 s[42:43], 0, v53
    s_and_b32 s30, s30, s31
    s_and_b32 s42, s42, s43
    s_lshr_b32 s30, s30, s11
    s_sub_u32 s26, s26, 1
    s_cselect_b32 s30, -1, s30
    s_cselect_b32 s42, -1, s42
    s_cselect_b32 s26, 0, s26
    s_bitcmp1_b32 s42, 0
    s_cselect_b32 s31, 15, 0
    s_and_b32 s30, s30, s31
    s_or_b32 s30, s30, 0x100
    v_mov_b32 v52, s30
    v_mov_b32 v53, s42
    ds_write_b64 v56, v[52:53] offset:224
    s_and_b32 s42, s42, 15
    s_lshl_b32 s42, s42, 4
    s_or_b32 s30, s30, s42
    s_cmp_eq_u32 s30, 0x1ff
    s_cbranch_scc1 L_f_at1
    s_sleep 0
    s_branch L_f_qp
L_f_at1:
    s_mov_b64 exec, -1
    s_lshr_b32 s26, s29, 1
    s_mov_b32 s27, 11
L_f_qw:
    ds_read_b64 v[58:59], v56 offset:224
    s_waitcnt lgkmcnt(0)
    v_readfirstlane_b32 s30, v58
    v_readfirstlane_b32 s31, v59
    s_lshr_b32 s30, s30, s26
    s_and_b32 s30, s30, 1
    s_lshr_b32 s28, s31, 1
    s_and_b32 s31, s31, s28
    s_and_b32 s31, s31, 5
    s_lshl_b32 s31, s31, 1
    s_or_b32 s30, s30, s31
    s_and_b32 s30, s30, s27
    s_cbranch_scc1 L_f_qa
    s_sleep 2
    s_branch L_f_qw
L_f_qa:
    s_bitcmp1_b32 s30, 1
    s_cbranch_scc0 L_f_qb
    s_cmp_eq_u32 s29, 0
    s_cbranch_scc1 L_f_d0
    s_add_u32 m0, s36, 0
    s_nop 0
    buffer_load_dwordx4 v60, s[44:47], 0 offen sc1 lds
L_f_d0:
    s_add_u32 m0, s37, 4096
    s_nop 0
    buffer_load_dword v61, s[44:47], 0 offen sc1 lds
    s_add_u32 m0, s36, 5120
    s_nop 0
    buffer_load_dwordx4 v62, s[44:47], 0 offen sc1 lds
    s_add_u32 m0, s37, 9216
    s_nop 0
    buffer_load_dword v63, s[44:47], 0 offen sc1 lds
L_f_qb:
    s_bitcmp1_b32 s30, 0
    s_cbranch_scc0 L_f_qc
    buffer_load_dwordx4 v[52:55], v5, s[44:47], s20 offen sc1
    buffer_load_dwordx2 v[14:15], v6, s[44:47], s18 offen sc1
    buffer_load_dwordx4 v[92:95], v5, s[44:47], s21 offen sc1
L_f_qc:
    s_bitcmp1_b32 s30, 3
    s_cbranch_scc0 L_f_qd
    s_add_u32 m0, s36, 10240
    s_nop 0
    buffer_load_dwordx4 v60, s[44:47], s38 offen sc1 lds
    s_add_u32 m0, s37, 14336
    s_nop 0
    buffer_load_dword v61, s[44:47], s38 offen sc1 lds
    s_add_u32 m0, s36, 15360
    s_nop 0
    buffer_load_dwordx4 v62, s[44:47], s38 offen sc1 lds
    s_add_u32 m0, s37, 19456
    s_nop 0
    buffer_load_dword v63, s[44:47], s38 offen sc1 lds
L_f_qd:
    s_andn2_b32 s27, s27, s30
    s_cbranch_scc1 L_f_qw
L_f_at2:
    v_cmp_eq_u32 vcc, 20, v4
    v_lshlrev_b32 v57, 3, v4
    s_nop 0
    v_cndmask_b32 v132, 0, v1, vcc
    v_cndmask_b32 v133, 0, v1, vcc
    v_cndmask_b32 v134, 0, v1, vcc
    v_cndmask_b32 v135, 0, v1, vcc
    v_cndmask_b32 v136, 0, v1, vcc
    v_cndmask_b32 v137, 0, v1, vcc
    v_cndmask_b32 v138, 0, v1, vcc
    v_cndmask_b32 v139, 0, v1, vcc
    v_mov_b32 v164, -1
    v_mov_b32 v165, -1
    v_mov_b32 v166, -1
    v_mov_b32 v167, -1
    v_add_u32 v6, 4096, v57
    s_waitcnt vmcnt(0)
L_f_nhx:
    v_mov_b32 v8, v52
    v_mov_b32 v16, v92
    v_mov_b32 v9, v53
    v_mov_b32 v17, v93
    v_mov_b32 v10, v54
    v_mov_b32 v18, v94
    v_mov_b32 v11, v55
    v_mov_b32 v19, v95
    v_cndmask_b32 v12, 0, v14, s[24:25]
    v_cndmask_b32 v13, 0, v15, s[24:25]
    s_barrier
    s_cmp_eq_u32 s34, 0
    s_cbranch_scc1 L_f_nhc
    buffer_store_dwordx4 v[104:107], v5, s[32:35], s4 offen offset:0 sc1
    buffer_store_dwordx4 v[108:111], v5, s[32:35], s4 offen offset:1024 sc1
    buffer_store_dwordx4 v[112:115], v5, s[32:35], s5 offen offset:0 sc1
    buffer_store_dwordx4 v[116:119], v5, s[32:35], s5 offen offset:1024 sc1
    buffer_store_dwordx4 v[144:147], v5, s[32:35], s5 offen offset:2048 sc1
    buffer_store_dwordx4 v[148:151], v5, s[32:35], s5 offen offset:3072 sc1
    buffer_store_dwordx4 v[152:155], v5, s[32:35], s4 offen offset:2048 sc1
    buffer_store_dwordx4 v[156:159], v5, s[32:35], s4 offen offset:3072 sc1
L_f_nhc:
    ds_read_b64 v[20:21], v6
    ds_read_b128 v[84:87], v5 offset:1024
    ds_read_b64 v[98:99], v6 offset:256
    ds_read_b128 v[88:91], v5 offset:2048
    ds_read_b64 v[100:101], v6 offset:512
    ds_read_b128 v[92:95], v5 offset:3072
    ds_read_b64 v[102:103], v6 offset:768
    s_waitcnt lgkmcnt(6)
    v_mfma_f32_32x32x16_bf16 v[32:47], v[16:19], v[8:11], 0
    v_mfma_f32_32x32x8_bf16 v[32:47], v[20:21], v[12:13], v[32:47]
    s_waitcnt lgkmcnt(4)
    v_mfma_f32_32x32x16_bf16 v[48:63], v[84:87], v[8:11], 0
    v_mfma_f32_32x32x8_bf16 v[48:63], v[98:99], v[12:13], v[48:63]
    s_waitcnt lgkmcnt(2)
    v_mfma_f32_32x32x16_bf16 v[64:79], v[88:91], v[8:11], 0
    v_mfma_f32_32x32x8_bf16 v[64:79], v[100:101], v[12:13], v[64:79]
    s_nop 5
    v_max_f32 v1, v32, v33
    v_max3_f32 v1, v1, v34, v35
    v_max3_f32 v1, v1, v36, v37
    v_max3_f32 v1, v1, v38, v39
    v_max3_f32 v1, v1, v40, v41
    v_max3_f32 v1, v1, v42, v43
    v_max3_f32 v1, v1, v44, v45
    v_max3_f32 v1, v1, v46, v47
    s_waitcnt lgkmcnt(0)
    v_mfma_f32_32x32x16_bf16 v[32:47], v[92:95], v[8:11], 0
    v_mfma_f32_32x32x8_bf16 v[32:47], v[102:103], v[12:13], v[32:47]
    v_max3_f32 v1, v1, v48, v49
    v_max3_f32 v1, v1, v50, v51
    v_max3_f32 v1, v1, v52, v53
    v_max3_f32 v1, v1, v54, v55
    v_max3_f32 v1, v1, v56, v57
    v_max3_f32 v1, v1, v58, v59
    v_max3_f32 v1, v1, v60, v61
    v_max3_f32 v1, v1, v62, v63
    v_max3_f32 v1, v1, v64, v65
    v_max3_f32 v1, v1, v66, v67
    v_max3_f32 v1, v1, v68, v69
    v_max3_f32 v1, v1, v70, v71
    v_max3_f32 v1, v1, v72, v73
    v_max3_f32 v1, v1, v74, v75
    v_max3_f32 v1, v1, v76, v77
    v_max3_f32 v1, v1, v78, v79
    v_max3_f32 v1, v1, v32, v33
    v_max3_f32 v1, v1, v34, v35
    v_max3_f32 v1, v1, v36, v37
    v_max3_f32 v1, v1, v38, v39
    v_max3_f32 v1, v1, v40, v41
    v_max3_f32 v1, v1, v42, v43
    v_max3_f32 v1, v1, v44, v45
    v_max3_f32 v1, v1, v46, v47
    v_mov_b32 v14, v1
    s_mov_b32 s26, 0x42c00000
    s_nop 0
    v_permlane32_swap_b32 v1, v14
    v_max_f32 v1, v1, v14
    v_add_f32 v1, s26, v1
    v_sub_f32 v80, 0, v1
    v_sub_f32 v81, 0, v1
    v_sub_f32 v82, 0, v1
    v_sub_f32 v83, 0, v1
    v_sub_f32 v84, 0, v1
    v_sub_f32 v85, 0, v1
    v_sub_f32 v86, 0, v1
    v_sub_f32 v87, 0, v1
    v_sub_f32 v88, 0, v1
    v_sub_f32 v89, 0, v1
    v_sub_f32 v90, 0, v1
    v_sub_f32 v91, 0, v1
    v_sub_f32 v92, 0, v1
    v_sub_f32 v93, 0, v1
    v_sub_f32 v94, 0, v1
    v_sub_f32 v95, 0, v1
    v_mov_b32 v64, 0
    v_mov_b32 v65, 0
    v_mov_b32 v66, 0
    v_mov_b32 v67, 0
    v_mov_b32 v68, 0
    v_mov_b32 v69, 0
    v_mov_b32 v70, 0
    v_mov_b32 v71, 0
    v_mov_b32 v72, 0
    v_mov_b32 v73, 0
    v_mov_b32 v74, 0
    v_mov_b32 v75, 0
    v_mov_b32 v76, 0
    v_mov_b32 v77, 0
    v_mov_b32 v78, 0
    v_mov_b32 v79, 0
    s_cmp_eq_u32 s34, 0
    s_cselect_b32 s9, 1, 0
    s_waitcnt lgkmcnt(0)
    ds_read_b128 v[124:127], v5 offset:1024
    ds_read_b64 v[128:129], v6 offset:256
    s_mov_b64 exec, s[22:23]
    ds_read_b128 v[24:27], v7 offset:0
    ds_read_b128 v[28:31], v7 offset:640
    s_mov_b64 exec, -1
    v_mfma_f32_32x32x16_bf16 v[32:47], v[16:19], v[8:11], v[80:95]
    v_mfma_f32_32x32x8_bf16 v[32:47], v[20:21], v[12:13], v[32:47]
    ds_read_b128 v[16:19], v5 offset:2048
    ds_read_b64 v[20:21], v6 offset:512
    s_mov_b64 exec, s[22:23]
    ds_read_b128 v[132:135], v7 offset:1280
    ds_read_b128 v[136:139], v7 offset:1920
    s_mov_b64 exec, -1
    s_nop 5
    v_exp_f32 v32, v32
    v_exp_f32 v33, v33
    v_exp_f32 v34, v34
    v_exp_f32 v35, v35
    v_exp_f32 v36, v36
    v_exp_f32 v37, v37
    v_exp_f32 v38, v38
    v_exp_f32 v39, v39
    s_setprio 3
    s_waitcnt lgkmcnt(6)
    v_mfma_f32_32x32x16_bf16 v[48:63], v[124:127], v[8:11], v[80:95]
    v_exp_f32 v40, v40
    v_exp_f32 v41, v41
    v_cvt_pk_bf16_f32 v32, v32, v33
    v_cvt_pk_bf16_f32 v33, v34, v35
    v_exp_f32 v42, v42
    v_exp_f32 v43, v43
    v_mfma_f32_32x32x8_bf16 v[48:63], v[128:129], v[12:13], v[48:63]
    ds_read_b128 v[124:127], v5 offset:3072
    ds_read_b64 v[128:129], v6 offset:768
    v_cvt_pk_bf16_f32 v34, v36, v37
    v_cvt_pk_bf16_f32 v35, v38, v39
    v_exp_f32 v44, v44
    v_exp_f32 v45, v45
    v_exp_f32 v46, v46
    v_exp_f32 v47, v47
    s_waitcnt lgkmcnt(6)
    v_mfma_f32_32x32x16_bf16 v[64:79], v[24:27], v[32:35], v[64:79]
    v_cvt_pk_bf16_f32 v40, v40, v41
    v_cvt_pk_bf16_f32 v41, v42, v43
    v_exp_f32 v48, v48
    v_exp_f32 v49, v49
    v_cvt_pk_bf16_f32 v42, v44, v45
    v_cvt_pk_bf16_f32 v43, v46, v47
    v_exp_f32 v50, v50
    v_exp_f32 v51, v51
    v_mfma_f32_32x32x16_bf16 v[64:79], v[28:31], v[40:43], v[64:79]
    s_mov_b64 exec, s[22:23]
    ds_read_b128 v[24:27], v7 offset:2560
    ds_read_b128 v[28:31], v7 offset:3200
    s_mov_b64 exec, -1
    v_exp_f32 v52, v52
    v_exp_f32 v53, v53
    v_exp_f32 v54, v54
    v_exp_f32 v55, v55
    s_setprio 2
    s_waitcnt lgkmcnt(6)
    v_mfma_f32_32x32x16_bf16 v[32:47], v[16:19], v[8:11], v[80:95]
    v_exp_f32 v56, v56
    v_exp_f32 v57, v57
    v_cvt_pk_bf16_f32 v48, v48, v49
    v_cvt_pk_bf16_f32 v49, v50, v51
    v_exp_f32 v58, v58
    v_exp_f32 v59, v59
    v_mfma_f32_32x32x8_bf16 v[32:47], v[20:21], v[12:13], v[32:47]
    ds_read_b128 v[16:19], v5 offset:10240
    ds_read_b64 v[20:21], v6 offset:10240
    v_cvt_pk_bf16_f32 v50, v52, v53
    v_cvt_pk_bf16_f32 v51, v54, v55
    v_exp_f32 v60, v60
    v_exp_f32 v61, v61
    v_exp_f32 v62, v62
    v_exp_f32 v63, v63
    s_waitcnt lgkmcnt(6)
    v_mfma_f32_32x32x16_bf16 v[64:79], v[132:135], v[48:51], v[64:79]
    v_cvt_pk_bf16_f32 v56, v56, v57
    v_cvt_pk_bf16_f32 v57, v58, v59
    v_exp_f32 v32, v32
    v_exp_f32 v33, v33
    v_cvt_pk_bf16_f32 v58, v60, v61
    v_cvt_pk_bf16_f32 v59, v62, v63
    v_exp_f32 v34, v34
    v_exp_f32 v35, v35
    v_mfma_f32_32x32x16_bf16 v[64:79], v[136:139], v[56:59], v[64:79]
    s_mov_b64 exec, s[22:23]
    ds_read_b128 v[132:135], v7 offset:3840
    ds_read_b128 v[136:139], v7 offset:4480
    s_mov_b64 exec, -1
    v_exp_f32 v36, v36
    v_exp_f32 v37, v37
    v_exp_f32 v38, v38
    v_exp_f32 v39, v39
    s_setprio 1
    s_waitcnt lgkmcnt(6)
    v_mfma_f32_32x32x16_bf16 v[48:63], v[124:127], v[8:11], v[80:95]
    v_exp_f32 v40, v40
    v_exp_f32 v41, v41
    v_cvt_pk_bf16_f32 v32, v32, v33
    v_cvt_pk_bf16_f32 v33, v34, v35
    v_exp_f32 v42, v42
    v_exp_f32 v43, v43
    v_mfma_f32_32x32x8_bf16 v[48:63], v[128:129], v[12:13], v[48:63]
    ds_read_b128 v[124:127], v5 offset:11264
    ds_read_b64 v[128:129], v6 offset:10496
    v_cvt_pk_bf16_f32 v34, v36, v37
    v_cvt_pk_bf16_f32 v35, v38, v39
    v_exp_f32 v44, v44
    v_exp_f32 v45, v45
    v_exp_f32 v46, v46
    v_exp_f32 v47, v47
    s_waitcnt lgkmcnt(6)
    v_mfma_f32_32x32x16_bf16 v[64:79], v[24:27], v[32:35], v[64:79]
    v_cvt_pk_bf16_f32 v40, v40, v41
    v_cvt_pk_bf16_f32 v41, v42, v43
    v_exp_f32 v48, v48
    v_exp_f32 v49, v49
    v_cvt_pk_bf16_f32 v42, v44, v45
    v_cvt_pk_bf16_f32 v43, v46, v47
    v_exp_f32 v50, v50
    v_exp_f32 v51, v51
    v_mfma_f32_32x32x16_bf16 v[64:79], v[28:31], v[40:43], v[64:79]
    s_mov_b64 exec, s[22:23]
    ds_read_b128 v[24:27], v7 offset:10240
    ds_read_b128 v[28:31], v7 offset:10880
    s_mov_b64 exec, -1
    s_getreg_b32 s30, hwreg(HW_REG_IB_STS, 0, 4)
    s_or_b32 s30, s30, s9
    s_cbranch_scc1 L_f_hp2
    s_waitcnt vmcnt(0)
    s_mov_b64 exec, 1
    buffer_store_dword v122, off, s[32:35], s10 sc1
    s_mov_b64 exec, -1
    s_mov_b32 s9, 1
L_f_hp2:
    v_exp_f32 v52, v52
    v_exp_f32 v53, v53
    v_exp_f32 v54, v54
    v_exp_f32 v55, v55
    s_setprio 0
    s_waitcnt lgkmcnt(6)
    v_mfma_f32_32x32x16_bf16 v[32:47], v[16:19], v[8:11], v[80:95]
    v_exp_f32 v56, v56
    v_exp_f32 v57, v57
    v_cvt_pk_bf16_f32 v48, v48, v49
    v_cvt_pk_bf16_f32 v49, v50, v51
    v_exp_f32 v58, v58
    v_exp_f32 v59, v59
    v_mfma_f32_32x32x8_bf16 v[32:47], v[20:21], v[12:13], v[32:47]
    ds_read_b128 v[16:19], v5 offset:12288
    ds_read_b64 v[20:21], v6 offset:10752
    v_cvt_pk_bf16_f32 v50, v52, v53
    v_cvt_pk_bf16_f32 v51, v54, v55
    v_exp_f32 v60, v60
    v_exp_f32 v61, v61
    v_exp_f32 v62, v62
    v_exp_f32 v63, v63
    s_waitcnt lgkmcnt(6)
    v_mfma_f32_32x32x16_bf16 v[64:79], v[132:135], v[48:51], v[64:79]
    v_cvt_pk_bf16_f32 v56, v56, v57
    v_cvt_pk_bf16_f32 v57, v58, v59
    v_exp_f32 v32, v32
    v_exp_f32 v33, v33
    v_cvt_pk_bf16_f32 v58, v60, v61
    v_cvt_pk_bf16_f32 v59, v62, v63
    v_exp_f32 v34, v34
    v_exp_f32 v35, v35
    v_mfma_f32_32x32x16_bf16 v[64:79], v[136:139], v[56:59], v[64:79]
    s_mov_b64 exec, s[22:23]
    ds_read_b128 v[132:135], v7 offset:11520
    ds_read_b128 v[136:139], v7 offset:12160
    s_mov_b64 exec, -1
    v_exp_f32 v36, v36
    v_exp_f32 v37, v37
    v_exp_f32 v38, v38
    v_exp_f32 v39, v39
    s_setprio 3
    s_waitcnt lgkmcnt(6)
    v_mfma_f32_32x32x16_bf16 v[48:63], v[124:127], v[8:11], v[80:95]
    v_exp_f32 v40, v40
    v_exp_f32 v41, v41
    v_cvt_pk_bf16_f32 v32, v32, v33
    v_cvt_pk_bf16_f32 v33, v34, v35
    v_exp_f32 v42, v42
    v_exp_f32 v43, v43
    v_mfma_f32_32x32x8_bf16 v[48:63], v[128:129], v[12:13], v[48:63]
    ds_read_b128 v[124:127], v5 offset:13312
    ds_read_b64 v[128:129], v6 offset:11008
    ds_read_b32 v120, v121
    v_cvt_pk_bf16_f32 v34, v36, v37
    v_cvt_pk_bf16_f32 v35, v38, v39
    v_exp_f32 v44, v44
    v_exp_f32 v45, v45
    v_exp_f32 v46, v46
    v_exp_f32 v47, v47
    s_waitcnt lgkmcnt(6)
    v_mfma_f32_32x32x16_bf16 v[64:79], v[24:27], v[32:35], v[64:79]
    v_cvt_pk_bf16_f32 v40, v40, v41
    v_cvt_pk_bf16_f32 v41, v42, v43
    v_exp_f32 v48, v48
    v_exp_f32 v49, v49
    v_cvt_pk_bf16_f32 v42, v44, v45
    v_cvt_pk_bf16_f32 v43, v46, v47
    v_exp_f32 v50, v50
    v_exp_f32 v51, v51
    v_mfma_f32_32x32x16_bf16 v[64:79], v[28:31], v[40:43], v[64:79]
    s_mov_b64 exec, s[22:23]
    ds_read_b128 v[24:27], v7 offset:12800
    ds_read_b128 v[28:31], v7 offset:13440
    s_mov_b64 exec, -1
    s_getreg_b32 s30, hwreg(HW_REG_IB_STS, 0, 4)
    s_or_b32 s30, s30, s9
    s_cbranch_scc1 L_f_hp4
    s_waitcnt vmcnt(0)
    s_mov_b64 exec, 1
    buffer_store_dword v122, off, s[32:35], s10 sc1
    s_mov_b64 exec, -1
    s_mov_b32 s9, 1
L_f_hp4:
    v_exp_f32 v52, v52
    v_exp_f32 v53, v53
    v_exp_f32 v54, v54
    v_exp_f32 v55, v55
    s_setprio 2
    s_waitcnt lgkmcnt(6)
    v_mfma_f32_32x32x16_bf16 v[32:47], v[16:19], v[8:11], v[80:95]
    v_exp_f32 v56, v56
    v_exp_f32 v57, v57
    v_cvt_pk_bf16_f32 v48, v48, v49
    v_cvt_pk_bf16_f32 v49, v50, v51
    v_exp_f32 v58, v58
    v_exp_f32 v59, v59
    v_mfma_f32_32x32x8_bf16 v[32:47], v[20:21], v[12:13], v[32:47]
    s_waitcnt lgkmcnt(2)
    v_cmp_gt_u32 vcc, 1, v120
    s_cbranch_vccz L_f_ok0
L_f_poll0:
    s_sleep 1
    ds_read_b32 v120, v121
    s_waitcnt lgkmcnt(0)
    v_cmp_gt_u32 vcc, 1, v120
    s_cbranch_vccnz L_f_poll0
L_f_ok0:
    ds_read_b128 v[16:19], v5 offset:20480
    ds_read_b64 v[20:21], v6 offset:20480
    v_cvt_pk_bf16_f32 v50, v52, v53
    v_cvt_pk_bf16_f32 v51, v54, v55
    v_exp_f32 v60, v60
    v_exp_f32 v61, v61
    v_exp_f32 v62, v62
    v_exp_f32 v63, v63
    s_waitcnt lgkmcnt(6)
    v_mfma_f32_32x32x16_bf16 v[64:79], v[132:135], v[48:51], v[64:79]
    v_cvt_pk_bf16_f32 v56, v56, v57
    v_cvt_pk_bf16_f32 v57, v58, v59
    v_exp_f32 v32, v32
    v_exp_f32 v33, v33
    v_cvt_pk_bf16_f32 v58, v60, v61
    v_cvt_pk_bf16_f32 v59, v62, v63
    v_exp_f32 v34, v34
    v_exp_f32 v35, v35
    v_mfma_f32_32x32x16_bf16 v[64:79], v[136:139], v[56:59], v[64:79]
    s_mov_b64 exec, s[22:23]
    ds_read_b128 v[132:135], v7 offset:14080
    ds_read_b128 v[136:139], v7 offset:14720
    s_mov_b64 exec, -1
    v_exp_f32 v36, v36
    v_exp_f32 v37, v37
    v_exp_f32 v38, v38
    v_exp_f32 v39, v39
    s_setprio 1
    s_waitcnt lgkmcnt(6)
    v_mfma_f32_32x32x16_bf16 v[48:63], v[124:127], v[8:11], v[80:95]
    v_exp_f32 v40, v40
    v_exp_f32 v41, v41
    v_cvt_pk_bf16_f32 v32, v32, v33
    v_cvt_pk_bf16_f32 v33, v34, v35
    v_exp_f32 v42, v42
    v_exp_f32 v43, v43
    v_mfma_f32_32x32x8_bf16 v[48:63], v[128:129], v[12:13], v[48:63]
    ds_read_b128 v[124:127], v5 offset:21504
    ds_read_b64 v[128:129], v6 offset:20736
    v_cvt_pk_bf16_f32 v34, v36, v37
    v_cvt_pk_bf16_f32 v35, v38, v39
    v_exp_f32 v44, v44
    v_exp_f32 v45, v45
    v_exp_f32 v46, v46
    v_exp_f32 v47, v47
    s_waitcnt lgkmcnt(6)
    v_mfma_f32_32x32x16_bf16 v[64:79], v[24:27], v[32:35], v[64:79]
    v_cvt_pk_bf16_f32 v40, v40, v41
    v_cvt_pk_bf16_f32 v41, v42, v43
    v_exp_f32 v48, v48
    v_exp_f32 v49, v49
    v_cvt_pk_bf16_f32 v42, v44, v45
    v_cvt_pk_bf16_f32 v43, v46, v47
    v_exp_f32 v50, v50
    v_exp_f32 v51, v51
    v_mfma_f32_32x32x16_bf16 v[64:79], v[28:31], v[40:43], v[64:79]
    s_mov_b64 exec, s[22:23]
    ds_read_b128 v[24:27], v7 offset:20480
    ds_read_b128 v[28:31], v7 offset:21120
    s_mov_b64 exec, -1
    s_getreg_b32 s30, hwreg(HW_REG_IB_STS, 0, 4)
    s_or_b32 s30, s30, s9
    s_cbranch_scc1 L_f_hp6
    s_waitcnt vmcnt(0)
    s_mov_b64 exec, 1
    buffer_store_dword v122, off, s[32:35], s10 sc1
    s_mov_b64 exec, -1
    s_mov_b32 s9, 1
L_f_hp6:
    v_exp_f32 v52, v52
    v_exp_f32 v53, v53
    v_exp_f32 v54, v54
    v_exp_f32 v55, v55
    s_setprio 0
    s_waitcnt lgkmcnt(6)
    v_mfma_f32_32x32x16_bf16 v[32:47], v[16:19], v[8:11], v[80:95]
    v_exp_f32 v56, v56
    v_exp_f32 v57, v57
    v_cvt_pk_bf16_f32 v48, v48, v49
    v_cvt_pk_bf16_f32 v49, v50, v51
    v_exp_f32 v58, v58
    v_exp_f32 v59, v59
    v_mfma_f32_32x32x8_bf16 v[32:47], v[20:21], v[12:13], v[32:47]
    ds_read_b128 v[16:19], v5 offset:22528
    ds_read_b64 v[20:21], v6 offset:20992
    ds_read_b32 v120, v121
    v_cvt_pk_bf16_f32 v50, v52, v53
    v_cvt_pk_bf16_f32 v51, v54, v55
    v_exp_f32 v60, v60
    v_exp_f32 v61, v61
    v_exp_f32 v62, v62
    v_exp_f32 v63, v63
    s_waitcnt lgkmcnt(6)
    v_mfma_f32_32x32x16_bf16 v[64:79], v[132:135], v[48:51], v[64:79]
    v_cvt_pk_bf16_f32 v56, v56, v57
    v_cvt_pk_bf16_f32 v57, v58, v59
    v_exp_f32 v32, v32
    v_exp_f32 v33, v33
    v_cvt_pk_bf16_f32 v58, v60, v61
    v_cvt_pk_bf16_f32 v59, v62, v63
    v_exp_f32 v34, v34
    v_exp_f32 v35, v35
    v_mfma_f32_32x32x16_bf16 v[64:79], v[136:139], v[56:59], v[64:79]
    s_mov_b64 exec, s[22:23]
    ds_read_b128 v[132:135], v7 offset:21760
    ds_read_b128 v[136:139], v7 offset:22400
    s_mov_b64 exec, -1
    v_exp_f32 v36, v36
    v_exp_f32 v37, v37
    v_exp_f32 v38, v38
    v_exp_f32 v39, v39
    v_add_u32 v5, 20480, v5
    v_add_u32 v6, 20480, v6
    v_add_u32 v7, 20480, v7
    s_mov_b32 s27, 1
    s_mov_b32 s28, 2
    v_mov_b32 v123, 1
L_f_loop:
    s_setprio 3
    s_waitcnt lgkmcnt(6)
    v_mfma_f32_32x32x16_bf16 v[48:63], v[124:127], v[8:11], v[80:95]
    v_exp_f32 v40, v40
    v_exp_f32 v41, v41
    v_cvt_pk_bf16_f32 v32, v32, v33
    v_cvt_pk_bf16_f32 v33, v34, v35
    v_exp_f32 v42, v42
    v_exp_f32 v43, v43
    v_mfma_f32_32x32x8_bf16 v[48:63], v[128:129], v[12:13], v[48:63]
    s_waitcnt lgkmcnt(2)
    v_cmp_gt_u32 vcc, s28, v120
    s_cbranch_vccz L_f_ok1
L_f_poll1:
    s_sleep 1
    ds_read_b32 v120, v121
    s_waitcnt lgkmcnt(0)
    v_cmp_gt_u32 vcc, s28, v120
    s_cbranch_vccnz L_f_poll1
L_f_ok1:
    ds_read_b128 v[124:127], v5 offset:3072
    ds_read_b64 v[128:129], v6 offset:768
    s_mov_b32 s28, 3
    v_add_u32 v123, 1, v123
    ds_write_b32 v122, v123
    v_cvt_pk_bf16_f32 v34, v36, v37
    v_cvt_pk_bf16_f32 v35, v38, v39
    v_exp_f32 v44, v44
    v_exp_f32 v45, v45
    v_exp_f32 v46, v46
    v_exp_f32 v47, v47
    s_waitcnt lgkmcnt(6)
    v_mfma_f32_32x32x16_bf16 v[64:79], v[24:27], v[32:35], v[64:79]
    v_cvt_pk_bf16_f32 v40, v40, v41
    v_cvt_pk_bf16_f32 v41, v42, v43
    v_exp_f32 v48, v48
    v_exp_f32 v49, v49
    v_cvt_pk_bf16_f32 v42, v44, v45
    v_cvt_pk_bf16_f32 v43, v46, v47
    v_exp_f32 v50, v50
    v_exp_f32 v51, v51
    v_mfma_f32_32x32x16_bf16 v[64:79], v[28:31], v[40:43], v[64:79]
    s_mov_b64 exec, s[22:23]
    ds_read_b128 v[24:27], v7 offset:2560
    ds_read_b128 v[28:31], v7 offset:3200
    s_mov_b64 exec, -1
    v_exp_f32 v52, v52
    v_exp_f32 v53, v53
    v_exp_f32 v54, v54
    v_exp_f32 v55, v55
    s_setprio 2
    s_waitcnt lgkmcnt(6)
    v_mfma_f32_32x32x16_bf16 v[32:47], v[16:19], v[8:11], v[80:95]
    v_exp_f32 v56, v56
    v_exp_f32 v57, v57
    v_cvt_pk_bf16_f32 v48, v48, v49
    v_cvt_pk_bf16_f32 v49, v50, v51
    v_exp_f32 v58, v58
    v_exp_f32 v59, v59
    v_mfma_f32_32x32x8_bf16 v[32:47], v[20:21], v[12:13], v[32:47]
    ds_read_b128 v[16:19], v5 offset:10240
    ds_read_b64 v[20:21], v6 offset:10240
    v_cvt_pk_bf16_f32 v50, v52, v53
    v_cvt_pk_bf16_f32 v51, v54, v55
    v_exp_f32 v60, v60
    v_exp_f32 v61, v61
    v_exp_f32 v62, v62
    v_exp_f32 v63, v63
    s_waitcnt lgkmcnt(6)
    v_mfma_f32_32x32x16_bf16 v[64:79], v[132:135], v[48:51], v[64:79]
    v_cvt_pk_bf16_f32 v56, v56, v57
    v_cvt_pk_bf16_f32 v57, v58, v59
    v_exp_f32 v32, v32
    v_exp_f32 v33, v33
    v_cvt_pk_bf16_f32 v58, v60, v61
    v_cvt_pk_bf16_f32 v59, v62, v63
    v_exp_f32 v34, v34
    v_exp_f32 v35, v35
    v_mfma_f32_32x32x16_bf16 v[64:79], v[136:139], v[56:59], v[64:79]
    s_mov_b64 exec, s[22:23]
    ds_read_b128 v[132:135], v7 offset:3840
    ds_read_b128 v[136:139], v7 offset:4480
    s_mov_b64 exec, -1
    s_cmp_lg_u32 s27, 1
    s_cbranch_scc1 L_f_nf
    s_cmp_lg_u32 s9, 0
    s_cbranch_scc1 L_f_hpl
    s_waitcnt vmcnt(0)
    s_mov_b64 exec, 1
    buffer_store_dword v122, off, s[32:35], s10 sc1
    s_mov_b64 exec, -1
    s_mov_b32 s9, 1
L_f_hpl:
L_f_nf:
    v_exp_f32 v36, v36
    v_exp_f32 v37, v37
    v_exp_f32 v38, v38
    v_exp_f32 v39, v39
    s_setprio 1
    s_waitcnt lgkmcnt(6)
    v_mfma_f32_32x32x16_bf16 v[48:63], v[124:127], v[8:11], v[80:95]
    v_exp_f32 v40, v40
    v_exp_f32 v41, v41
    v_cvt_pk_bf16_f32 v32, v32, v33
    v_cvt_pk_bf16_f32 v33, v34, v35
    v_exp_f32 v42, v42
    v_exp_f32 v43, v43
    v_mfma_f32_32x32x8_bf16 v[48:63], v[128:129], v[12:13], v[48:63]
    ds_read_b128 v[124:127], v5 offset:11264
    ds_read_b64 v[128:129], v6 offset:10496
    v_cvt_pk_bf16_f32 v34, v36, v37
    v_cvt_pk_bf16_f32 v35, v38, v39
    v_exp_f32 v44, v44
    v_exp_f32 v45, v45
    v_exp_f32 v46, v46
    v_exp_f32 v47, v47
    s_waitcnt lgkmcnt(6)
    v_mfma_f32_32x32x16_bf16 v[64:79], v[24:27], v[32:35], v[64:79]
    v_cvt_pk_bf16_f32 v40, v40, v41
    v_cvt_pk_bf16_f32 v41, v42, v43
    v_exp_f32 v48, v48
    v_exp_f32 v49, v49
    v_cvt_pk_bf16_f32 v42, v44, v45
    v_cvt_pk_bf16_f32 v43, v46, v47
    v_exp_f32 v50, v50
    v_exp_f32 v51, v51
    v_mfma_f32_32x32x16_bf16 v[64:79], v[28:31], v[40:43], v[64:79]
    s_mov_b64 exec, s[22:23]
    ds_read_b128 v[24:27], v7 offset:10240
    ds_read_b128 v[28:31], v7 offset:10880
    s_mov_b64 exec, -1
    v_exp_f32 v52, v52
    v_exp_f32 v53, v53
    v_exp_f32 v54, v54
    v_exp_f32 v55, v55
    s_setprio 0
    s_waitcnt lgkmcnt(6)
    v_mfma_f32_32x32x16_bf16 v[32:47], v[16:19], v[8:11], v[80:95]
    v_exp_f32 v56, v56
    v_exp_f32 v57, v57
    v_cvt_pk_bf16_f32 v48, v48, v49
    v_cvt_pk_bf16_f32 v49, v50, v51
    v_exp_f32 v58, v58
    v_exp_f32 v59, v59
    v_mfma_f32_32x32x8_bf16 v[32:47], v[20:21], v[12:13], v[32:47]
    ds_read_b128 v[16:19], v5 offset:12288
    ds_read_b64 v[20:21], v6 offset:10752
    v_cvt_pk_bf16_f32 v50, v52, v53
    v_cvt_pk_bf16_f32 v51, v54, v55
    v_exp_f32 v60, v60
    v_exp_f32 v61, v61
    v_exp_f32 v62, v62
    v_exp_f32 v63, v63
    s_waitcnt lgkmcnt(6)
    v_mfma_f32_32x32x16_bf16 v[64:79], v[132:135], v[48:51], v[64:79]
    v_cvt_pk_bf16_f32 v56, v56, v57
    v_cvt_pk_bf16_f32 v57, v58, v59
    v_exp_f32 v32, v32
    v_exp_f32 v33, v33
    v_cvt_pk_bf16_f32 v58, v60, v61
    v_cvt_pk_bf16_f32 v59, v62, v63
    v_exp_f32 v34, v34
    v_exp_f32 v35, v35
    v_mfma_f32_32x32x16_bf16 v[64:79], v[136:139], v[56:59], v[64:79]
    s_mov_b64 exec, s[22:23]
    ds_read_b128 v[132:135], v7 offset:11520
    ds_read_b128 v[136:139], v7 offset:12160
    s_mov_b64 exec, -1
    v_exp_f32 v36, v36
    v_exp_f32 v37, v37
    v_exp_f32 v38, v38
    v_exp_f32 v39, v39
    s_setprio 3
    s_waitcnt lgkmcnt(6)
    v_mfma_f32_32x32x16_bf16 v[48:63], v[124:127], v[8:11], v[80:95]
    v_exp_f32 v40, v40
    v_exp_f32 v41, v41
    v_cvt_pk_bf16_f32 v32, v32, v33
    v_cvt_pk_bf16_f32 v33, v34, v35
    v_exp_f32 v42, v42
    v_exp_f32 v43, v43
    v_mfma_f32_32x32x8_bf16 v[48:63], v[128:129], v[12:13], v[48:63]
    ds_read_b128 v[124:127], v5 offset:13312
    ds_read_b64 v[128:129], v6 offset:11008
    v_add_u32 v123, 1, v123
    ds_write_b32 v122, v123
    s_cmp_lg_u32 s27, 7
    s_cbranch_scc1 L_f_nh
    s_waitcnt vmcnt(0)
    s_mov_b64 exec, 1
    buffer_store_dword v122, off, s[44:47], s61 sc1
    s_mov_b64 exec, -1
L_f_nh:
    v_cvt_pk_bf16_f32 v34, v36, v37
    v_cvt_pk_bf16_f32 v35, v38, v39
    v_exp_f32 v44, v44
    v_exp_f32 v45, v45
    v_exp_f32 v46, v46
    v_exp_f32 v47, v47
    s_waitcnt lgkmcnt(6)
    v_mfma_f32_32x32x16_bf16 v[64:79], v[24:27], v[32:35], v[64:79]
    v_cvt_pk_bf16_f32 v40, v40, v41
    v_cvt_pk_bf16_f32 v41, v42, v43
    v_exp_f32 v48, v48
    v_exp_f32 v49, v49
    v_cvt_pk_bf16_f32 v42, v44, v45
    v_cvt_pk_bf16_f32 v43, v46, v47
    v_exp_f32 v50, v50
    v_exp_f32 v51, v51
    v_mfma_f32_32x32x16_bf16 v[64:79], v[28:31], v[40:43], v[64:79]
    s_mov_b64 exec, s[22:23]
    ds_read_b128 v[24:27], v7 offset:12800
    ds_read_b128 v[28:31], v7 offset:13440
    s_mov_b64 exec, -1
    v_exp_f32 v52, v52
    v_exp_f32 v53, v53
    v_exp_f32 v54, v54
    v_exp_f32 v55, v55
    s_setprio 2
    s_waitcnt lgkmcnt(6)
    v_mfma_f32_32x32x16_bf16 v[32:47], v[16:19], v[8:11], v[80:95]
    v_exp_f32 v56, v56
    v_exp_f32 v57, v57
    v_cvt_pk_bf16_f32 v48, v48, v49
    v_cvt_pk_bf16_f32 v49, v50, v51
    v_exp_f32 v58, v58
    v_exp_f32 v59, v59
    v_mfma_f32_32x32x8_bf16 v[32:47], v[20:21], v[12:13], v[32:47]
    ds_read_b128 v[16:19], v5 offset:20480
    ds_read_b64 v[20:21], v6 offset:20480
    s_cmp_lg_u32 s27, 3
    s_cbranch_scc1 L_f_no
    v_lshlrev_b32 v1, 4, v2
    v_lshlrev_b32 v0, 3, v4
    buffer_store_dwordx4 v[164:167], v1, s[44:47], s60 offen sc1
    buffer_store_dwordx2 v[164:165], v0, s[44:47], s60 offen offset:1024 sc1
L_f_no:
    v_cvt_pk_bf16_f32 v50, v52, v53
    v_cvt_pk_bf16_f32 v51, v54, v55
    v_exp_f32 v60, v60
    v_exp_f32 v61, v61
    v_exp_f32 v62, v62
    v_exp_f32 v63, v63
    s_waitcnt lgkmcnt(6)
    v_mfma_f32_32x32x16_bf16 v[64:79], v[132:135], v[48:51], v[64:79]
    v_cvt_pk_bf16_f32 v56, v56, v57
    v_cvt_pk_bf16_f32 v57, v58, v59
    v_exp_f32 v32, v32
    v_exp_f32 v33, v33
    v_cvt_pk_bf16_f32 v58, v60, v61
    v_cvt_pk_bf16_f32 v59, v62, v63
    v_exp_f32 v34, v34
    v_exp_f32 v35, v35
    v_mfma_f32_32x32x16_bf16 v[64:79], v[136:139], v[56:59], v[64:79]
    s_mov_b64 exec, s[22:23]
    ds_read_b128 v[132:135], v7 offset:14080
    ds_read_b128 v[136:139], v7 offset:14720
    s_mov_b64 exec, -1
    v_exp_f32 v36, v36
    v_exp_f32 v37, v37
    v_exp_f32 v38, v38
    v_exp_f32 v39, v39
    s_setprio 1
    s_waitcnt lgkmcnt(6)
    v_mfma_f32_32x32x16_bf16 v[48:63], v[124:127], v[8:11], v[80:95]
    v_exp_f32 v40, v40
    v_exp_f32 v41, v41
    v_cvt_pk_bf16_f32 v32, v32, v33
    v_cvt_pk_bf16_f32 v33, v34, v35
    v_exp_f32 v42, v42
    v_exp_f32 v43, v43
    v_mfma_f32_32x32x8_bf16 v[48:63], v[128:129], v[12:13], v[48:63]
    ds_read_b128 v[124:127], v5 offset:21504
    ds_read_b64 v[128:129], v6 offset:20736
    v_cvt_pk_bf16_f32 v34, v36, v37
    v_cvt_pk_bf16_f32 v35, v38, v39
    v_exp_f32 v44, v44
    v_exp_f32 v45, v45
    v_exp_f32 v46, v46
    v_exp_f32 v47, v47
    s_waitcnt lgkmcnt(6)
    v_mfma_f32_32x32x16_bf16 v[64:79], v[24:27], v[32:35], v[64:79]
    v_cvt_pk_bf16_f32 v40, v40, v41
    v_cvt_pk_bf16_f32 v41, v42, v43
    v_exp_f32 v48, v48
    v_exp_f32 v49, v49
    v_cvt_pk_bf16_f32 v42, v44, v45
    v_cvt_pk_bf16_f32 v43, v46, v47
    v_exp_f32 v50, v50
    v_exp_f32 v51, v51
    v_mfma_f32_32x32x16_bf16 v[64:79], v[28:31], v[40:43], v[64:79]
    s_mov_b64 exec, s[22:23]
    ds_read_b128 v[24:27], v7 offset:20480
    ds_read_b128 v[28:31], v7 offset:21120
    s_mov_b64 exec, -1
    v_exp_f32 v52, v52
    v_exp_f32 v53, v53
    v_exp_f32 v54, v54
    v_exp_f32 v55, v55
    s_setprio 0
    s_waitcnt lgkmcnt(6)
    v_mfma_f32_32x32x16_bf16 v[32:47], v[16:19], v[8:11], v[80:95]
    v_exp_f32 v56, v56
    v_exp_f32 v57, v57
    v_cvt_pk_bf16_f32 v48, v48, v49
    v_cvt_pk_bf16_f32 v49, v50, v51
    v_exp_f32 v58, v58
    v_exp_f32 v59, v59
    v_mfma_f32_32x32x8_bf16 v[32:47], v[20:21], v[12:13], v[32:47]
    ds_read_b128 v[16:19], v5 offset:22528
    ds_read_b64 v[20:21], v6 offset:20992
    ds_read_b32 v120, v121
    v_cvt_pk_bf16_f32 v50, v52, v53
    v_cvt_pk_bf16_f32 v51, v54, v55
    v_exp_f32 v60, v60
    v_exp_f32 v61, v61
    v_exp_f32 v62, v62
    v_exp_f32 v63, v63
    s_waitcnt lgkmcnt(6)
    v_mfma_f32_32x32x16_bf16 v[64:79], v[132:135], v[48:51], v[64:79]
    v_cvt_pk_bf16_f32 v56, v56, v57
    v_cvt_pk_bf16_f32 v57, v58, v59
    v_exp_f32 v32, v32
    v_exp_f32 v33, v33
    v_cvt_pk_bf16_f32 v58, v60, v61
    v_cvt_pk_bf16_f32 v59, v62, v63
    v_exp_f32 v34, v34
    v_exp_f32 v35, v35
    v_mfma_f32_32x32x16_bf16 v[64:79], v[136:139], v[56:59], v[64:79]
    s_mov_b64 exec, s[22:23]
    ds_read_b128 v[132:135], v7 offset:21760
    ds_read_b128 v[136:139], v7 offset:22400
    s_mov_b64 exec, -1
    v_exp_f32 v36, v36
    v_exp_f32 v37, v37
    v_exp_f32 v38, v38
    v_exp_f32 v39, v39
    v_add_u32 v5, 20480, v5
    v_add_u32 v6, 20480, v6
    v_add_u32 v7, 20480, v7
    s_add_u32 s27, s27, 1
    s_cmp_lt_u32 s27, 8
    s_cbranch_scc1 L_f_loop
    v_mov_b32 v123, 16
    ds_write_b32 v122, v123
    v_mov_b32 v1, 0
    s_movk_i32 s26, 0x207
    v_fma_f32 v1, v64, 0, v1
    v_fma_f32 v1, v65, 0, v1
    v_fma_f32 v1, v66, 0, v1
    v_fma_f32 v1, v67, 0, v1
    v_fma_f32 v1, v68, 0, v1
    v_fma_f32 v1, v69, 0, v1
    v_fma_f32 v1, v70, 0, v1
    v_fma_f32 v1, v71, 0, v1
    v_fma_f32 v1, v72, 0, v1
    v_fma_f32 v1, v73, 0, v1
    v_fma_f32 v1, v74, 0, v1
    v_fma_f32 v1, v75, 0, v1
    v_cmp_class_f32 vcc, v1, s26
    s_cbranch_vccnz L_f_fb
L_f_epi:
    v_mov_b32 v10, 0
    ds_read_b64 v[12:13], v10 offset:96
    v_mov_b32 v14, v72
    v_mov_b32 v15, v72
    v_lshlrev_b32 v5, 4, v2
    s_nop 0
    v_permlane32_swap_b32 v14, v15
    v_rcp_f32 v14, v15
    v_lshlrev_b32 v6, 3, v4
    v_mov_b32 v11, v121
    v_pk_mul_f32 v[64:65], v[64:65], v[14:15] op_sel_hi:[1,0]
    v_pk_mul_f32 v[66:67], v[66:67], v[14:15] op_sel_hi:[1,0]
    v_pk_mul_f32 v[68:69], v[68:69], v[14:15] op_sel_hi:[1,0]
    v_pk_mul_f32 v[70:71], v[70:71], v[14:15] op_sel_hi:[1,0]
    v_pk_mul_f32 v[72:73], v[72:73], v[14:15] op_sel_hi:[1,0]
    v_pk_mul_f32 v[74:75], v[74:75], v[14:15] op_sel_hi:[1,0]
    v_cvt_pk_bf16_f32 v64, v64, v65
    v_cvt_pk_bf16_f32 v65, v66, v67
    v_cvt_pk_bf16_f32 v66, v68, v69
    v_cvt_pk_bf16_f32 v67, v70, v71
    v_cvt_pk_bf16_f32 v68, v72, v73
    v_cvt_pk_bf16_f32 v69, v74, v75
    buffer_store_dwordx4 v[64:67], v5, s[44:47], s60 offen sc1
    s_mov_b64 exec, s[24:25]
    buffer_store_dwordx2 v[68:69], v6, s[44:47], s60 offen offset:1024 sc1
    s_mov_b64 exec, -1
    s_setprio 0
    v_mul_u32_u24 v14, 2560, v3
    s_add_u32 s28, s57, 5120
    s_waitcnt lgkmcnt(0)
    v_readfirstlane_b32 s30, v12
    v_readfirstlane_b32 s31, v13
    v_lshl_add_u32 v8, v4, 3, v14
    s_lshr_b64 s[30:31], s[30:31], s56
    s_mov_b32 s63, s30
    s_mov_b32 s64, 0
    s_bitcmp1_b32 s63, 0
    s_cbranch_scc0 L_f_su
    buffer_load_dwordx4 v[16:19], v5, s[44:47], s57 offen offset:0 sc1
    s_mov_b32 s64, 1
    s_bitcmp1_b32 s63, 1
    s_cbranch_scc0 L_f_su
    buffer_load_dwordx4 v[20:23], v5, s[44:47], s57 offen offset:1280 sc1
    s_mov_b32 s64, 2
    s_bitcmp1_b32 s63, 2
    s_cbranch_scc0 L_f_su
    buffer_load_dwordx4 v[24:27], v5, s[44:47], s57 offen offset:2560 sc1
    s_mov_b32 s64, 3
    s_bitcmp1_b32 s63, 3
    s_cbranch_scc0 L_f_su
    buffer_load_dwordx4 v[28:31], v5, s[44:47], s57 offen offset:3840 sc1
    s_mov_b32 s64, 4
    s_bitcmp1_b32 s63, 4
    s_cbranch_scc0 L_f_su
    buffer_load_dwordx4 v[32:35], v5, s[44:47], s28 offen offset:0 sc1
    s_mov_b32 s64, 5
    s_bitcmp1_b32 s63, 5
    s_cbranch_scc0 L_f_su
    buffer_load_dwordx4 v[36:39], v5, s[44:47], s28 offen offset:1280 sc1
    s_mov_b32 s64, 6
    s_bitcmp1_b32 s63, 6
    s_cbranch_scc0 L_f_su
    buffer_load_dwordx4 v[40:43], v5, s[44:47], s28 offen offset:2560 sc1
    s_mov_b32 s64, 7
    s_bitcmp1_b32 s63, 7
    s_cbranch_scc0 L_f_su
    buffer_load_dwordx4 v[44:47], v5, s[44:47], s28 offen offset:3840 sc1
    buffer_load_dwordx2 v[48:49], v8, s[44:47], s57 offen offset:1024 sc1
    buffer_load_dwordx2 v[50:51], v8, s[44:47], s57 offen offset:2304 sc1
    buffer_load_dwordx2 v[52:53], v8, s[44:47], s28 offen offset:1024 sc1
    buffer_load_dwordx2 v[54:55], v8, s[44:47], s28 offen offset:2304 sc1
    s_mov_b32 s64, 9
L_f_su:
    ds_read_b32 v1, v11
    v_mul_u32_u24 v12, 1280, v4
    v_bfe_u32 v13, v2, 2, 2
    v_and_b32 v7, 3, v2
    v_lshl_add_u32 v9, v3, 3, v12
    v_lshlrev_b32 v13, 6, v13
    v_lshl_add_u32 v13, v7, 3, v13
    v_bfe_u32 v12, v2, 4, 1
    v_lshlrev_b32 v7, 3, v7
    v_sub_u32 v13, v13, v7
    v_lshl_add_u32 v7, v12, 5, v7
    s_lshl_b32 s30, s54, 4
    v_add_u32 v7, s30, v7
    v_and_b32 v7, 63, v7
    v_add_u32 v13, v13, v7
    v_add_u32 v13, s58, v13
    v_lshl_add_u32 v6, v3, 8, v13
    v_add_u32 v7, v14, v13
    s_sub_u32 s26, s54, 1
    v_sub_u32 v14, s26, v2
    v_and_b32 v14, 3, v14
    s_lshl_b32 s26, s52, 4
    s_add_u32 s26, s26, 128
    v_lshl_add_u32 v15, v14, 2, s26
    s_lshl_b32 s27, s54, 2
    s_add_u32 s27, s27, s26
    s_mov_b32 s62, 300000
    v_add_u32 v12, s59, v5
    s_lshl_b32 s30, s54, 2
    v_mov_b32 v13, s30
L_f_lw0:
    s_waitcnt lgkmcnt(0)
    v_cmp_gt_u32 vcc, 6, v1
    s_cbranch_vccz L_f_lwd0
    s_sleep 2
    ds_read_b32 v1, v11
    s_branch L_f_lw0
L_f_lwd0:
    s_cmp_lg_u32 s52, 0
    s_cbranch_scc1 L_f_tB
    ds_read_b64_tr_b16 v[104:105], v6 offset:0
    ds_read_b64_tr_b16 v[106:107], v6 offset:512
    ds_read_b64_tr_b16 v[108:109], v6 offset:10240
    ds_read_b64_tr_b16 v[110:111], v6 offset:10752
    ds_read_b64_tr_b16 v[112:113], v6 offset:20480
    ds_read_b64_tr_b16 v[114:115], v6 offset:20992
    ds_read_b64_tr_b16 v[116:117], v6 offset:1280
    ds_read_b64_tr_b16 v[118:119], v6 offset:1792
    ds_read_b64_tr_b16 v[120:121], v6 offset:11520
    ds_read_b64_tr_b16 v[122:123], v6 offset:12032
    ds_read_b64_tr_b16 v[124:125], v6 offset:21760
    ds_read_b64_tr_b16 v[126:127], v6 offset:22272
    ds_read_b64_tr_b16 v[128:129], v6 offset:2560
    ds_read_b64_tr_b16 v[130:131], v6 offset:3072
    ds_read_b64_tr_b16 v[132:133], v6 offset:12800
    ds_read_b64_tr_b16 v[134:135], v6 offset:13312
    ds_read_b64_tr_b16 v[136:137], v6 offset:23040
    ds_read_b64_tr_b16 v[138:139], v6 offset:23552
    ds_read_b64_tr_b16 v[140:141], v6 offset:3840
    ds_read_b64_tr_b16 v[142:143], v6 offset:4352
    ds_read_b64_tr_b16 v[144:145], v6 offset:14080
    ds_read_b64_tr_b16 v[146:147], v6 offset:14592
    ds_read_b64_tr_b16 v[148:149], v6 offset:24320
    ds_read_b64_tr_b16 v[150:151], v6 offset:24832
    ds_read_b64_tr_b16 v[152:153], v6 offset:5120
    ds_read_b64_tr_b16 v[154:155], v6 offset:5632
    ds_read_b64_tr_b16 v[156:157], v6 offset:15360
    ds_read_b64_tr_b16 v[158:159], v6 offset:15872
    ds_read_b64_tr_b16 v[160:161], v6 offset:25600
    ds_read_b64_tr_b16 v[162:163], v6 offset:26112
    s_add_u32 s32, s58, 20480
    s_sub_u32 s30, s54, 1
    s_and_b32 s30, s30, 3
    s_mul_i32 s30, s30, 30720
    s_add_u32 s36, s30, 21504
    s_sub_u32 s30, s54, 2
    s_and_b32 s30, s30, 3
    s_mul_i32 s30, s30, 30720
    s_add_u32 s37, s30, 24576
    s_sub_u32 s30, s54, 3
    s_and_b32 s30, s30, 3
    s_mul_i32 s30, s30, 30720
    s_add_u32 s38, s30, 27648
    s_add_u32 s33, s55, s53
    s_add_u32 s34, s33, s53
    s_mov_b32 s35, 0
    v_mov_b32 v56, 0
    v_mov_b32 v57, 0
    v_mov_b32 v58, 0
    v_mov_b32 v59, 0
    v_mov_b32 v60, 0
    v_mov_b32 v61, 0
    v_mov_b32 v62, 0
    v_mov_b32 v63, 0
    v_mov_b32 v64, 0
    v_mov_b32 v65, 0
    v_mov_b32 v66, 0
    v_mov_b32 v67, 0
    v_mov_b32 v68, 0
    v_mov_b32 v69, 0
    v_mov_b32 v70, 0
    v_mov_b32 v71, 0
    v_mov_b32 v72, 0
    v_mov_b32 v73, 0
    v_mov_b32 v74, 0
    v_mov_b32 v75, 0
    v_mov_b32 v76, 0
    v_mov_b32 v77, 0
    v_mov_b32 v78, 0
    v_mov_b32 v79, 0
    v_mov_b32 v80, 0
    v_mov_b32 v81, 0
    v_mov_b32 v82, 0
    v_mov_b32 v83, 0
    v_mov_b32 v84, 0
    v_mov_b32 v85, 0
    v_mov_b32 v86, 0
    v_mov_b32 v87, 0
    v_mov_b32 v88, 0
    v_mov_b32 v89, 0
    v_mov_b32 v90, 0
    v_mov_b32 v91, 0
    v_mov_b32 v92, 0
    v_mov_b32 v93, 0
    v_mov_b32 v94, 0
    v_mov_b32 v95, 0
    v_mov_b32 v96, 0
    v_mov_b32 v97, 0
    v_mov_b32 v98, 0
    v_mov_b32 v99, 0
    v_mov_b32 v100, 0
    v_mov_b32 v101, 0
    v_mov_b32 v102, 0
    v_mov_b32 v103, 0
    s_cmp_eq_u32 s64, 9
    s_cbranch_scc1 L_f_idA
    s_cmp_gt_u32 s64, 0
    s_cbranch_scc1 L_f_isA0n
    s_bitcmp1_b32 s63, 0
    s_cbranch_scc1 L_f_isA0g
L_f_isA0p:
    ds_read_b64 v[0:1], v10 offset:96
    s_waitcnt lgkmcnt(0)
    v_readfirstlane_b32 s30, v0
    v_readfirstlane_b32 s31, v1
    s_lshr_b64 s[30:31], s[30:31], s56
    s_mov_b32 s63, s30
    s_bitcmp1_b32 s30, 0
    s_cbranch_scc1 L_f_isA0g
    s_sleep 1
    s_branch L_f_isA0p
L_f_isA0g:
    buffer_load_dwordx4 v[16:19], v5, s[44:47], s57 offen offset:0 sc1
L_f_isA0n:
    s_cmp_gt_u32 s64, 1
    s_cbranch_scc1 L_f_isA1n
    s_bitcmp1_b32 s63, 1
    s_cbranch_scc1 L_f_isA1g
L_f_isA1p:
    ds_read_b64 v[0:1], v10 offset:96
    s_waitcnt lgkmcnt(0)
    v_readfirstlane_b32 s30, v0
    v_readfirstlane_b32 s31, v1
    s_lshr_b64 s[30:31], s[30:31], s56
    s_mov_b32 s63, s30
    s_bitcmp1_b32 s30, 1
    s_cbranch_scc1 L_f_isA1g
    s_sleep 1
    s_branch L_f_isA1p
L_f_isA1g:
    buffer_load_dwordx4 v[20:23], v5, s[44:47], s57 offen offset:1280 sc1
L_f_isA1n:
    s_cmp_gt_u32 s64, 2
    s_cbranch_scc1 L_f_isA2n
    s_bitcmp1_b32 s63, 2
    s_cbranch_scc1 L_f_isA2g
L_f_isA2p:
    ds_read_b64 v[0:1], v10 offset:96
    s_waitcnt lgkmcnt(0)
    v_readfirstlane_b32 s30, v0
    v_readfirstlane_b32 s31, v1
    s_lshr_b64 s[30:31], s[30:31], s56
    s_mov_b32 s63, s30
    s_bitcmp1_b32 s30, 2
    s_cbranch_scc1 L_f_isA2g
    s_sleep 1
    s_branch L_f_isA2p
L_f_isA2g:
    buffer_load_dwordx4 v[24:27], v5, s[44:47], s57 offen offset:2560 sc1
L_f_isA2n:
    s_cmp_gt_u32 s64, 3
    s_cbranch_scc1 L_f_isA3n
    s_bitcmp1_b32 s63, 3
    s_cbranch_scc1 L_f_isA3g
L_f_isA3p:
    ds_read_b64 v[0:1], v10 offset:96
    s_waitcnt lgkmcnt(0)
    v_readfirstlane_b32 s30, v0
    v_readfirstlane_b32 s31, v1
    s_lshr_b64 s[30:31], s[30:31], s56
    s_mov_b32 s63, s30
    s_bitcmp1_b32 s30, 3
    s_cbranch_scc1 L_f_isA3g
    s_sleep 1
    s_branch L_f_isA3p
L_f_isA3g:
    buffer_load_dwordx4 v[28:31], v5, s[44:47], s57 offen offset:3840 sc1
L_f_isA3n:
    s_cmp_gt_u32 s64, 4
    s_cbranch_scc1 L_f_isA4n
    s_bitcmp1_b32 s63, 4
    s_cbranch_scc1 L_f_isA4g
L_f_isA4p:
    ds_read_b64 v[0:1], v10 offset:96
    s_waitcnt lgkmcnt(0)
    v_readfirstlane_b32 s30, v0
    v_readfirstlane_b32 s31, v1
    s_lshr_b64 s[30:31], s[30:31], s56
    s_mov_b32 s63, s30
    s_bitcmp1_b32 s30, 4
    s_cbranch_scc1 L_f_isA4g
    s_sleep 1
    s_branch L_f_isA4p
L_f_isA4g:
    buffer_load_dwordx4 v[32:35], v5, s[44:47], s28 offen offset:0 sc1
L_f_isA4n:
    s_cmp_gt_u32 s64, 5
    s_cbranch_scc1 L_f_isA5n
    s_bitcmp1_b32 s63, 5
    s_cbranch_scc1 L_f_isA5g
L_f_isA5p:
    ds_read_b64 v[0:1], v10 offset:96
    s_waitcnt lgkmcnt(0)
    v_readfirstlane_b32 s30, v0
    v_readfirstlane_b32 s31, v1
    s_lshr_b64 s[30:31], s[30:31], s56
    s_mov_b32 s63, s30
    s_bitcmp1_b32 s30, 5
    s_cbranch_scc1 L_f_isA5g
    s_sleep 1
    s_branch L_f_isA5p
L_f_isA5g:
    buffer_load_dwordx4 v[36:39], v5, s[44:47], s28 offen offset:1280 sc1
L_f_isA5n:
    s_cmp_gt_u32 s64, 6
    s_cbranch_scc1 L_f_isA6n
    s_bitcmp1_b32 s63, 6
    s_cbranch_scc1 L_f_isA6g
L_f_isA6p:
    ds_read_b64 v[0:1], v10 offset:96
    s_waitcnt lgkmcnt(0)
    v_readfirstlane_b32 s30, v0
    v_readfirstlane_b32 s31, v1
    s_lshr_b64 s[30:31], s[30:31], s56
    s_mov_b32 s63, s30
    s_bitcmp1_b32 s30, 6
    s_cbranch_scc1 L_f_isA6g
    s_sleep 1
    s_branch L_f_isA6p
L_f_isA6g:
    buffer_load_dwordx4 v[40:43], v5, s[44:47], s28 offen offset:2560 sc1
L_f_isA6n:
    s_cmp_gt_u32 s64, 7
    s_cbranch_scc1 L_f_isA7n
    s_bitcmp1_b32 s63, 7
    s_cbranch_scc1 L_f_isA7g
L_f_isA7p:
    ds_read_b64 v[0:1], v10 offset:96
    s_waitcnt lgkmcnt(0)
    v_readfirstlane_b32 s30, v0
    v_readfirstlane_b32 s31, v1
    s_lshr_b64 s[30:31], s[30:31], s56
    s_mov_b32 s63, s30
    s_bitcmp1_b32 s30, 7
    s_cbranch_scc1 L_f_isA7g
    s_sleep 1
    s_branch L_f_isA7p
L_f_isA7g:
    buffer_load_dwordx4 v[44:47], v5, s[44:47], s28 offen offset:3840 sc1
L_f_isA7n:
    buffer_load_dwordx2 v[48:49], v8, s[44:47], s57 offen offset:1024 sc1
    buffer_load_dwordx2 v[50:51], v8, s[44:47], s57 offen offset:2304 sc1
    buffer_load_dwordx2 v[52:53], v8, s[44:47], s28 offen offset:1024 sc1
    buffer_load_dwordx2 v[54:55], v8, s[44:47], s28 offen offset:2304 sc1
L_f_idA:
    ds_read_b32 v1, v13
L_f_lw1:
    s_waitcnt lgkmcnt(0)
    v_cmp_gt_u32 vcc, 7, v1
    s_cbranch_vccz L_f_lwd1
    s_sleep 2
    ds_read_b32 v1, v13
    s_branch L_f_lw1
L_f_lwd1:
    ds_read_b128 v[56:59], v12 offset:2048
    ds_read_b128 v[72:75], v12 offset:3072
    ds_read_b128 v[88:91], v12 offset:4096
    s_waitcnt lgkmcnt(0)
    s_waitcnt vmcnt(11)
L_f_ckA0:
    v_max3_u32 v1, v16, v17, v18
    v_max_u32 v1, v1, v19
    v_cmp_eq_u32 vcc, -1, v1
    s_cbranch_vccnz L_f_rtA0
L_f_bkA0:
    v_mfma_f32_32x32x16_bf16 v[56:71], v[104:107], v[16:19], v[56:71]
    v_mfma_f32_32x32x16_bf16 v[72:87], v[108:111], v[16:19], v[72:87]
    ds_read_b64_tr_b16 v[104:105], v6 offset:6400
    ds_read_b64_tr_b16 v[106:107], v6 offset:6912
    v_mfma_f32_32x32x16_bf16 v[88:103], v[112:115], v[16:19], v[88:103]
    ds_read_b64_tr_b16 v[108:109], v6 offset:16640
    ds_read_b64_tr_b16 v[110:111], v6 offset:17152
    ds_read_b64_tr_b16 v[112:113], v6 offset:26880
    ds_read_b64_tr_b16 v[114:115], v6 offset:27392
    s_waitcnt vmcnt(10)
L_f_ckA1:
    v_max3_u32 v1, v20, v21, v22
    v_max_u32 v1, v1, v23
    v_cmp_eq_u32 vcc, -1, v1
    s_cbranch_vccnz L_f_rtA1
L_f_bkA1:
    v_mfma_f32_32x32x16_bf16 v[56:71], v[116:119], v[20:23], v[56:71]
    v_mfma_f32_32x32x16_bf16 v[72:87], v[120:123], v[20:23], v[72:87]
    ds_read_b64_tr_b16 v[116:117], v6 offset:7680
    ds_read_b64_tr_b16 v[118:119], v6 offset:8192
    v_mfma_f32_32x32x16_bf16 v[88:103], v[124:127], v[20:23], v[88:103]
    ds_read_b64_tr_b16 v[120:121], v6 offset:17920
    ds_read_b64_tr_b16 v[122:123], v6 offset:18432
    ds_read_b64_tr_b16 v[124:125], v6 offset:28160
    ds_read_b64_tr_b16 v[126:127], v6 offset:28672
    s_waitcnt vmcnt(9)
L_f_ckA2:
    v_max3_u32 v1, v24, v25, v26
    v_max_u32 v1, v1, v27
    v_cmp_eq_u32 vcc, -1, v1
    s_cbranch_vccnz L_f_rtA2
L_f_bkA2:
    v_mfma_f32_32x32x16_bf16 v[56:71], v[128:131], v[24:27], v[56:71]
    v_mfma_f32_32x32x16_bf16 v[72:87], v[132:135], v[24:27], v[72:87]
    ds_read_b64_tr_b16 v[128:129], v6 offset:8960
    ds_read_b64_tr_b16 v[130:131], v6 offset:9472
    v_mfma_f32_32x32x16_bf16 v[88:103], v[136:139], v[24:27], v[88:103]
    ds_read_b64_tr_b16 v[132:133], v6 offset:19200
    ds_read_b64_tr_b16 v[134:135], v6 offset:19712
    ds_read_b64_tr_b16 v[136:137], v6 offset:29440
    ds_read_b64_tr_b16 v[138:139], v6 offset:29952
    s_waitcnt vmcnt(8)
L_f_ckA3:
    v_max3_u32 v1, v28, v29, v30
    v_max_u32 v1, v1, v31
    v_cmp_eq_u32 vcc, -1, v1
    s_cbranch_vccnz L_f_rtA3
L_f_bkA3:
    v_mfma_f32_32x32x16_bf16 v[56:71], v[140:143], v[28:31], v[56:71]
    v_mfma_f32_32x32x16_bf16 v[72:87], v[144:147], v[28:31], v[72:87]
    ds_read_b64_tr_b16 v[140:141], v7 offset:1024
    ds_read_b64_tr_b16 v[142:143], v7 offset:2304
    v_mfma_f32_32x32x16_bf16 v[88:103], v[148:151], v[28:31], v[88:103]
    ds_read_b64_tr_b16 v[144:145], v7 offset:11264
    ds_read_b64_tr_b16 v[146:147], v7 offset:12544
    ds_read_b64_tr_b16 v[148:149], v7 offset:21504
    ds_read_b64_tr_b16 v[150:151], v7 offset:22784
    s_waitcnt vmcnt(7)
L_f_ckA4:
    v_max3_u32 v1, v32, v33, v34
    v_max_u32 v1, v1, v35
    v_cmp_eq_u32 vcc, -1, v1
    s_cbranch_vccnz L_f_rtA4
L_f_bkA4:
    v_mfma_f32_32x32x16_bf16 v[56:71], v[152:155], v[32:35], v[56:71]
    v_mfma_f32_32x32x16_bf16 v[72:87], v[156:159], v[32:35], v[72:87]
    ds_read_b64_tr_b16 v[152:153], v7 offset:6144
    ds_read_b64_tr_b16 v[154:155], v7 offset:7424
    v_mfma_f32_32x32x16_bf16 v[88:103], v[160:163], v[32:35], v[88:103]
    ds_read_b64_tr_b16 v[156:157], v7 offset:16384
    ds_read_b64_tr_b16 v[158:159], v7 offset:17664
    ds_read_b64_tr_b16 v[160:161], v7 offset:26624
    ds_read_b64_tr_b16 v[162:163], v7 offset:27904
    s_waitcnt vmcnt(6)
L_f_ckA5:
    v_max3_u32 v1, v36, v37, v38
    v_max_u32 v1, v1, v39
    v_cmp_eq_u32 vcc, -1, v1
    s_cbranch_vccnz L_f_rtA5
L_f_bkA5:
    s_waitcnt lgkmcnt(15)
    v_mfma_f32_32x32x16_bf16 v[56:71], v[104:107], v[36:39], v[56:71]
    s_waitcnt lgkmcnt(15)
    v_mfma_f32_32x32x16_bf16 v[72:87], v[108:111], v[36:39], v[72:87]
    s_waitcnt lgkmcnt(15)
    v_mfma_f32_32x32x16_bf16 v[88:103], v[112:115], v[36:39], v[88:103]
    s_waitcnt vmcnt(5)
L_f_ckA6:
    v_max3_u32 v1, v40, v41, v42
    v_max_u32 v1, v1, v43
    v_cmp_eq_u32 vcc, -1, v1
    s_cbranch_vccnz L_f_rtA6
L_f_bkA6:
    s_waitcnt lgkmcnt(15)
    v_mfma_f32_32x32x16_bf16 v[56:71], v[116:119], v[40:43], v[56:71]
    s_waitcnt lgkmcnt(15)
    v_mfma_f32_32x32x16_bf16 v[72:87], v[120:123], v[40:43], v[72:87]
    s_waitcnt lgkmcnt(15)
    v_mfma_f32_32x32x16_bf16 v[88:103], v[124:127], v[40:43], v[88:103]
    s_waitcnt vmcnt(4)
L_f_ckA7:
    v_max3_u32 v1, v44, v45, v46
    v_max_u32 v1, v1, v47
    v_cmp_eq_u32 vcc, -1, v1
    s_cbranch_vccnz L_f_rtA7
L_f_bkA7:
    s_waitcnt lgkmcnt(15)
    v_mfma_f32_32x32x16_bf16 v[56:71], v[128:131], v[44:47], v[56:71]
    s_waitcnt lgkmcnt(14)
    v_mfma_f32_32x32x16_bf16 v[72:87], v[132:135], v[44:47], v[72:87]
    s_waitcnt lgkmcnt(12)
    v_mfma_f32_32x32x16_bf16 v[88:103], v[136:139], v[44:47], v[88:103]
    s_waitcnt vmcnt(2)
L_f_ckA8:
    v_max3_u32 v1, v48, v49, v50
    v_max_u32 v1, v1, v51
    v_cmp_eq_u32 vcc, -1, v1
    s_cbranch_vccnz L_f_rtA8
L_f_bkA8:
    s_waitcnt lgkmcnt(10)
    v_mfma_f32_32x32x16_bf16 v[56:71], v[140:143], v[48:51], v[56:71]
    s_waitcnt lgkmcnt(8)
    v_mfma_f32_32x32x16_bf16 v[72:87], v[144:147], v[48:51], v[72:87]
    s_waitcnt lgkmcnt(6)
    v_mfma_f32_32x32x16_bf16 v[88:103], v[148:151], v[48:51], v[88:103]
    s_waitcnt vmcnt(0)
L_f_ckA9:
    v_max3_u32 v1, v52, v53, v54
    v_max_u32 v1, v1, v55
    v_cmp_eq_u32 vcc, -1, v1
    s_cbranch_vccnz L_f_rtA9
L_f_bkA9:
    s_waitcnt lgkmcnt(4)
    v_mfma_f32_32x32x16_bf16 v[56:71], v[152:155], v[52:55], v[56:71]
    s_waitcnt lgkmcnt(2)
    v_mfma_f32_32x32x16_bf16 v[72:87], v[156:159], v[52:55], v[72:87]
    s_waitcnt lgkmcnt(0)
    v_mfma_f32_32x32x16_bf16 v[88:103], v[160:163], v[52:55], v[88:103]
    v_add_u32 v16, s32, v5
    v_add_u32 v20, s36, v5
    v_add_u32 v21, s37, v5
    v_add_u32 v22, s38, v5
    v_mov_b32 v13, s27
    s_mov_b32 s63, 7
    s_nop 1
    ds_write_b128 v16, v[60:63] offset:0
    ds_write_b128 v16, v[64:67] offset:3072
    ds_write_b128 v16, v[68:71] offset:6144
    ds_write_b128 v16, v[76:79] offset:1024
    ds_write_b128 v16, v[80:83] offset:4096
    ds_write_b128 v16, v[84:87] offset:7168
    ds_write_b128 v16, v[92:95] offset:2048
    ds_write_b128 v16, v[96:99] offset:5120
    ds_write_b128 v16, v[100:103] offset:8192
    s_waitcnt lgkmcnt(0)
    ds_write_b32 v13, v13
L_f_spA:
    ds_read_b32 v1, v15
    s_waitcnt lgkmcnt(0)
    v_cmp_ne_u32 vcc, 0, v1
    s_and_b32 s30, vcc_lo, s63
    s_bitcmp1_b32 s30, 0
    s_cbranch_scc0 L_f_nrA0
    ds_read_b128 v[104:107], v20 offset:0
    ds_read_b128 v[116:119], v20 offset:1024
    ds_read_b128 v[128:131], v20 offset:2048
L_f_nrA0:
    s_bitcmp1_b32 s30, 1
    s_cbranch_scc0 L_f_nrA1
    ds_read_b128 v[108:111], v21 offset:0
    ds_read_b128 v[120:123], v21 offset:1024
    ds_read_b128 v[132:135], v21 offset:2048
L_f_nrA1:
    s_bitcmp1_b32 s30, 2
    s_cbranch_scc0 L_f_nrA2
    ds_read_b128 v[112:115], v22 offset:0
    ds_read_b128 v[124:127], v22 offset:1024
    ds_read_b128 v[136:139], v22 offset:2048
L_f_nrA2:
    s_andn2_b32 s63, s63, s30
    s_cbranch_scc1 L_f_spA
    s_waitcnt lgkmcnt(0)
    v_add_f32 v56, v56, v104
    v_add_f32 v108, v108, v112
    v_add_f32 v57, v57, v105
    v_add_f32 v109, v109, v113
    v_add_f32 v58, v58, v106
    v_add_f32 v110, v110, v114
    v_add_f32 v59, v59, v107
    v_add_f32 v111, v111, v115
    v_add_f32 v56, v56, v108
    v_add_f32 v57, v57, v109
    v_add_f32 v58, v58, v110
    v_add_f32 v59, v59, v111
    v_cvt_pk_bf16_f32 v56, v56, v57
    v_cvt_pk_bf16_f32 v57, v58, v59
    buffer_store_dwordx2 v[56:57], v9, s[48:51], s55 offen
    v_add_f32 v72, v72, v116
    v_add_f32 v120, v120, v124
    v_add_f32 v73, v73, v117
    v_add_f32 v121, v121, v125
    v_add_f32 v74, v74, v118
    v_add_f32 v122, v122, v126
    v_add_f32 v75, v75, v119
    v_add_f32 v123, v123, v127
    v_add_f32 v72, v72, v120
    v_add_f32 v73, v73, v121
    v_add_f32 v74, v74, v122
    v_add_f32 v75, v75, v123
    v_cvt_pk_bf16_f32 v72, v72, v73
    v_cvt_pk_bf16_f32 v73, v74, v75
    buffer_store_dwordx2 v[72:73], v9, s[48:51], s33 offen
    v_add_f32 v88, v88, v128
    v_add_f32 v132, v132, v136
    v_add_f32 v89, v89, v129
    v_add_f32 v133, v133, v137
    v_add_f32 v90, v90, v130
    v_add_f32 v134, v134, v138
    v_add_f32 v91, v91, v131
    v_add_f32 v135, v135, v139
    v_add_f32 v88, v88, v132
    v_add_f32 v89, v89, v133
    v_add_f32 v90, v90, v134
    v_add_f32 v91, v91, v135
    v_cvt_pk_bf16_f32 v88, v88, v89
    v_cvt_pk_bf16_f32 v89, v90, v91
    buffer_store_dwordx2 v[88:89], v9, s[48:51], s34 offen
    s_endpgm
L_f_rtA0:
    s_sub_u32 s62, s62, 1
    s_cbranch_scc1 L_f_bkA0
    buffer_load_dwordx4 v[16:19], v5, s[44:47], s57 offen offset:0 sc1
    buffer_load_dwordx4 v[20:23], v5, s[44:47], s57 offen offset:1280 sc1
    buffer_load_dwordx4 v[24:27], v5, s[44:47], s57 offen offset:2560 sc1
    buffer_load_dwordx4 v[28:31], v5, s[44:47], s57 offen offset:3840 sc1
    buffer_load_dwordx4 v[32:35], v5, s[44:47], s28 offen offset:0 sc1
    buffer_load_dwordx4 v[36:39], v5, s[44:47], s28 offen offset:1280 sc1
    buffer_load_dwordx4 v[40:43], v5, s[44:47], s28 offen offset:2560 sc1
    buffer_load_dwordx4 v[44:47], v5, s[44:47], s28 offen offset:3840 sc1
    buffer_load_dwordx2 v[48:49], v8, s[44:47], s57 offen offset:1024 sc1
    buffer_load_dwordx2 v[50:51], v8, s[44:47], s57 offen offset:2304 sc1
    buffer_load_dwordx2 v[52:53], v8, s[44:47], s28 offen offset:1024 sc1
    buffer_load_dwordx2 v[54:55], v8, s[44:47], s28 offen offset:2304 sc1
    s_waitcnt vmcnt(11)
    s_branch L_f_ckA0
L_f_rtA1:
    s_sub_u32 s62, s62, 1
    s_cbranch_scc1 L_f_bkA1
    buffer_load_dwordx4 v[20:23], v5, s[44:47], s57 offen offset:1280 sc1
    buffer_load_dwordx4 v[24:27], v5, s[44:47], s57 offen offset:2560 sc1
    buffer_load_dwordx4 v[28:31], v5, s[44:47], s57 offen offset:3840 sc1
    buffer_load_dwordx4 v[32:35], v5, s[44:47], s28 offen offset:0 sc1
    buffer_load_dwordx4 v[36:39], v5, s[44:47], s28 offen offset:1280 sc1
    buffer_load_dwordx4 v[40:43], v5, s[44:47], s28 offen offset:2560 sc1
    buffer_load_dwordx4 v[44:47], v5, s[44:47], s28 offen offset:3840 sc1
    buffer_load_dwordx2 v[48:49], v8, s[44:47], s57 offen offset:1024 sc1
    buffer_load_dwordx2 v[50:51], v8, s[44:47], s57 offen offset:2304 sc1
    buffer_load_dwordx2 v[52:53], v8, s[44:47], s28 offen offset:1024 sc1
    buffer_load_dwordx2 v[54:55], v8, s[44:47], s28 offen offset:2304 sc1
    s_waitcnt vmcnt(10)
    s_branch L_f_ckA1
L_f_rtA2:
    s_sub_u32 s62, s62, 1
    s_cbranch_scc1 L_f_bkA2
    buffer_load_dwordx4 v[24:27], v5, s[44:47], s57 offen offset:2560 sc1
    buffer_load_dwordx4 v[28:31], v5, s[44:47], s57 offen offset:3840 sc1
    buffer_load_dwordx4 v[32:35], v5, s[44:47], s28 offen offset:0 sc1
    buffer_load_dwordx4 v[36:39], v5, s[44:47], s28 offen offset:1280 sc1
    buffer_load_dwordx4 v[40:43], v5, s[44:47], s28 offen offset:2560 sc1
    buffer_load_dwordx4 v[44:47], v5, s[44:47], s28 offen offset:3840 sc1
    buffer_load_dwordx2 v[48:49], v8, s[44:47], s57 offen offset:1024 sc1
    buffer_load_dwordx2 v[50:51], v8, s[44:47], s57 offen offset:2304 sc1
    buffer_load_dwordx2 v[52:53], v8, s[44:47], s28 offen offset:1024 sc1
    buffer_load_dwordx2 v[54:55], v8, s[44:47], s28 offen offset:2304 sc1
    s_waitcnt vmcnt(9)
    s_branch L_f_ckA2
L_f_rtA3:
    s_sub_u32 s62, s62, 1
    s_cbranch_scc1 L_f_bkA3
    buffer_load_dwordx4 v[28:31], v5, s[44:47], s57 offen offset:3840 sc1
    buffer_load_dwordx4 v[32:35], v5, s[44:47], s28 offen offset:0 sc1
    buffer_load_dwordx4 v[36:39], v5, s[44:47], s28 offen offset:1280 sc1
    buffer_load_dwordx4 v[40:43], v5, s[44:47], s28 offen offset:2560 sc1
    buffer_load_dwordx4 v[44:47], v5, s[44:47], s28 offen offset:3840 sc1
    buffer_load_dwordx2 v[48:49], v8, s[44:47], s57 offen offset:1024 sc1
    buffer_load_dwordx2 v[50:51], v8, s[44:47], s57 offen offset:2304 sc1
    buffer_load_dwordx2 v[52:53], v8, s[44:47], s28 offen offset:1024 sc1
    buffer_load_dwordx2 v[54:55], v8, s[44:47], s28 offen offset:2304 sc1
    s_waitcnt vmcnt(8)
    s_branch L_f_ckA3
L_f_rtA4:
    s_sub_u32 s62, s62, 1
    s_cbranch_scc1 L_f_bkA4
    buffer_load_dwordx4 v[32:35], v5, s[44:47], s28 offen offset:0 sc1
    buffer_load_dwordx4 v[36:39], v5, s[44:47], s28 offen offset:1280 sc1
    buffer_load_dwordx4 v[40:43], v5, s[44:47], s28 offen offset:2560 sc1
    buffer_load_dwordx4 v[44:47], v5, s[44:47], s28 offen offset:3840 sc1
    buffer_load_dwordx2 v[48:49], v8, s[44:47], s57 offen offset:1024 sc1
    buffer_load_dwordx2 v[50:51], v8, s[44:47], s57 offen offset:2304 sc1
    buffer_load_dwordx2 v[52:53], v8, s[44:47], s28 offen offset:1024 sc1
    buffer_load_dwordx2 v[54:55], v8, s[44:47], s28 offen offset:2304 sc1
    s_waitcnt vmcnt(7)
    s_branch L_f_ckA4
L_f_rtA5:
    s_sub_u32 s62, s62, 1
    s_cbranch_scc1 L_f_bkA5
    buffer_load_dwordx4 v[36:39], v5, s[44:47], s28 offen offset:1280 sc1
    buffer_load_dwordx4 v[40:43], v5, s[44:47], s28 offen offset:2560 sc1
    buffer_load_dwordx4 v[44:47], v5, s[44:47], s28 offen offset:3840 sc1
    buffer_load_dwordx2 v[48:49], v8, s[44:47], s57 offen offset:1024 sc1
    buffer_load_dwordx2 v[50:51], v8, s[44:47], s57 offen offset:2304 sc1
    buffer_load_dwordx2 v[52:53], v8, s[44:47], s28 offen offset:1024 sc1
    buffer_load_dwordx2 v[54:55], v8, s[44:47], s28 offen offset:2304 sc1
    s_waitcnt vmcnt(6)
    s_branch L_f_ckA5
L_f_rtA6:
    s_sub_u32 s62, s62, 1
    s_cbranch_scc1 L_f_bkA6
    buffer_load_dwordx4 v[40:43], v5, s[44:47], s28 offen offset:2560 sc1
    buffer_load_dwordx4 v[44:47], v5, s[44:47], s28 offen offset:3840 sc1
    buffer_load_dwordx2 v[48:49], v8, s[44:47], s57 offen offset:1024 sc1
    buffer_load_dwordx2 v[50:51], v8, s[44:47], s57 offen offset:2304 sc1
    buffer_load_dwordx2 v[52:53], v8, s[44:47], s28 offen offset:1024 sc1
    buffer_load_dwordx2 v[54:55], v8, s[44:47], s28 offen offset:2304 sc1
    s_waitcnt vmcnt(5)
    s_branch L_f_ckA6
L_f_rtA7:
    s_sub_u32 s62, s62, 1
    s_cbranch_scc1 L_f_bkA7
    buffer_load_dwordx4 v[44:47], v5, s[44:47], s28 offen offset:3840 sc1
    buffer_load_dwordx2 v[48:49], v8, s[44:47], s57 offen offset:1024 sc1
    buffer_load_dwordx2 v[50:51], v8, s[44:47], s57 offen offset:2304 sc1
    buffer_load_dwordx2 v[52:53], v8, s[44:47], s28 offen offset:1024 sc1
    buffer_load_dwordx2 v[54:55], v8, s[44:47], s28 offen offset:2304 sc1
    s_waitcnt vmcnt(4)
    s_branch L_f_ckA7
L_f_rtA8:
    s_sub_u32 s62, s62, 1
    s_cbranch_scc1 L_f_bkA8
    buffer_load_dwordx2 v[48:49], v8, s[44:47], s57 offen offset:1024 sc1
    buffer_load_dwordx2 v[50:51], v8, s[44:47], s57 offen offset:2304 sc1
    buffer_load_dwordx2 v[52:53], v8, s[44:47], s28 offen offset:1024 sc1
    buffer_load_dwordx2 v[54:55], v8, s[44:47], s28 offen offset:2304 sc1
    s_waitcnt vmcnt(2)
    s_branch L_f_ckA8
L_f_rtA9:
    s_sub_u32 s62, s62, 1
    s_cbranch_scc1 L_f_bkA9
    buffer_load_dwordx2 v[52:53], v8, s[44:47], s28 offen offset:1024 sc1
    buffer_load_dwordx2 v[54:55], v8, s[44:47], s28 offen offset:2304 sc1
    s_waitcnt vmcnt(0)
    s_branch L_f_ckA9
L_f_tB:
    ds_read_b64_tr_b16 v[88:89], v6 offset:0
    ds_read_b64_tr_b16 v[90:91], v6 offset:512
    ds_read_b64_tr_b16 v[92:93], v6 offset:10240
    ds_read_b64_tr_b16 v[94:95], v6 offset:10752
    ds_read_b64_tr_b16 v[96:97], v6 offset:1280
    ds_read_b64_tr_b16 v[98:99], v6 offset:1792
    ds_read_b64_tr_b16 v[100:101], v6 offset:11520
    ds_read_b64_tr_b16 v[102:103], v6 offset:12032
    ds_read_b64_tr_b16 v[104:105], v6 offset:2560
    ds_read_b64_tr_b16 v[106:107], v6 offset:3072
    ds_read_b64_tr_b16 v[108:109], v6 offset:12800
    ds_read_b64_tr_b16 v[110:111], v6 offset:13312
    ds_read_b64_tr_b16 v[112:113], v6 offset:3840
    ds_read_b64_tr_b16 v[114:115], v6 offset:4352
    ds_read_b64_tr_b16 v[116:117], v6 offset:14080
    ds_read_b64_tr_b16 v[118:119], v6 offset:14592
    ds_read_b64_tr_b16 v[120:121], v6 offset:5120
    ds_read_b64_tr_b16 v[122:123], v6 offset:5632
    ds_read_b64_tr_b16 v[124:125], v6 offset:15360
    ds_read_b64_tr_b16 v[126:127], v6 offset:15872
    ds_read_b64_tr_b16 v[128:129], v6 offset:6400
    ds_read_b64_tr_b16 v[130:131], v6 offset:6912
    ds_read_b64_tr_b16 v[132:133], v6 offset:16640
    ds_read_b64_tr_b16 v[134:135], v6 offset:17152
    ds_read_b64_tr_b16 v[136:137], v6 offset:7680
    ds_read_b64_tr_b16 v[138:139], v6 offset:8192
    ds_read_b64_tr_b16 v[140:141], v6 offset:17920
    ds_read_b64_tr_b16 v[142:143], v6 offset:18432
    ds_read_b64_tr_b16 v[144:145], v6 offset:8960
    ds_read_b64_tr_b16 v[146:147], v6 offset:9472
    ds_read_b64_tr_b16 v[148:149], v6 offset:19200
    ds_read_b64_tr_b16 v[150:151], v6 offset:19712
    ds_read_b64_tr_b16 v[152:153], v7 offset:1024
    ds_read_b64_tr_b16 v[154:155], v7 offset:2304
    ds_read_b64_tr_b16 v[156:157], v7 offset:11264
    ds_read_b64_tr_b16 v[158:159], v7 offset:12544
    ds_read_b64_tr_b16 v[160:161], v7 offset:6144
    ds_read_b64_tr_b16 v[162:163], v7 offset:7424
    ds_read_b64_tr_b16 v[164:165], v7 offset:16384
    ds_read_b64_tr_b16 v[166:167], v7 offset:17664
    s_lshl_b32 s32, s54, 12
    s_add_u32 s32, s32, 123904
    s_sub_u32 s30, s54, 1
    s_and_b32 s30, s30, 3
    s_mul_i32 s30, s30, 5120
    s_add_u32 s36, s30, 143360
    s_sub_u32 s30, s54, 2
    s_and_b32 s30, s30, 3
    s_mul_i32 s30, s30, 4096
    s_add_u32 s37, s30, 123904
    s_sub_u32 s30, s54, 3
    s_and_b32 s30, s30, 3
    s_mul_i32 s30, s30, 4096
    s_add_u32 s38, s30, 125952
    s_add_u32 s33, s55, s53
    s_add_u32 s34, s33, s53
    s_mov_b32 s35, 0
    v_mov_b32 v56, 0
    v_mov_b32 v57, 0
    v_mov_b32 v58, 0
    v_mov_b32 v59, 0
    v_mov_b32 v60, 0
    v_mov_b32 v61, 0
    v_mov_b32 v62, 0
    v_mov_b32 v63, 0
    v_mov_b32 v64, 0
    v_mov_b32 v65, 0
    v_mov_b32 v66, 0
    v_mov_b32 v67, 0
    v_mov_b32 v68, 0
    v_mov_b32 v69, 0
    v_mov_b32 v70, 0
    v_mov_b32 v71, 0
    v_mov_b32 v72, 0
    v_mov_b32 v73, 0
    v_mov_b32 v74, 0
    v_mov_b32 v75, 0
    v_mov_b32 v76, 0
    v_mov_b32 v77, 0
    v_mov_b32 v78, 0
    v_mov_b32 v79, 0
    v_mov_b32 v80, 0
    v_mov_b32 v81, 0
    v_mov_b32 v82, 0
    v_mov_b32 v83, 0
    v_mov_b32 v84, 0
    v_mov_b32 v85, 0
    v_mov_b32 v86, 0
    v_mov_b32 v87, 0
    s_cmp_eq_u32 s64, 9
    s_cbranch_scc1 L_f_idB
    s_cmp_gt_u32 s64, 0
    s_cbranch_scc1 L_f_isB0n
    s_bitcmp1_b32 s63, 0
    s_cbranch_scc1 L_f_isB0g
L_f_isB0p:
    ds_read_b64 v[0:1], v10 offset:96
    s_waitcnt lgkmcnt(0)
    v_readfirstlane_b32 s30, v0
    v_readfirstlane_b32 s31, v1
    s_lshr_b64 s[30:31], s[30:31], s56
    s_mov_b32 s63, s30
    s_bitcmp1_b32 s30, 0
    s_cbranch_scc1 L_f_isB0g
    s_sleep 1
    s_branch L_f_isB0p
L_f_isB0g:
    buffer_load_dwordx4 v[16:19], v5, s[44:47], s57 offen offset:0 sc1
L_f_isB0n:
    s_cmp_gt_u32 s64, 1
    s_cbranch_scc1 L_f_isB1n
    s_bitcmp1_b32 s63, 1
    s_cbranch_scc1 L_f_isB1g
L_f_isB1p:
    ds_read_b64 v[0:1], v10 offset:96
    s_waitcnt lgkmcnt(0)
    v_readfirstlane_b32 s30, v0
    v_readfirstlane_b32 s31, v1
    s_lshr_b64 s[30:31], s[30:31], s56
    s_mov_b32 s63, s30
    s_bitcmp1_b32 s30, 1
    s_cbranch_scc1 L_f_isB1g
    s_sleep 1
    s_branch L_f_isB1p
L_f_isB1g:
    buffer_load_dwordx4 v[20:23], v5, s[44:47], s57 offen offset:1280 sc1
L_f_isB1n:
    s_cmp_gt_u32 s64, 2
    s_cbranch_scc1 L_f_isB2n
    s_bitcmp1_b32 s63, 2
    s_cbranch_scc1 L_f_isB2g
L_f_isB2p:
    ds_read_b64 v[0:1], v10 offset:96
    s_waitcnt lgkmcnt(0)
    v_readfirstlane_b32 s30, v0
    v_readfirstlane_b32 s31, v1
    s_lshr_b64 s[30:31], s[30:31], s56
    s_mov_b32 s63, s30
    s_bitcmp1_b32 s30, 2
    s_cbranch_scc1 L_f_isB2g
    s_sleep 1
    s_branch L_f_isB2p
L_f_isB2g:
    buffer_load_dwordx4 v[24:27], v5, s[44:47], s57 offen offset:2560 sc1
L_f_isB2n:
    s_cmp_gt_u32 s64, 3
    s_cbranch_scc1 L_f_isB3n
    s_bitcmp1_b32 s63, 3
    s_cbranch_scc1 L_f_isB3g
L_f_isB3p:
    ds_read_b64 v[0:1], v10 offset:96
    s_waitcnt lgkmcnt(0)
    v_readfirstlane_b32 s30, v0
    v_readfirstlane_b32 s31, v1
    s_lshr_b64 s[30:31], s[30:31], s56
    s_mov_b32 s63, s30
    s_bitcmp1_b32 s30, 3
    s_cbranch_scc1 L_f_isB3g
    s_sleep 1
    s_branch L_f_isB3p
L_f_isB3g:
    buffer_load_dwordx4 v[28:31], v5, s[44:47], s57 offen offset:3840 sc1
L_f_isB3n:
    s_cmp_gt_u32 s64, 4
    s_cbranch_scc1 L_f_isB4n
    s_bitcmp1_b32 s63, 4
    s_cbranch_scc1 L_f_isB4g
L_f_isB4p:
    ds_read_b64 v[0:1], v10 offset:96
    s_waitcnt lgkmcnt(0)
    v_readfirstlane_b32 s30, v0
    v_readfirstlane_b32 s31, v1
    s_lshr_b64 s[30:31], s[30:31], s56
    s_mov_b32 s63, s30
    s_bitcmp1_b32 s30, 4
    s_cbranch_scc1 L_f_isB4g
    s_sleep 1
    s_branch L_f_isB4p
L_f_isB4g:
    buffer_load_dwordx4 v[32:35], v5, s[44:47], s28 offen offset:0 sc1
L_f_isB4n:
    s_cmp_gt_u32 s64, 5
    s_cbranch_scc1 L_f_isB5n
    s_bitcmp1_b32 s63, 5
    s_cbranch_scc1 L_f_isB5g
L_f_isB5p:
    ds_read_b64 v[0:1], v10 offset:96
    s_waitcnt lgkmcnt(0)
    v_readfirstlane_b32 s30, v0
    v_readfirstlane_b32 s31, v1
    s_lshr_b64 s[30:31], s[30:31], s56
    s_mov_b32 s63, s30
    s_bitcmp1_b32 s30, 5
    s_cbranch_scc1 L_f_isB5g
    s_sleep 1
    s_branch L_f_isB5p
L_f_isB5g:
    buffer_load_dwordx4 v[36:39], v5, s[44:47], s28 offen offset:1280 sc1
L_f_isB5n:
    s_cmp_gt_u32 s64, 6
    s_cbranch_scc1 L_f_isB6n
    s_bitcmp1_b32 s63, 6
    s_cbranch_scc1 L_f_isB6g
L_f_isB6p:
    ds_read_b64 v[0:1], v10 offset:96
    s_waitcnt lgkmcnt(0)
    v_readfirstlane_b32 s30, v0
    v_readfirstlane_b32 s31, v1
    s_lshr_b64 s[30:31], s[30:31], s56
    s_mov_b32 s63, s30
    s_bitcmp1_b32 s30, 6
    s_cbranch_scc1 L_f_isB6g
    s_sleep 1
    s_branch L_f_isB6p
L_f_isB6g:
    buffer_load_dwordx4 v[40:43], v5, s[44:47], s28 offen offset:2560 sc1
L_f_isB6n:
    s_cmp_gt_u32 s64, 7
    s_cbranch_scc1 L_f_isB7n
    s_bitcmp1_b32 s63, 7
    s_cbranch_scc1 L_f_isB7g
L_f_isB7p:
    ds_read_b64 v[0:1], v10 offset:96
    s_waitcnt lgkmcnt(0)
    v_readfirstlane_b32 s30, v0
    v_readfirstlane_b32 s31, v1
    s_lshr_b64 s[30:31], s[30:31], s56
    s_mov_b32 s63, s30
    s_bitcmp1_b32 s30, 7
    s_cbranch_scc1 L_f_isB7g
    s_sleep 1
    s_branch L_f_isB7p
L_f_isB7g:
    buffer_load_dwordx4 v[44:47], v5, s[44:47], s28 offen offset:3840 sc1
L_f_isB7n:
    buffer_load_dwordx2 v[48:49], v8, s[44:47], s57 offen offset:1024 sc1
    buffer_load_dwordx2 v[50:51], v8, s[44:47], s57 offen offset:2304 sc1
    buffer_load_dwordx2 v[52:53], v8, s[44:47], s28 offen offset:1024 sc1
    buffer_load_dwordx2 v[54:55], v8, s[44:47], s28 offen offset:2304 sc1
L_f_idB:
    ds_read_b32 v1, v13
L_f_lw2:
    s_waitcnt lgkmcnt(0)
    v_cmp_gt_u32 vcc, 7, v1
    s_cbranch_vccz L_f_lwd2
    s_sleep 2
    ds_read_b32 v1, v13
    s_branch L_f_lw2
L_f_lwd2:
    ds_read_b128 v[56:59], v12 offset:0
    ds_read_b128 v[72:75], v12 offset:1024
    s_waitcnt lgkmcnt(0)
    s_waitcnt vmcnt(11)
L_f_ckB0:
    v_max3_u32 v1, v16, v17, v18
    v_max_u32 v1, v1, v19
    v_cmp_eq_u32 vcc, -1, v1
    s_cbranch_vccnz L_f_rtB0
L_f_bkB0:
    v_mfma_f32_32x32x16_bf16 v[56:71], v[88:91], v[16:19], v[56:71]
    v_mfma_f32_32x32x16_bf16 v[72:87], v[92:95], v[16:19], v[72:87]
    s_waitcnt vmcnt(10)
L_f_ckB1:
    v_max3_u32 v1, v20, v21, v22
    v_max_u32 v1, v1, v23
    v_cmp_eq_u32 vcc, -1, v1
    s_cbranch_vccnz L_f_rtB1
L_f_bkB1:
    v_mfma_f32_32x32x16_bf16 v[56:71], v[96:99], v[20:23], v[56:71]
    v_mfma_f32_32x32x16_bf16 v[72:87], v[100:103], v[20:23], v[72:87]
    s_waitcnt vmcnt(9)
L_f_ckB2:
    v_max3_u32 v1, v24, v25, v26
    v_max_u32 v1, v1, v27
    v_cmp_eq_u32 vcc, -1, v1
    s_cbranch_vccnz L_f_rtB2
L_f_bkB2:
    v_mfma_f32_32x32x16_bf16 v[56:71], v[104:107], v[24:27], v[56:71]
    v_mfma_f32_32x32x16_bf16 v[72:87], v[108:111], v[24:27], v[72:87]
    s_waitcnt vmcnt(8)
L_f_ckB3:
    v_max3_u32 v1, v28, v29, v30
    v_max_u32 v1, v1, v31
    v_cmp_eq_u32 vcc, -1, v1
    s_cbranch_vccnz L_f_rtB3
L_f_bkB3:
    v_mfma_f32_32x32x16_bf16 v[56:71], v[112:115], v[28:31], v[56:71]
    v_mfma_f32_32x32x16_bf16 v[72:87], v[116:119], v[28:31], v[72:87]
    s_waitcnt vmcnt(7)
L_f_ckB4:
    v_max3_u32 v1, v32, v33, v34
    v_max_u32 v1, v1, v35
    v_cmp_eq_u32 vcc, -1, v1
    s_cbranch_vccnz L_f_rtB4
L_f_bkB4:
    v_mfma_f32_32x32x16_bf16 v[56:71], v[120:123], v[32:35], v[56:71]
    v_mfma_f32_32x32x16_bf16 v[72:87], v[124:127], v[32:35], v[72:87]
    s_waitcnt vmcnt(6)
L_f_ckB5:
    v_max3_u32 v1, v36, v37, v38
    v_max_u32 v1, v1, v39
    v_cmp_eq_u32 vcc, -1, v1
    s_cbranch_vccnz L_f_rtB5
L_f_bkB5:
    v_mfma_f32_32x32x16_bf16 v[56:71], v[128:131], v[36:39], v[56:71]
    v_mfma_f32_32x32x16_bf16 v[72:87], v[132:135], v[36:39], v[72:87]
    s_waitcnt vmcnt(5)
L_f_ckB6:
    v_max3_u32 v1, v40, v41, v42
    v_max_u32 v1, v1, v43
    v_cmp_eq_u32 vcc, -1, v1
    s_cbranch_vccnz L_f_rtB6
L_f_bkB6:
    v_mfma_f32_32x32x16_bf16 v[56:71], v[136:139], v[40:43], v[56:71]
    v_mfma_f32_32x32x16_bf16 v[72:87], v[140:143], v[40:43], v[72:87]
    s_waitcnt vmcnt(4)
L_f_ckB7:
    v_max3_u32 v1, v44, v45, v46
    v_max_u32 v1, v1, v47
    v_cmp_eq_u32 vcc, -1, v1
    s_cbranch_vccnz L_f_rtB7
L_f_bkB7:
    v_mfma_f32_32x32x16_bf16 v[56:71], v[144:147], v[44:47], v[56:71]
    v_mfma_f32_32x32x16_bf16 v[72:87], v[148:151], v[44:47], v[72:87]
    s_waitcnt vmcnt(2)
L_f_ckB8:
    v_max3_u32 v1, v48, v49, v50
    v_max_u32 v1, v1, v51
    v_cmp_eq_u32 vcc, -1, v1
    s_cbranch_vccnz L_f_rtB8
L_f_bkB8:
    v_mfma_f32_32x32x16_bf16 v[56:71], v[152:155], v[48:51], v[56:71]
    v_mfma_f32_32x32x16_bf16 v[72:87], v[156:159], v[48:51], v[72:87]
    s_waitcnt vmcnt(0)
L_f_ckB9:
    v_max3_u32 v1, v52, v53, v54
    v_max_u32 v1, v1, v55
    v_cmp_eq_u32 vcc, -1, v1
    s_cbranch_vccnz L_f_rtB9
L_f_bkB9:
    v_mfma_f32_32x32x16_bf16 v[56:71], v[160:163], v[52:55], v[56:71]
    v_mfma_f32_32x32x16_bf16 v[72:87], v[164:167], v[52:55], v[72:87]
    v_add_u32 v16, s32, v5
    v_add_u32 v20, s36, v5
    v_add_u32 v21, s37, v5
    v_add_u32 v22, s38, v5
    v_mov_b32 v13, s27
    s_mov_b32 s63, 7
    s_nop 4
    ds_write_b128 v12, v[60:63] offset:0
    ds_write_b128 v16, v[64:67] offset:0
    ds_write_b128 v16, v[68:71] offset:2048
    ds_write_b128 v12, v[76:79] offset:1024
    ds_write_b128 v16, v[80:83] offset:1024
    ds_write_b128 v16, v[84:87] offset:3072
    s_waitcnt lgkmcnt(0)
    ds_write_b32 v13, v13
L_f_spB:
    ds_read_b32 v1, v15
    s_waitcnt lgkmcnt(0)
    v_cmp_ne_u32 vcc, 0, v1
    s_and_b32 s30, vcc_lo, s63
    s_bitcmp1_b32 s30, 0
    s_cbranch_scc0 L_f_nrB0
    ds_read_b128 v[88:91], v20 offset:0
    ds_read_b128 v[100:103], v20 offset:1024
L_f_nrB0:
    s_bitcmp1_b32 s30, 1
    s_cbranch_scc0 L_f_nrB1
    ds_read_b128 v[92:95], v21 offset:0
    ds_read_b128 v[104:107], v21 offset:1024
L_f_nrB1:
    s_bitcmp1_b32 s30, 2
    s_cbranch_scc0 L_f_nrB2
    ds_read_b128 v[96:99], v22 offset:0
    ds_read_b128 v[108:111], v22 offset:1024
L_f_nrB2:
    s_andn2_b32 s63, s63, s30
    s_cbranch_scc1 L_f_spB
    s_waitcnt lgkmcnt(0)
    v_add_f32 v56, v56, v88
    v_add_f32 v92, v92, v96
    v_add_f32 v57, v57, v89
    v_add_f32 v93, v93, v97
    v_add_f32 v58, v58, v90
    v_add_f32 v94, v94, v98
    v_add_f32 v59, v59, v91
    v_add_f32 v95, v95, v99
    v_add_f32 v56, v56, v92
    v_add_f32 v57, v57, v93
    v_add_f32 v58, v58, v94
    v_add_f32 v59, v59, v95
    v_cvt_pk_bf16_f32 v56, v56, v57
    v_cvt_pk_bf16_f32 v57, v58, v59
    buffer_store_dwordx2 v[56:57], v9, s[48:51], s55 offen
    v_add_f32 v72, v72, v100
    v_add_f32 v104, v104, v108
    v_add_f32 v73, v73, v101
    v_add_f32 v105, v105, v109
    v_add_f32 v74, v74, v102
    v_add_f32 v106, v106, v110
    v_add_f32 v75, v75, v103
    v_add_f32 v107, v107, v111
    v_add_f32 v72, v72, v104
    v_add_f32 v73, v73, v105
    v_add_f32 v74, v74, v106
    v_add_f32 v75, v75, v107
    v_cvt_pk_bf16_f32 v72, v72, v73
    v_cvt_pk_bf16_f32 v73, v74, v75
    buffer_store_dwordx2 v[72:73], v9, s[48:51], s33 offen
    s_endpgm
L_f_rtB0:
    s_sub_u32 s62, s62, 1
    s_cbranch_scc1 L_f_bkB0
    buffer_load_dwordx4 v[16:19], v5, s[44:47], s57 offen offset:0 sc1
    buffer_load_dwordx4 v[20:23], v5, s[44:47], s57 offen offset:1280 sc1
    buffer_load_dwordx4 v[24:27], v5, s[44:47], s57 offen offset:2560 sc1
    buffer_load_dwordx4 v[28:31], v5, s[44:47], s57 offen offset:3840 sc1
    buffer_load_dwordx4 v[32:35], v5, s[44:47], s28 offen offset:0 sc1
    buffer_load_dwordx4 v[36:39], v5, s[44:47], s28 offen offset:1280 sc1
    buffer_load_dwordx4 v[40:43], v5, s[44:47], s28 offen offset:2560 sc1
    buffer_load_dwordx4 v[44:47], v5, s[44:47], s28 offen offset:3840 sc1
    buffer_load_dwordx2 v[48:49], v8, s[44:47], s57 offen offset:1024 sc1
    buffer_load_dwordx2 v[50:51], v8, s[44:47], s57 offen offset:2304 sc1
    buffer_load_dwordx2 v[52:53], v8, s[44:47], s28 offen offset:1024 sc1
    buffer_load_dwordx2 v[54:55], v8, s[44:47], s28 offen offset:2304 sc1
    s_waitcnt vmcnt(11)
    s_branch L_f_ckB0
L_f_rtB1:
    s_sub_u32 s62, s62, 1
    s_cbranch_scc1 L_f_bkB1
    buffer_load_dwordx4 v[20:23], v5, s[44:47], s57 offen offset:1280 sc1
    buffer_load_dwordx4 v[24:27], v5, s[44:47], s57 offen offset:2560 sc1
    buffer_load_dwordx4 v[28:31], v5, s[44:47], s57 offen offset:3840 sc1
    buffer_load_dwordx4 v[32:35], v5, s[44:47], s28 offen offset:0 sc1
    buffer_load_dwordx4 v[36:39], v5, s[44:47], s28 offen offset:1280 sc1
    buffer_load_dwordx4 v[40:43], v5, s[44:47], s28 offen offset:2560 sc1
    buffer_load_dwordx4 v[44:47], v5, s[44:47], s28 offen offset:3840 sc1
    buffer_load_dwordx2 v[48:49], v8, s[44:47], s57 offen offset:1024 sc1
    buffer_load_dwordx2 v[50:51], v8, s[44:47], s57 offen offset:2304 sc1
    buffer_load_dwordx2 v[52:53], v8, s[44:47], s28 offen offset:1024 sc1
    buffer_load_dwordx2 v[54:55], v8, s[44:47], s28 offen offset:2304 sc1
    s_waitcnt vmcnt(10)
    s_branch L_f_ckB1
L_f_rtB2:
    s_sub_u32 s62, s62, 1
    s_cbranch_scc1 L_f_bkB2
    buffer_load_dwordx4 v[24:27], v5, s[44:47], s57 offen offset:2560 sc1
    buffer_load_dwordx4 v[28:31], v5, s[44:47], s57 offen offset:3840 sc1
    buffer_load_dwordx4 v[32:35], v5, s[44:47], s28 offen offset:0 sc1
    buffer_load_dwordx4 v[36:39], v5, s[44:47], s28 offen offset:1280 sc1
    buffer_load_dwordx4 v[40:43], v5, s[44:47], s28 offen offset:2560 sc1
    buffer_load_dwordx4 v[44:47], v5, s[44:47], s28 offen offset:3840 sc1
    buffer_load_dwordx2 v[48:49], v8, s[44:47], s57 offen offset:1024 sc1
    buffer_load_dwordx2 v[50:51], v8, s[44:47], s57 offen offset:2304 sc1
    buffer_load_dwordx2 v[52:53], v8, s[44:47], s28 offen offset:1024 sc1
    buffer_load_dwordx2 v[54:55], v8, s[44:47], s28 offen offset:2304 sc1
    s_waitcnt vmcnt(9)
    s_branch L_f_ckB2
L_f_rtB3:
    s_sub_u32 s62, s62, 1
    s_cbranch_scc1 L_f_bkB3
    buffer_load_dwordx4 v[28:31], v5, s[44:47], s57 offen offset:3840 sc1
    buffer_load_dwordx4 v[32:35], v5, s[44:47], s28 offen offset:0 sc1
    buffer_load_dwordx4 v[36:39], v5, s[44:47], s28 offen offset:1280 sc1
    buffer_load_dwordx4 v[40:43], v5, s[44:47], s28 offen offset:2560 sc1
    buffer_load_dwordx4 v[44:47], v5, s[44:47], s28 offen offset:3840 sc1
    buffer_load_dwordx2 v[48:49], v8, s[44:47], s57 offen offset:1024 sc1
    buffer_load_dwordx2 v[50:51], v8, s[44:47], s57 offen offset:2304 sc1
    buffer_load_dwordx2 v[52:53], v8, s[44:47], s28 offen offset:1024 sc1
    buffer_load_dwordx2 v[54:55], v8, s[44:47], s28 offen offset:2304 sc1
    s_waitcnt vmcnt(8)
    s_branch L_f_ckB3
L_f_rtB4:
    s_sub_u32 s62, s62, 1
    s_cbranch_scc1 L_f_bkB4
    buffer_load_dwordx4 v[32:35], v5, s[44:47], s28 offen offset:0 sc1
    buffer_load_dwordx4 v[36:39], v5, s[44:47], s28 offen offset:1280 sc1
    buffer_load_dwordx4 v[40:43], v5, s[44:47], s28 offen offset:2560 sc1
    buffer_load_dwordx4 v[44:47], v5, s[44:47], s28 offen offset:3840 sc1
    buffer_load_dwordx2 v[48:49], v8, s[44:47], s57 offen offset:1024 sc1
    buffer_load_dwordx2 v[50:51], v8, s[44:47], s57 offen offset:2304 sc1
    buffer_load_dwordx2 v[52:53], v8, s[44:47], s28 offen offset:1024 sc1
    buffer_load_dwordx2 v[54:55], v8, s[44:47], s28 offen offset:2304 sc1
    s_waitcnt vmcnt(7)
    s_branch L_f_ckB4
L_f_rtB5:
    s_sub_u32 s62, s62, 1
    s_cbranch_scc1 L_f_bkB5
    buffer_load_dwordx4 v[36:39], v5, s[44:47], s28 offen offset:1280 sc1
    buffer_load_dwordx4 v[40:43], v5, s[44:47], s28 offen offset:2560 sc1
    buffer_load_dwordx4 v[44:47], v5, s[44:47], s28 offen offset:3840 sc1
    buffer_load_dwordx2 v[48:49], v8, s[44:47], s57 offen offset:1024 sc1
    buffer_load_dwordx2 v[50:51], v8, s[44:47], s57 offen offset:2304 sc1
    buffer_load_dwordx2 v[52:53], v8, s[44:47], s28 offen offset:1024 sc1
    buffer_load_dwordx2 v[54:55], v8, s[44:47], s28 offen offset:2304 sc1
    s_waitcnt vmcnt(6)
    s_branch L_f_ckB5
L_f_rtB6:
    s_sub_u32 s62, s62, 1
    s_cbranch_scc1 L_f_bkB6
    buffer_load_dwordx4 v[40:43], v5, s[44:47], s28 offen offset:2560 sc1
    buffer_load_dwordx4 v[44:47], v5, s[44:47], s28 offen offset:3840 sc1
    buffer_load_dwordx2 v[48:49], v8, s[44:47], s57 offen offset:1024 sc1
    buffer_load_dwordx2 v[50:51], v8, s[44:47], s57 offen offset:2304 sc1
    buffer_load_dwordx2 v[52:53], v8, s[44:47], s28 offen offset:1024 sc1
    buffer_load_dwordx2 v[54:55], v8, s[44:47], s28 offen offset:2304 sc1
    s_waitcnt vmcnt(5)
    s_branch L_f_ckB6
L_f_rtB7:
    s_sub_u32 s62, s62, 1
    s_cbranch_scc1 L_f_bkB7
    buffer_load_dwordx4 v[44:47], v5, s[44:47], s28 offen offset:3840 sc1
    buffer_load_dwordx2 v[48:49], v8, s[44:47], s57 offen offset:1024 sc1
    buffer_load_dwordx2 v[50:51], v8, s[44:47], s57 offen offset:2304 sc1
    buffer_load_dwordx2 v[52:53], v8, s[44:47], s28 offen offset:1024 sc1
    buffer_load_dwordx2 v[54:55], v8, s[44:47], s28 offen offset:2304 sc1
    s_waitcnt vmcnt(4)
    s_branch L_f_ckB7
L_f_rtB8:
    s_sub_u32 s62, s62, 1
    s_cbranch_scc1 L_f_bkB8
    buffer_load_dwordx2 v[48:49], v8, s[44:47], s57 offen offset:1024 sc1
    buffer_load_dwordx2 v[50:51], v8, s[44:47], s57 offen offset:2304 sc1
    buffer_load_dwordx2 v[52:53], v8, s[44:47], s28 offen offset:1024 sc1
    buffer_load_dwordx2 v[54:55], v8, s[44:47], s28 offen offset:2304 sc1
    s_waitcnt vmcnt(2)
    s_branch L_f_ckB8
L_f_rtB9:
    s_sub_u32 s62, s62, 1
    s_cbranch_scc1 L_f_bkB9
    buffer_load_dwordx2 v[52:53], v8, s[44:47], s28 offen offset:1024 sc1
    buffer_load_dwordx2 v[54:55], v8, s[44:47], s28 offen offset:2304 sc1
    s_waitcnt vmcnt(0)
    s_branch L_f_ckB9
L_f_fb:
    s_waitcnt lgkmcnt(0)
    v_lshlrev_b32 v5, 4, v2
    v_lshlrev_b32 v6, 4, v4
    v_mul_u32_u24 v7, 10368, v3
    v_lshl_add_u32 v7, v4, 4, v7
    v_add_u32 v15, 20736, v7
    v_mov_b32 v1, 0xff800000
    s_add_u32 s18, s16, 40960
    s_mov_b32 s26, s18
    s_mov_b32 s27, 64
L_f_fb1:
    s_add_u32 s30, s26, s17
    buffer_load_dwordx4 v[16:19], v5, s[44:47], s26 offen sc1
    buffer_load_dwordx2 v[20:21], v6, s[44:47], s30 offen sc1
    s_waitcnt vmcnt(0)
    v_mfma_f32_32x32x16_bf16 v[32:47], v[16:19], v[8:11], 0
    v_mfma_f32_32x32x8_bf16 v[32:47], v[20:21], v[12:13], v[32:47]
    s_nop 11
    v_max3_f32 v1, v1, v32, v33
    v_max3_f32 v1, v1, v34, v35
    v_max3_f32 v1, v1, v36, v37
    v_max3_f32 v1, v1, v38, v39
    v_max3_f32 v1, v1, v40, v41
    v_max3_f32 v1, v1, v42, v43
    v_max3_f32 v1, v1, v44, v45
    v_max3_f32 v1, v1, v46, v47
    s_add_u32 s26, s26, 123520
    s_sub_u32 s27, s27, 1
    s_cmp_lg_u32 s27, 0
    s_cbranch_scc1 L_f_fb1
    v_mov_b32 v14, v1
    s_nop 1
    v_permlane32_swap_b32 v1, v14
    v_max_f32 v1, v1, v14
    v_sub_f32 v80, 0, v1
    v_mov_b32 v64, 0
    v_sub_f32 v81, 0, v1
    v_mov_b32 v65, 0
    v_sub_f32 v82, 0, v1
    v_mov_b32 v66, 0
    v_sub_f32 v83, 0, v1
    v_mov_b32 v67, 0
    v_sub_f32 v84, 0, v1
    v_mov_b32 v68, 0
    v_sub_f32 v85, 0, v1
    v_mov_b32 v69, 0
    v_sub_f32 v86, 0, v1
    v_mov_b32 v70, 0
    v_sub_f32 v87, 0, v1
    v_mov_b32 v71, 0
    v_sub_f32 v88, 0, v1
    v_mov_b32 v72, 0
    v_sub_f32 v89, 0, v1
    v_mov_b32 v73, 0
    v_sub_f32 v90, 0, v1
    v_mov_b32 v74, 0
    v_sub_f32 v91, 0, v1
    v_mov_b32 v75, 0
    v_sub_f32 v92, 0, v1
    v_mov_b32 v76, 0
    v_sub_f32 v93, 0, v1
    v_mov_b32 v77, 0
    v_sub_f32 v94, 0, v1
    v_mov_b32 v78, 0
    v_sub_f32 v95, 0, v1
    v_mov_b32 v79, 0
    s_mov_b32 s26, s18
    s_mul_i32 s28, s14, 320
    s_add_u32 s28, s28, 81920
    s_mov_b32 s27, 64
L_f_fb2:
    s_add_u32 s30, s26, s17
    buffer_load_dwordx4 v[16:19], v5, s[44:47], s26 offen sc1
    buffer_load_dwordx2 v[20:21], v6, s[44:47], s30 offen sc1
    s_mov_b64 exec, s[22:23]
    buffer_load_dwordx4 v[24:27], v7, s[44:47], s28 offen sc1
    buffer_load_dwordx4 v[28:31], v15, s[44:47], s28 offen sc1
    s_mov_b64 exec, -1
    s_waitcnt vmcnt(0)
    v_mfma_f32_32x32x16_bf16 v[32:47], v[16:19], v[8:11], v[80:95]
    v_mfma_f32_32x32x8_bf16 v[32:47], v[20:21], v[12:13], v[32:47]
    s_nop 11
    v_exp_f32 v32, v32
    v_exp_f32 v33, v33
    v_exp_f32 v34, v34
    v_exp_f32 v35, v35
    v_exp_f32 v36, v36
    v_exp_f32 v37, v37
    v_exp_f32 v38, v38
    v_exp_f32 v39, v39
    v_exp_f32 v40, v40
    v_exp_f32 v41, v41
    v_exp_f32 v42, v42
    v_exp_f32 v43, v43
    v_exp_f32 v44, v44
    v_exp_f32 v45, v45
    v_exp_f32 v46, v46
    v_exp_f32 v47, v47
    v_cvt_pk_bf16_f32 v32, v32, v33
    v_cvt_pk_bf16_f32 v33, v34, v35
    v_cvt_pk_bf16_f32 v34, v36, v37
    v_cvt_pk_bf16_f32 v35, v38, v39
    v_cvt_pk_bf16_f32 v40, v40, v41
    v_cvt_pk_bf16_f32 v41, v42, v43
    v_cvt_pk_bf16_f32 v42, v44, v45
    v_cvt_pk_bf16_f32 v43, v46, v47
    v_mfma_f32_32x32x16_bf16 v[64:79], v[24:27], v[32:35], v[64:79]
    s_nop 0
    v_mfma_f32_32x32x16_bf16 v[64:79], v[28:31], v[40:43], v[64:79]
    s_add_u32 s26, s26, 123520
    s_add_u32 s28, s28, 123520
    s_sub_u32 s27, s27, 1
    s_cmp_lg_u32 s27, 0
    s_cbranch_scc1 L_f_fb2
    s_nop 15
    s_branch L_f_epi
L_f_ffn:
    s_lshl_b32 s14, s40, 2
    s_lshr_b32 s15, s41, 3
    s_add_u32 s14, s14, s15
    s_mul_i32 s16, s14, 5
    s_add_u32 s16, s16, 1
    s_lshr_b32 s16, s16, 1
    s_lshl_b32 s16, s16, 9
    s_add_u32 s16, s16, 0
    s_movk_i32 s17, 1024
    s_bitcmp1_b32 s14, 0
    s_cselect_b32 s17, -504, s17
    s_and_b32 s19, s41, 7
    s_lshl_b32 s15, s19, 3
    s_mul_i32 s19, s19, 0
    v_lshlrev_b32 v5, 4, v2
    s_mul_i32 s30, s14, 20
    s_add_u32 s31, s30, 19
    s_lshr_b32 s30, s30, 6
    s_lshr_b32 s31, s31, 6
    s_sub_u32 s31, s31, s30
    s_lshl_b32 s30, s30, 12
    s_add_u32 s30, s30, 27394048
    s_lshl_b32 s31, s31, 12
    v_mul_u32_u24 v64, s31, v3
    v_lshl_add_u32 v64, v4, 7, v64
    v_add_u32 v64, s30, v64
    s_mul_i32 s20, s29, 123520
    s_add_u32 s20, s20, s16
    s_add_u32 s20, s20, 40960
    v_add_u32 v60, s20, v5
    s_add_u32 s20, s20, s17
    v_lshrrev_b32 v8, 1, v2
    v_and_b32 v9, 1, v2
    v_lshlrev_b32 v9, 2, v9
    v_lshl_add_u32 v8, v8, 4, v9
    v_add_u32 v61, s20, v8
    s_lshl_b32 s17, s29, 10
    s_lshl_b32 s18, s29, 8
    s_mul_i32 s20, s14, 320
    s_add_u32 s20, s20, 81920
    s_lshl_b32 s21, s29, 6
    s_lshl_b32 s22, s29, 4
    s_add_u32 s22, s22, 256
    v_add_u32 v11, s21, v2
    v_mul_u32_u24 v8, 3277, v11
    v_lshrrev_b32 v8, 16, v8
    v_mul_u32_u24 v9, 20, v8
    v_sub_u32 v9, v11, v9
    v_lshrrev_b32 v10, 2, v8
    v_and_b32 v8, 3, v8
    v_mul_u32_u24 v10, 123520, v10
    v_mul_u32_u24 v8, 10368, v8
    v_lshl_add_u32 v9, v9, 4, s20
    v_add3_u32 v62, v8, v9, v10
    v_lshrrev_b32 v11, 2, v2
    v_add_u32 v11, s22, v11
    v_mul_u32_u24 v8, 3277, v11
    v_lshrrev_b32 v8, 16, v8
    v_mul_u32_u24 v9, 20, v8
    v_sub_u32 v9, v11, v9
    v_lshrrev_b32 v10, 2, v8
    v_and_b32 v8, 3, v8
    v_mul_u32_u24 v10, 123520, v10
    v_mul_u32_u24 v8, 10368, v8
    v_lshl_add_u32 v9, v9, 4, s20
    v_add3_u32 v63, v8, v9, v10
    v_and_b32 v11, 3, v2
    v_lshl_add_u32 v63, v11, 2, v63
    s_mov_b32 s19, 988160
    v_lshrrev_b32 v84, 2, v2
    v_and_b32 v16, 3, v2
    v_lshlrev_b32 v84, 7, v84
    v_lshl_add_u32 v84, v16, 2, v84
    v_mov_b32 v16, 13824
    s_lshr_b32 s14, s40, 1
    s_lshl_b32 s14, s14, 3
    s_and_b32 s24, s41, 7
    s_add_u32 s14, s14, s24
    s_lshl_b32 s56, s14, 11
    s_add_u32 s56, s56, 27328512
    s_mul_i32 s30, s14, 3456
    s_add_u32 s30, s30, 27435008
    v_min_u32 v65, 26, v4
    v_lshl_add_u32 v65, v65, 7, s30
    s_lshl_b32 s14, s14, 1
    s_bfe_u32 s25, s41, 0x10003
    s_xor_b32 s15, s25, 1
    s_add_u32 s15, s15, s14
    s_add_u32 s14, s14, s25
    s_and_b32 s27, s40, 1
    s_lshl_b32 s27, s27, 1
    s_lshr_b32 s16, s41, 4
    s_add_u32 s27, s27, s16
    s_mul_i32 s30, s27, 108
    s_add_u32 s30, s30, s29
    s_lshl_b32 s30, s30, 7
    s_add_u32 s30, s30, 27545600
    v_min_u32 v66, 26, v4
    v_lshl_add_u32 v66, v66, 9, s30
    v_mad_u32_u24 v66, v3, v16, v66
    s_and_b32 s24, s41, 15
    s_mul_i32 s24, s24, 27
    s_lshr_b32 s24, s24, 4
    s_mul_i32 s24, s24, 1
    s_add_u32 s20, s17, 10485760
    s_mul_i32 s23, s29, 20480
    s_mul_i32 s28, s27, 5120
    s_add_u32 s23, s23, s28
    s_add_u32 s23, s23, 17825792
    s_add_u32 s22, s20, 110592
    s_lshl_b32 s16, s24, 12
    s_add_u32 s16, s16, s20
    s_mul_i32 s26, s24, 81920
    s_add_u32 s26, s26, s23
    s_mul_i32 s30, s14, 110592
    s_mul_i32 s31, s15, 110592
    v_add_u32 v8, s30, v5
    v_add_u32 v9, s31, v5
    s_lshl_b32 s30, s25, 12
    s_lshl_b32 s31, s25, 11
    s_add_u32 s31, s31, 1024
    v_add_u32 v10, s30, v5
    v_add_u32 v11, s31, v5
    v_add_u32 v12, 2048, v5
    v_mov_b32 v7, s29
    v_lshlrev_b32 v7, 2, v7
    v_and_b32 v1, 7, v2
    v_lshlrev_b32 v1, 2, v1
    v_and_b32 v15, 12, v1
    v_mul_u32_u24 v85, 1280, v4
    v_lshl_add_u32 v85, v3, 3, v85
    s_mul_i32 s52, s27, 320
    s_lshl_b32 s53, s29, 4
    s_add_u32 s53, s53, s52
    s_mul_i32 s54, s14, 40960
    s_mul_i32 s55, s15, 40960
    s_add_u32 s54, s54, s53
    s_add_u32 s55, s55, s53
    s_lshl_b32 s57, s25, 8
    s_lshl_b32 s58, s25, 7
    s_add_u32 s52, s52, s57
    s_sub_u32 s59, 64, s58
    s_add_u32 s58, s58, 64
    s_add_u32 s30, s55, s57
    s_add_u32 s31, s55, s58
    s_add_u32 s32, s54, s57
    s_add_u32 s33, s54, s58
    s_add_u32 s34, s54, 128
    s_sub_u32 s54, s29, 1
    s_add_u32 s53, s59, 204800
    s_mul_i32 s53, s53, s54
    s_add_u32 s52, s52, s53
    s_mul_i32 s53, s54, 40960
    s_add_u32 s53, s53, 1024
    v_lshrrev_b32 v16, 2, v2
    v_and_b32 v17, 3, v2
    v_mul_u32_u24 v16, 1280, v16
    v_lshl_add_u32 v76, v17, 4, v16
    s_mul_i32 s54, s29, 5120
    s_add_u32 s54, s54, 143360
    v_add_u32 v79, s54, v5
    s_sub_u32 s60, s59, 184320
    s_lshl_b32 s61, s59, 1
    s_sub_u32 s61, 20480, s61
    s_cmp_eq_u32 s29, 3
    s_cselect_b32 s54, 9, 0
    s_cselect_b32 s55, 10, 0
    s_cselect_b32 s63, 11, 0
    s_cselect_b32 s3, 12, 0
    s_cselect_b32 s62, 13, 0
    s_cselect_b32 s57, s61, s60
    s_cmp_eq_u32 s29, 2
    s_cselect_b32 s62, 9, s62
    s_cselect_b32 s58, s61, s60
    s_cmp_eq_u32 s29, 1
    s_cselect_b32 s59, s61, s60
    v_mov_b32 v6, 224
    s_mov_b32 s10, 300000
    s_mov_b32 s8, 0
    s_waitcnt lgkmcnt(0)
    buffer_store_dwordx4 v[88:91], v5, s[64:67], s69 offen offset:0 sc1
    buffer_store_dwordx4 v[92:95], v5, s[64:67], s69 offen offset:1024 sc1
    buffer_store_dwordx4 v[96:99], v5, s[64:67], s69 offen offset:2048 sc1
    buffer_store_dwordx4 v[100:103], v5, s[64:67], s69 offen offset:3072 sc1
    s_barrier
    ds_read_b32 v0, v6 offset:4
    s_waitcnt lgkmcnt(0)
    v_readfirstlane_b32 s8, v0
    s_sleep 6
L_f_gw2:
    s_and_b32 s9, s8, 0x30
    s_cmp_eq_u32 s9, 0x30
    s_cbranch_scc1 L_f_gg2
    buffer_load_dwordx4 v[68:71], v64, s[44:47], 0 offen sc1
    s_waitcnt vmcnt(0)
    v_min_u32 v69, v69, v70
    v_cmp_ne_u32 s[8:9], 0, v69
    s_and_b32 s8, s8, s9
    s_sub_u32 s10, s10, 1
    s_cselect_b32 s8, -1, s8
    s_cselect_b32 s10, 0, s10
    s_branch L_f_gw2
L_f_gg2:
    s_add_u32 m0, s17, 20480
    s_nop 0
    buffer_load_dwordx4 v60, s[44:47], s19 offen sc1 lds
    s_add_u32 m0, s18, 24576
    s_nop 0
    buffer_load_dword v61, s[44:47], s19 offen sc1 lds
    s_add_u32 m0, s17, 25600
    s_nop 0
    buffer_load_dwordx4 v62, s[44:47], s19 offen sc1 lds
    s_add_u32 m0, s18, 29696
    s_nop 0
    buffer_load_dword v63, s[44:47], s19 offen sc1 lds
    s_add_u32 s19, s19, 494080
    s_waitcnt vmcnt(4)
    v_mov_b32 v0, 1
    s_mov_b64 exec, 1
    buffer_store_dword v0, off, s[64:67], s68 sc1
    s_mov_b64 exec, -1
L_f_gw3:
    s_and_b32 s9, s8, 0xc0
    s_cmp_eq_u32 s9, 0xc0
    s_cbranch_scc1 L_f_gg3
    buffer_load_dwordx4 v[68:71], v64, s[44:47], 0 offen sc1
    s_waitcnt vmcnt(0)
    v_min_u32 v69, v69, v70
    v_cmp_ne_u32 s[8:9], 0, v69
    s_and_b32 s8, s8, s9
    s_sub_u32 s10, s10, 1
    s_cselect_b32 s8, -1, s8
    s_cselect_b32 s10, 0, s10
    s_branch L_f_gw3
L_f_gg3:
    s_add_u32 m0, s17, 30720
    s_nop 0
    buffer_load_dwordx4 v60, s[44:47], s19 offen sc1 lds
    s_add_u32 m0, s18, 34816
    s_nop 0
    buffer_load_dword v61, s[44:47], s19 offen sc1 lds
    s_add_u32 m0, s17, 35840
    s_nop 0
    buffer_load_dwordx4 v62, s[44:47], s19 offen sc1 lds
    s_add_u32 m0, s18, 39936
    s_nop 0
    buffer_load_dword v63, s[44:47], s19 offen sc1 lds
    s_add_u32 s19, s19, 494080
L_f_gw4:
    s_and_b32 s9, s8, 0x300
    s_cmp_eq_u32 s9, 0x300
    s_cbranch_scc1 L_f_gg4
    buffer_load_dwordx4 v[68:71], v64, s[44:47], 0 offen sc1
    s_waitcnt vmcnt(0)
    v_min_u32 v69, v69, v70
    v_cmp_ne_u32 s[8:9], 0, v69
    s_and_b32 s8, s8, s9
    s_sub_u32 s10, s10, 1
    s_cselect_b32 s8, -1, s8
    s_cselect_b32 s10, 0, s10
    s_branch L_f_gw4
L_f_gg4:
    s_add_u32 m0, s17, 40960
    s_nop 0
    buffer_load_dwordx4 v60, s[44:47], s19 offen sc1 lds
    s_add_u32 m0, s18, 45056
    s_nop 0
    buffer_load_dword v61, s[44:47], s19 offen sc1 lds
    s_add_u32 m0, s17, 46080
    s_nop 0
    buffer_load_dwordx4 v62, s[44:47], s19 offen sc1 lds
    s_add_u32 m0, s18, 50176
    s_nop 0
    buffer_load_dword v63, s[44:47], s19 offen sc1 lds
    s_add_u32 s19, s19, 494080
L_f_gw5:
    s_and_b32 s9, s8, 0xc00
    s_cmp_eq_u32 s9, 0xc00
    s_cbranch_scc1 L_f_gg5
    buffer_load_dwordx4 v[68:71], v64, s[44:47], 0 offen sc1
    s_waitcnt vmcnt(0)
    v_min_u32 v69, v69, v70
    v_cmp_ne_u32 s[8:9], 0, v69
    s_and_b32 s8, s8, s9
    s_sub_u32 s10, s10, 1
    s_cselect_b32 s8, -1, s8
    s_cselect_b32 s10, 0, s10
    s_branch L_f_gw5
L_f_gg5:
    s_add_u32 m0, s17, 51200
    s_nop 0
    buffer_load_dwordx4 v60, s[44:47], s19 offen sc1 lds
    s_add_u32 m0, s18, 55296
    s_nop 0
    buffer_load_dword v61, s[44:47], s19 offen sc1 lds
    s_add_u32 m0, s17, 56320
    s_nop 0
    buffer_load_dwordx4 v62, s[44:47], s19 offen sc1 lds
    s_add_u32 m0, s18, 60416
    s_nop 0
    buffer_load_dword v63, s[44:47], s19 offen sc1 lds
    s_add_u32 s19, s19, 494080
    s_waitcnt vmcnt(13)
    v_mov_b32 v0, 1
    ds_write_b32 v7, v0
L_f_gw6:
    s_and_b32 s9, s8, 0x3000
    s_cmp_eq_u32 s9, 0x3000
    s_cbranch_scc1 L_f_gg6
    buffer_load_dwordx4 v[68:71], v64, s[44:47], 0 offen sc1
    s_waitcnt vmcnt(0)
    v_min_u32 v69, v69, v70
    v_cmp_ne_u32 s[8:9], 0, v69
    s_and_b32 s8, s8, s9
    s_sub_u32 s10, s10, 1
    s_cselect_b32 s8, -1, s8
    s_cselect_b32 s10, 0, s10
    s_branch L_f_gw6
L_f_gg6:
    s_add_u32 m0, s17, 61440
    s_nop 0
    buffer_load_dwordx4 v60, s[44:47], s19 offen sc1 lds
    s_add_u32 m0, s18, 65536
    s_nop 0
    buffer_load_dword v61, s[44:47], s19 offen sc1 lds
    s_add_u32 m0, s17, 66560
    s_nop 0
    buffer_load_dwordx4 v62, s[44:47], s19 offen sc1 lds
    s_add_u32 m0, s18, 70656
    s_nop 0
    buffer_load_dword v63, s[44:47], s19 offen sc1 lds
    s_add_u32 s19, s19, 494080
L_f_gw7:
    s_and_b32 s9, s8, 0xc000
    s_cmp_eq_u32 s9, 0xc000
    s_cbranch_scc1 L_f_gg7
    buffer_load_dwordx4 v[68:71], v64, s[44:47], 0 offen sc1
    s_waitcnt vmcnt(0)
    v_min_u32 v69, v69, v70
    v_cmp_ne_u32 s[8:9], 0, v69
    s_and_b32 s8, s8, s9
    s_sub_u32 s10, s10, 1
    s_cselect_b32 s8, -1, s8
    s_cselect_b32 s10, 0, s10
    s_branch L_f_gw7
L_f_gg7:
    s_add_u32 m0, s17, 71680
    s_nop 0
    buffer_load_dwordx4 v60, s[44:47], s19 offen sc1 lds
    s_add_u32 m0, s18, 75776
    s_nop 0
    buffer_load_dword v61, s[44:47], s19 offen sc1 lds
    s_add_u32 m0, s17, 76800
    s_nop 0
    buffer_load_dwordx4 v62, s[44:47], s19 offen sc1 lds
    s_add_u32 m0, s18, 80896
    s_nop 0
    buffer_load_dword v63, s[44:47], s19 offen sc1 lds
    s_add_u32 s19, s19, 494080
L_f_gw8:
    s_and_b32 s9, s8, 0x30000
    s_cmp_eq_u32 s9, 0x30000
    s_cbranch_scc1 L_f_gg8
    buffer_load_dwordx4 v[68:71], v64, s[44:47], 0 offen sc1
    s_waitcnt vmcnt(0)
    v_min_u32 v69, v69, v70
    v_cmp_ne_u32 s[8:9], 0, v69
    s_and_b32 s8, s8, s9
    s_sub_u32 s10, s10, 1
    s_cselect_b32 s8, -1, s8
    s_cselect_b32 s10, 0, s10
    s_branch L_f_gw8
L_f_gg8:
    s_add_u32 m0, s17, 81920
    s_nop 0
    buffer_load_dwordx4 v60, s[44:47], s19 offen sc1 lds
    s_add_u32 m0, s18, 86016
    s_nop 0
    buffer_load_dword v61, s[44:47], s19 offen sc1 lds
    s_add_u32 m0, s17, 87040
    s_nop 0
    buffer_load_dwordx4 v62, s[44:47], s19 offen sc1 lds
    s_add_u32 m0, s18, 91136
    s_nop 0
    buffer_load_dword v63, s[44:47], s19 offen sc1 lds
    s_add_u32 s19, s19, 494080
    s_waitcnt vmcnt(12)
    v_mov_b32 v0, 2
    ds_write_b32 v7, v0
L_f_gw9:
    s_and_b32 s9, s8, 0xc0000
    s_cmp_eq_u32 s9, 0xc0000
    s_cbranch_scc1 L_f_gg9
    buffer_load_dwordx4 v[68:71], v64, s[44:47], 0 offen sc1
    s_waitcnt vmcnt(0)
    v_min_u32 v69, v69, v70
    v_cmp_ne_u32 s[8:9], 0, v69
    s_and_b32 s8, s8, s9
    s_sub_u32 s10, s10, 1
    s_cselect_b32 s8, -1, s8
    s_cselect_b32 s10, 0, s10
    s_branch L_f_gw9
L_f_gg9:
    s_add_u32 m0, s17, 92160
    s_nop 0
    buffer_load_dwordx4 v60, s[44:47], s19 offen sc1 lds
    s_add_u32 m0, s18, 96256
    s_nop 0
    buffer_load_dword v61, s[44:47], s19 offen sc1 lds
    s_add_u32 m0, s17, 97280
    s_nop 0
    buffer_load_dwordx4 v62, s[44:47], s19 offen sc1 lds
    s_add_u32 m0, s18, 101376
    s_nop 0
    buffer_load_dword v63, s[44:47], s19 offen sc1 lds
    s_add_u32 s19, s19, 494080
L_f_gw10:
    s_and_b32 s9, s8, 0x300000
    s_cmp_eq_u32 s9, 0x300000
    s_cbranch_scc1 L_f_gg10
    buffer_load_dwordx4 v[68:71], v64, s[44:47], 0 offen sc1
    s_waitcnt vmcnt(0)
    v_min_u32 v69, v69, v70
    v_cmp_ne_u32 s[8:9], 0, v69
    s_and_b32 s8, s8, s9
    s_sub_u32 s10, s10, 1
    s_cselect_b32 s8, -1, s8
    s_cselect_b32 s10, 0, s10
    s_branch L_f_gw10
L_f_gg10:
    s_add_u32 m0, s17, 102400
    s_nop 0
    buffer_load_dwordx4 v60, s[44:47], s19 offen sc1 lds
    s_add_u32 m0, s18, 106496
    s_nop 0
    buffer_load_dword v61, s[44:47], s19 offen sc1 lds
    s_add_u32 m0, s17, 107520
    s_nop 0
    buffer_load_dwordx4 v62, s[44:47], s19 offen sc1 lds
    s_add_u32 m0, s18, 111616
    s_nop 0
    buffer_load_dword v63, s[44:47], s19 offen sc1 lds
    s_add_u32 s19, s19, 494080
L_f_gw11:
    s_and_b32 s9, s8, 0xc00000
    s_cmp_eq_u32 s9, 0xc00000
    s_cbranch_scc1 L_f_gg11
    buffer_load_dwordx4 v[68:71], v64, s[44:47], 0 offen sc1
    s_waitcnt vmcnt(0)
    v_min_u32 v69, v69, v70
    v_cmp_ne_u32 s[8:9], 0, v69
    s_and_b32 s8, s8, s9
    s_sub_u32 s10, s10, 1
    s_cselect_b32 s8, -1, s8
    s_cselect_b32 s10, 0, s10
    s_branch L_f_gw11
L_f_gg11:
    s_add_u32 m0, s17, 112640
    s_nop 0
    buffer_load_dwordx4 v60, s[44:47], s19 offen sc1 lds
    s_add_u32 m0, s18, 116736
    s_nop 0
    buffer_load_dword v61, s[44:47], s19 offen sc1 lds
    s_add_u32 m0, s17, 117760
    s_nop 0
    buffer_load_dwordx4 v62, s[44:47], s19 offen sc1 lds
    s_add_u32 m0, s18, 121856
    s_nop 0
    buffer_load_dword v63, s[44:47], s19 offen sc1 lds
    s_add_u32 s19, s19, 494080
L_f_gw12:
    s_and_b32 s9, s8, 0x3000000
    s_cmp_eq_u32 s9, 0x3000000
    s_cbranch_scc1 L_f_gg12
    buffer_load_dwordx4 v[68:71], v64, s[44:47], 0 offen sc1
    s_waitcnt vmcnt(0)
    v_min_u32 v69, v69, v70
    v_cmp_ne_u32 s[8:9], 0, v69
    s_and_b32 s8, s8, s9
    s_sub_u32 s10, s10, 1
    s_cselect_b32 s8, -1, s8
    s_cselect_b32 s10, 0, s10
    s_branch L_f_gw12
L_f_gg12:
    s_add_u32 m0, s17, 122880
    s_nop 0
    buffer_load_dwordx4 v60, s[44:47], s19 offen sc1 lds
    s_add_u32 m0, s18, 126976
    s_nop 0
    buffer_load_dword v61, s[44:47], s19 offen sc1 lds
    s_add_u32 m0, s17, 128000
    s_nop 0
    buffer_load_dwordx4 v62, s[44:47], s19 offen sc1 lds
    s_add_u32 m0, s18, 132096
    s_nop 0
    buffer_load_dword v63, s[44:47], s19 offen sc1 lds
    s_add_u32 s19, s19, 494080
L_f_gw13:
    s_and_b32 s9, s8, 0xc000000
    s_cmp_eq_u32 s9, 0xc000000
    s_cbranch_scc1 L_f_gg13
    buffer_load_dwordx4 v[68:71], v64, s[44:47], 0 offen sc1
    s_waitcnt vmcnt(0)
    v_min_u32 v69, v69, v70
    v_cmp_ne_u32 s[8:9], 0, v69
    s_and_b32 s8, s8, s9
    s_sub_u32 s10, s10, 1
    s_cselect_b32 s8, -1, s8
    s_cselect_b32 s10, 0, s10
    s_branch L_f_gw13
L_f_gg13:
    s_add_u32 m0, s17, 133120
    s_nop 0
    buffer_load_dwordx4 v60, s[44:47], s19 offen sc1 lds
    s_add_u32 m0, s18, 137216
    s_nop 0
    buffer_load_dword v61, s[44:47], s19 offen sc1 lds
    s_add_u32 m0, s17, 138240
    s_nop 0
    buffer_load_dwordx4 v62, s[44:47], s19 offen sc1 lds
    s_add_u32 m0, s18, 142336
    s_nop 0
    buffer_load_dword v63, s[44:47], s19 offen sc1 lds
    s_add_u32 s19, s19, 494080
L_f_gw14:
    s_and_b32 s9, s8, 0x30000000
    s_cmp_eq_u32 s9, 0x30000000
    s_cbranch_scc1 L_f_gg14
    buffer_load_dwordx4 v[68:71], v64, s[44:47], 0 offen sc1
    s_waitcnt vmcnt(0)
    v_min_u32 v69, v69, v70
    v_cmp_ne_u32 s[8:9], 0, v69
    s_and_b32 s8, s8, s9
    s_sub_u32 s10, s10, 1
    s_cselect_b32 s8, -1, s8
    s_cselect_b32 s10, 0, s10
    s_branch L_f_gw14
L_f_gg14:
    s_add_u32 m0, s17, 143360
    s_nop 0
    buffer_load_dwordx4 v60, s[44:47], s19 offen sc1 lds
    s_add_u32 m0, s18, 147456
    s_nop 0
    buffer_load_dword v61, s[44:47], s19 offen sc1 lds
    s_add_u32 m0, s17, 148480
    s_nop 0
    buffer_load_dwordx4 v62, s[44:47], s19 offen sc1 lds
    s_add_u32 m0, s18, 152576
    s_nop 0
    buffer_load_dword v63, s[44:47], s19 offen sc1 lds
    s_add_u32 s19, s19, 494080
L_f_gw15:
    s_and_b32 s9, s8, 0xc0000000
    s_cmp_eq_u32 s9, 0xc0000000
    s_cbranch_scc1 L_f_gg15
    buffer_load_dwordx4 v[68:71], v64, s[44:47], 0 offen sc1
    s_waitcnt vmcnt(0)
    v_min_u32 v69, v69, v70
    v_cmp_ne_u32 s[8:9], 0, v69
    s_and_b32 s8, s8, s9
    s_sub_u32 s10, s10, 1
    s_cselect_b32 s8, -1, s8
    s_cselect_b32 s10, 0, s10
    s_branch L_f_gw15
L_f_gg15:
    s_add_u32 m0, s17, 153600
    s_nop 0
    buffer_load_dwordx4 v60, s[44:47], s19 offen sc1 lds
    s_add_u32 m0, s18, 157696
    s_nop 0
    buffer_load_dword v61, s[44:47], s19 offen sc1 lds
    s_add_u32 m0, s17, 158720
    s_nop 0
    buffer_load_dwordx4 v62, s[44:47], s19 offen sc1 lds
    s_add_u32 m0, s18, 162816
    s_nop 0
    buffer_load_dword v63, s[44:47], s19 offen sc1 lds
    s_lshl_b32 s8, s41, 2
    s_add_u32 s8, s8, s29
    s_lshl_b32 s8, s8, 6
    v_add_u32 v68, s8, v2
    v_min_u32 v68, 6399, v68
    v_mul_u32_u24 v69, 6554, v68
    v_lshrrev_b32 v69, 16, v69
    v_mul_u32_u24 v70, 640, v69
    v_lshl_add_u32 v68, v68, 6, v70
    s_and_b32 s8, s40, 1
    s_mul_i32 s8, s8, 640
    s_mov_b32 s48, s6
    s_mov_b32 s49, s7
    s_mov_b32 s50, 819200
    s_mov_b32 s51, 0x20000
    buffer_load_dword v70, v68, s[48:51], s8 offen
    s_waitcnt vmcnt(1)
    v_mov_b32 v0, 3
    ds_write_b32 v7, v0
L_f_hq:
    ds_read_b32 v0, v1 offset:64
    s_waitcnt lgkmcnt(0)
    v_cmp_gt_u32 vcc, 2, v0
    s_cbranch_vccz L_f_hw
    s_sleep 4
    s_branch L_f_hq
L_f_hw:
    buffer_load_dword v68, v65, s[44:47], 0 offen sc1
    buffer_load_dword v69, v66, s[44:47], 0 offen sc1
    s_waitcnt vmcnt(2)
    v_mov_b32 v0, 3
    ds_write_b32 v7, v0
    s_waitcnt vmcnt(0)
    v_min_u32 v68, v68, v69
    v_cmp_eq_u32 s[8:9], 0, v68
    s_or_b32 s8, s8, s9
    s_and_b32 s8, s8, 0x7ffffff
    s_cbranch_scc0 L_f_hg
    s_sub_u32 s10, s10, 1
    s_cselect_b32 s10, 0, s10
    s_cbranch_scc1 L_f_hg
    s_sleep 2
    s_branch L_f_hw
L_f_hg:
    buffer_load_dwordx4 v[16:19], v9, s[44:47], s16 offen sc1
    buffer_load_dwordx4 v[20:23], v10, s[44:47], s26 offen sc1
    buffer_load_dwordx4 v[24:27], v11, s[44:47], s26 offen sc1
    buffer_load_dwordx4 v[28:31], v12, s[44:47], s26 offen sc1
    buffer_load_dwordx4 v[32:35], v8, s[44:47], s16 offen sc1
    s_add_u32 s16, s16, 4096
    s_add_u32 s26, s26, 81920
    s_cmp_eq_u32 s16, s22
    s_cselect_b32 s16, s20, s16
    s_cselect_b32 s26, s23, s26
    buffer_load_dwordx4 v[36:39], v9, s[44:47], s16 offen sc1
    buffer_load_dwordx4 v[40:43], v10, s[44:47], s26 offen sc1
    buffer_load_dwordx4 v[44:47], v11, s[44:47], s26 offen sc1
    buffer_load_dwordx4 v[48:51], v12, s[44:47], s26 offen sc1
    buffer_load_dwordx4 v[52:55], v8, s[44:47], s16 offen sc1
    s_add_u32 s16, s16, 4096
    s_add_u32 s26, s26, 81920
    s_cmp_eq_u32 s16, s22
    s_cselect_b32 s16, s20, s16
    s_cselect_b32 s26, s23, s26
    buffer_load_dwordx4 v[56:59], v9, s[44:47], s16 offen sc1
    buffer_load_dwordx4 v[60:63], v10, s[44:47], s26 offen sc1
    buffer_load_dwordx4 v[64:67], v11, s[44:47], s26 offen sc1
    buffer_load_dwordx4 v[68:71], v12, s[44:47], s26 offen sc1
    buffer_load_dwordx4 v[72:75], v8, s[44:47], s16 offen sc1
    s_add_u32 s16, s16, 4096
    s_add_u32 s26, s26, 81920
    s_cmp_eq_u32 s16, s22
    s_cselect_b32 s16, s20, s16
    s_cselect_b32 s26, s23, s26
    s_setprio 0
    s_waitcnt vmcnt(13)
    v_mfma_f32_32x32x16_bf16 v[88:103], v[20:23], v[16:19], 0
    s_waitcnt vmcnt(12)
    v_mfma_f32_32x32x16_bf16 v[104:119], v[24:27], v[16:19], 0
    buffer_load_dwordx4 v[16:19], v9, s[44:47], s16 offen sc1
    s_waitcnt vmcnt(11)
    v_mfma_f32_32x32x16_bf16 v[120:135], v[20:23], v[32:35], 0
    buffer_load_dwordx4 v[20:23], v10, s[44:47], s26 offen sc1
    v_mfma_f32_32x32x16_bf16 v[136:151], v[24:27], v[32:35], 0
    buffer_load_dwordx4 v[24:27], v11, s[44:47], s26 offen sc1
    v_mfma_f32_32x32x16_bf16 v[152:167], v[28:31], v[32:35], 0
    buffer_load_dwordx4 v[28:31], v12, s[44:47], s26 offen sc1
    buffer_load_dwordx4 v[32:35], v8, s[44:47], s16 offen sc1
    s_add_u32 s16, s16, 4096
    s_add_u32 s26, s26, 81920
    s_cmp_eq_u32 s16, s22
    s_cselect_b32 s16, s20, s16
    s_cselect_b32 s26, s23, s26
    s_waitcnt vmcnt(13)
    v_mfma_f32_32x32x16_bf16 v[88:103], v[40:43], v[36:39], v[88:103]
    s_waitcnt vmcnt(12)
    v_mfma_f32_32x32x16_bf16 v[104:119], v[44:47], v[36:39], v[104:119]
    buffer_load_dwordx4 v[36:39], v9, s[44:47], s16 offen sc1
    s_waitcnt vmcnt(11)
    v_mfma_f32_32x32x16_bf16 v[120:135], v[40:43], v[52:55], v[120:135]
    buffer_load_dwordx4 v[40:43], v10, s[44:47], s26 offen sc1
    v_mfma_f32_32x32x16_bf16 v[136:151], v[44:47], v[52:55], v[136:151]
    buffer_load_dwordx4 v[44:47], v11, s[44:47], s26 offen sc1
    v_mfma_f32_32x32x16_bf16 v[152:167], v[48:51], v[52:55], v[152:167]
    buffer_load_dwordx4 v[48:51], v12, s[44:47], s26 offen sc1
    buffer_load_dwordx4 v[52:55], v8, s[44:47], s16 offen sc1
    s_add_u32 s16, s16, 4096
    s_add_u32 s26, s26, 81920
    s_cmp_eq_u32 s16, s22
    s_cselect_b32 s16, s20, s16
    s_cselect_b32 s26, s23, s26
    s_waitcnt vmcnt(13)
    v_mfma_f32_32x32x16_bf16 v[88:103], v[60:63], v[56:59], v[88:103]
    s_waitcnt vmcnt(12)
    v_mfma_f32_32x32x16_bf16 v[104:119], v[64:67], v[56:59], v[104:119]
    buffer_load_dwordx4 v[56:59], v9, s[44:47], s16 offen sc1
    s_waitcnt vmcnt(11)
    v_mfma_f32_32x32x16_bf16 v[120:135], v[60:63], v[72:75], v[120:135]
    buffer_load_dwordx4 v[60:63], v10, s[44:47], s26 offen sc1
    v_mfma_f32_32x32x16_bf16 v[136:151], v[64:67], v[72:75], v[136:151]
    buffer_load_dwordx4 v[64:67], v11, s[44:47], s26 offen sc1
    v_mfma_f32_32x32x16_bf16 v[152:167], v[68:71], v[72:75], v[152:167]
    buffer_load_dwordx4 v[68:71], v12, s[44:47], s26 offen sc1
    buffer_load_dwordx4 v[72:75], v8, s[44:47], s16 offen sc1
    s_add_u32 s16, s16, 4096
    s_add_u32 s26, s26, 81920
    s_cmp_eq_u32 s16, s22
    s_cselect_b32 s16, s20, s16
    s_cselect_b32 s26, s23, s26
    s_waitcnt vmcnt(13)
    v_mfma_f32_32x32x16_bf16 v[88:103], v[20:23], v[16:19], v[88:103]
    s_waitcnt vmcnt(12)
    v_mfma_f32_32x32x16_bf16 v[104:119], v[24:27], v[16:19], v[104:119]
    buffer_load_dwordx4 v[16:19], v9, s[44:47], s16 offen sc1
    s_waitcnt vmcnt(11)
    v_mfma_f32_32x32x16_bf16 v[120:135], v[20:23], v[32:35], v[120:135]
    buffer_load_dwordx4 v[20:23], v10, s[44:47], s26 offen sc1
    v_mfma_f32_32x32x16_bf16 v[136:151], v[24:27], v[32:35], v[136:151]
    buffer_load_dwordx4 v[24:27], v11, s[44:47], s26 offen sc1
    v_mfma_f32_32x32x16_bf16 v[152:167], v[28:31], v[32:35], v[152:167]
    buffer_load_dwordx4 v[28:31], v12, s[44:47], s26 offen sc1
    buffer_load_dwordx4 v[32:35], v8, s[44:47], s16 offen sc1
    s_add_u32 s16, s16, 4096
    s_add_u32 s26, s26, 81920
    s_cmp_eq_u32 s16, s22
    s_cselect_b32 s16, s20, s16
    s_cselect_b32 s26, s23, s26
    s_waitcnt vmcnt(13)
    v_mfma_f32_32x32x16_bf16 v[88:103], v[40:43], v[36:39], v[88:103]
    s_waitcnt vmcnt(12)
    v_mfma_f32_32x32x16_bf16 v[104:119], v[44:47], v[36:39], v[104:119]
    buffer_load_dwordx4 v[36:39], v9, s[44:47], s16 offen sc1
    s_waitcnt vmcnt(11)
    v_mfma_f32_32x32x16_bf16 v[120:135], v[40:43], v[52:55], v[120:135]
    buffer_load_dwordx4 v[40:43], v10, s[44:47], s26 offen sc1
    v_mfma_f32_32x32x16_bf16 v[136:151], v[44:47], v[52:55], v[136:151]
    buffer_load_dwordx4 v[44:47], v11, s[44:47], s26 offen sc1
    v_mfma_f32_32x32x16_bf16 v[152:167], v[48:51], v[52:55], v[152:167]
    buffer_load_dwordx4 v[48:51], v12, s[44:47], s26 offen sc1
    buffer_load_dwordx4 v[52:55], v8, s[44:47], s16 offen sc1
    s_add_u32 s16, s16, 4096
    s_add_u32 s26, s26, 81920
    s_cmp_eq_u32 s16, s22
    s_cselect_b32 s16, s20, s16
    s_cselect_b32 s26, s23, s26
    s_waitcnt vmcnt(13)
    v_mfma_f32_32x32x16_bf16 v[88:103], v[60:63], v[56:59], v[88:103]
    s_waitcnt vmcnt(12)
    v_mfma_f32_32x32x16_bf16 v[104:119], v[64:67], v[56:59], v[104:119]
    buffer_load_dwordx4 v[56:59], v9, s[44:47], s16 offen sc1
    s_waitcnt vmcnt(11)
    v_mfma_f32_32x32x16_bf16 v[120:135], v[60:63], v[72:75], v[120:135]
    buffer_load_dwordx4 v[60:63], v10, s[44:47], s26 offen sc1
    v_mfma_f32_32x32x16_bf16 v[136:151], v[64:67], v[72:75], v[136:151]
    buffer_load_dwordx4 v[64:67], v11, s[44:47], s26 offen sc1
    v_mfma_f32_32x32x16_bf16 v[152:167], v[68:71], v[72:75], v[152:167]
    buffer_load_dwordx4 v[68:71], v12, s[44:47], s26 offen sc1
    buffer_load_dwordx4 v[72:75], v8, s[44:47], s16 offen sc1
    s_add_u32 s16, s16, 4096
    s_add_u32 s26, s26, 81920
    s_cmp_eq_u32 s16, s22
    s_cselect_b32 s16, s20, s16
    s_cselect_b32 s26, s23, s26
    s_waitcnt vmcnt(13)
    v_mfma_f32_32x32x16_bf16 v[88:103], v[20:23], v[16:19], v[88:103]
    s_waitcnt vmcnt(12)
    v_mfma_f32_32x32x16_bf16 v[104:119], v[24:27], v[16:19], v[104:119]
    buffer_load_dwordx4 v[16:19], v9, s[44:47], s16 offen sc1
    s_waitcnt vmcnt(11)
    v_mfma_f32_32x32x16_bf16 v[120:135], v[20:23], v[32:35], v[120:135]
    buffer_load_dwordx4 v[20:23], v10, s[44:47], s26 offen sc1
    v_mfma_f32_32x32x16_bf16 v[136:151], v[24:27], v[32:35], v[136:151]
    buffer_load_dwordx4 v[24:27], v11, s[44:47], s26 offen sc1
    v_mfma_f32_32x32x16_bf16 v[152:167], v[28:31], v[32:35], v[152:167]
    buffer_load_dwordx4 v[28:31], v12, s[44:47], s26 offen sc1
    buffer_load_dwordx4 v[32:35], v8, s[44:47], s16 offen sc1
    s_add_u32 s16, s16, 4096
    s_add_u32 s26, s26, 81920
    s_cmp_eq_u32 s16, s22
    s_cselect_b32 s16, s20, s16
    s_cselect_b32 s26, s23, s26
    s_waitcnt vmcnt(13)
    v_mfma_f32_32x32x16_bf16 v[88:103], v[40:43], v[36:39], v[88:103]
    s_waitcnt vmcnt(12)
    v_mfma_f32_32x32x16_bf16 v[104:119], v[44:47], v[36:39], v[104:119]
    buffer_load_dwordx4 v[36:39], v9, s[44:47], s16 offen sc1
    s_waitcnt vmcnt(11)
    v_mfma_f32_32x32x16_bf16 v[120:135], v[40:43], v[52:55], v[120:135]
    buffer_load_dwordx4 v[40:43], v10, s[44:47], s26 offen sc1
    v_mfma_f32_32x32x16_bf16 v[136:151], v[44:47], v[52:55], v[136:151]
    buffer_load_dwordx4 v[44:47], v11, s[44:47], s26 offen sc1
    v_mfma_f32_32x32x16_bf16 v[152:167], v[48:51], v[52:55], v[152:167]
    buffer_load_dwordx4 v[48:51], v12, s[44:47], s26 offen sc1
    buffer_load_dwordx4 v[52:55], v8, s[44:47], s16 offen sc1
    s_add_u32 s16, s16, 4096
    s_add_u32 s26, s26, 81920
    s_cmp_eq_u32 s16, s22
    s_cselect_b32 s16, s20, s16
    s_cselect_b32 s26, s23, s26
    s_waitcnt vmcnt(13)
    v_mfma_f32_32x32x16_bf16 v[88:103], v[60:63], v[56:59], v[88:103]
    s_waitcnt vmcnt(12)
    v_mfma_f32_32x32x16_bf16 v[104:119], v[64:67], v[56:59], v[104:119]
    buffer_load_dwordx4 v[56:59], v9, s[44:47], s16 offen sc1
    s_waitcnt vmcnt(11)
    v_mfma_f32_32x32x16_bf16 v[120:135], v[60:63], v[72:75], v[120:135]
    buffer_load_dwordx4 v[60:63], v10, s[44:47], s26 offen sc1
    v_mfma_f32_32x32x16_bf16 v[136:151], v[64:67], v[72:75], v[136:151]
    buffer_load_dwordx4 v[64:67], v11, s[44:47], s26 offen sc1
    v_mfma_f32_32x32x16_bf16 v[152:167], v[68:71], v[72:75], v[152:167]
    buffer_load_dwordx4 v[68:71], v12, s[44:47], s26 offen sc1
    buffer_load_dwordx4 v[72:75], v8, s[44:47], s16 offen sc1
    s_add_u32 s16, s16, 4096
    s_add_u32 s26, s26, 81920
    s_cmp_eq_u32 s16, s22
    s_cselect_b32 s16, s20, s16
    s_cselect_b32 s26, s23, s26
    s_waitcnt vmcnt(13)
    v_mfma_f32_32x32x16_bf16 v[88:103], v[20:23], v[16:19], v[88:103]
    s_waitcnt vmcnt(12)
    v_mfma_f32_32x32x16_bf16 v[104:119], v[24:27], v[16:19], v[104:119]
    buffer_load_dwordx4 v[16:19], v9, s[44:47], s16 offen sc1
    s_waitcnt vmcnt(11)
    v_mfma_f32_32x32x16_bf16 v[120:135], v[20:23], v[32:35], v[120:135]
    buffer_load_dwordx4 v[20:23], v10, s[44:47], s26 offen sc1
    v_mfma_f32_32x32x16_bf16 v[136:151], v[24:27], v[32:35], v[136:151]
    buffer_load_dwordx4 v[24:27], v11, s[44:47], s26 offen sc1
    v_mfma_f32_32x32x16_bf16 v[152:167], v[28:31], v[32:35], v[152:167]
    buffer_load_dwordx4 v[28:31], v12, s[44:47], s26 offen sc1
    buffer_load_dwordx4 v[32:35], v8, s[44:47], s16 offen sc1
    s_add_u32 s16, s16, 4096
    s_add_u32 s26, s26, 81920
    s_cmp_eq_u32 s16, s22
    s_cselect_b32 s16, s20, s16
    s_cselect_b32 s26, s23, s26
    s_waitcnt vmcnt(13)
    v_mfma_f32_32x32x16_bf16 v[88:103], v[40:43], v[36:39], v[88:103]
    s_waitcnt vmcnt(12)
    v_mfma_f32_32x32x16_bf16 v[104:119], v[44:47], v[36:39], v[104:119]
    buffer_load_dwordx4 v[36:39], v9, s[44:47], s16 offen sc1
    s_waitcnt vmcnt(11)
    v_mfma_f32_32x32x16_bf16 v[120:135], v[40:43], v[52:55], v[120:135]
    buffer_load_dwordx4 v[40:43], v10, s[44:47], s26 offen sc1
    v_mfma_f32_32x32x16_bf16 v[136:151], v[44:47], v[52:55], v[136:151]
    buffer_load_dwordx4 v[44:47], v11, s[44:47], s26 offen sc1
    v_mfma_f32_32x32x16_bf16 v[152:167], v[48:51], v[52:55], v[152:167]
    buffer_load_dwordx4 v[48:51], v12, s[44:47], s26 offen sc1
    buffer_load_dwordx4 v[52:55], v8, s[44:47], s16 offen sc1
    s_add_u32 s16, s16, 4096
    s_add_u32 s26, s26, 81920
    s_cmp_eq_u32 s16, s22
    s_cselect_b32 s16, s20, s16
    s_cselect_b32 s26, s23, s26
    s_waitcnt vmcnt(13)
    v_mfma_f32_32x32x16_bf16 v[88:103], v[60:63], v[56:59], v[88:103]
    s_waitcnt vmcnt(12)
    v_mfma_f32_32x32x16_bf16 v[104:119], v[64:67], v[56:59], v[104:119]
    buffer_load_dwordx4 v[56:59], v9, s[44:47], s16 offen sc1
    s_waitcnt vmcnt(11)
    v_mfma_f32_32x32x16_bf16 v[120:135], v[60:63], v[72:75], v[120:135]
    buffer_load_dwordx4 v[60:63], v10, s[44:47], s26 offen sc1
    v_mfma_f32_32x32x16_bf16 v[136:151], v[64:67], v[72:75], v[136:151]
    buffer_load_dwordx4 v[64:67], v11, s[44:47], s26 offen sc1
    v_mfma_f32_32x32x16_bf16 v[152:167], v[68:71], v[72:75], v[152:167]
    buffer_load_dwordx4 v[68:71], v12, s[44:47], s26 offen sc1
    buffer_load_dwordx4 v[72:75], v8, s[44:47], s16 offen sc1
    s_add_u32 s16, s16, 4096
    s_add_u32 s26, s26, 81920
    s_cmp_eq_u32 s16, s22
    s_cselect_b32 s16, s20, s16
    s_cselect_b32 s26, s23, s26
    s_waitcnt vmcnt(13)
    v_mfma_f32_32x32x16_bf16 v[88:103], v[20:23], v[16:19], v[88:103]
    s_waitcnt vmcnt(12)
    v_mfma_f32_32x32x16_bf16 v[104:119], v[24:27], v[16:19], v[104:119]
    buffer_load_dwordx4 v[16:19], v9, s[44:47], s16 offen sc1
    s_waitcnt vmcnt(11)
    v_mfma_f32_32x32x16_bf16 v[120:135], v[20:23], v[32:35], v[120:135]
    buffer_load_dwordx4 v[20:23], v10, s[44:47], s26 offen sc1
    v_mfma_f32_32x32x16_bf16 v[136:151], v[24:27], v[32:35], v[136:151]
    buffer_load_dwordx4 v[24:27], v11, s[44:47], s26 offen sc1
    v_mfma_f32_32x32x16_bf16 v[152:167], v[28:31], v[32:35], v[152:167]
    buffer_load_dwordx4 v[28:31], v12, s[44:47], s26 offen sc1
    buffer_load_dwordx4 v[32:35], v8, s[44:47], s16 offen sc1
    s_add_u32 s16, s16, 4096
    s_add_u32 s26, s26, 81920
    s_cmp_eq_u32 s16, s22
    s_cselect_b32 s16, s20, s16
    s_cselect_b32 s26, s23, s26
    s_waitcnt vmcnt(13)
    v_mfma_f32_32x32x16_bf16 v[88:103], v[40:43], v[36:39], v[88:103]
    s_waitcnt vmcnt(12)
    v_mfma_f32_32x32x16_bf16 v[104:119], v[44:47], v[36:39], v[104:119]
    buffer_load_dwordx4 v[36:39], v9, s[44:47], s16 offen sc1
    s_waitcnt vmcnt(11)
    v_mfma_f32_32x32x16_bf16 v[120:135], v[40:43], v[52:55], v[120:135]
    buffer_load_dwordx4 v[40:43], v10, s[44:47], s26 offen sc1
    v_mfma_f32_32x32x16_bf16 v[136:151], v[44:47], v[52:55], v[136:151]
    buffer_load_dwordx4 v[44:47], v11, s[44:47], s26 offen sc1
    v_mfma_f32_32x32x16_bf16 v[152:167], v[48:51], v[52:55], v[152:167]
    buffer_load_dwordx4 v[48:51], v12, s[44:47], s26 offen sc1
    buffer_load_dwordx4 v[52:55], v8, s[44:47], s16 offen sc1
    s_add_u32 s16, s16, 4096
    s_add_u32 s26, s26, 81920
    s_cmp_eq_u32 s16, s22
    s_cselect_b32 s16, s20, s16
    s_cselect_b32 s26, s23, s26
    s_waitcnt vmcnt(13)
    v_mfma_f32_32x32x16_bf16 v[88:103], v[60:63], v[56:59], v[88:103]
    s_waitcnt vmcnt(12)
    v_mfma_f32_32x32x16_bf16 v[104:119], v[64:67], v[56:59], v[104:119]
    buffer_load_dwordx4 v[56:59], v9, s[44:47], s16 offen sc1
    s_waitcnt vmcnt(11)
    v_mfma_f32_32x32x16_bf16 v[120:135], v[60:63], v[72:75], v[120:135]
    buffer_load_dwordx4 v[60:63], v10, s[44:47], s26 offen sc1
    v_mfma_f32_32x32x16_bf16 v[136:151], v[64:67], v[72:75], v[136:151]
    buffer_load_dwordx4 v[64:67], v11, s[44:47], s26 offen sc1
    v_mfma_f32_32x32x16_bf16 v[152:167], v[68:71], v[72:75], v[152:167]
    buffer_load_dwordx4 v[68:71], v12, s[44:47], s26 offen sc1
    buffer_load_dwordx4 v[72:75], v8, s[44:47], s16 offen sc1
    s_add_u32 s16, s16, 4096
    s_add_u32 s26, s26, 81920
    s_cmp_eq_u32 s16, s22
    s_cselect_b32 s16, s20, s16
    s_cselect_b32 s26, s23, s26
    s_waitcnt vmcnt(13)
    v_mfma_f32_32x32x16_bf16 v[88:103], v[20:23], v[16:19], v[88:103]
    s_waitcnt vmcnt(12)
    v_mfma_f32_32x32x16_bf16 v[104:119], v[24:27], v[16:19], v[104:119]
    buffer_load_dwordx4 v[16:19], v9, s[44:47], s16 offen sc1
    s_waitcnt vmcnt(11)
    v_mfma_f32_32x32x16_bf16 v[120:135], v[20:23], v[32:35], v[120:135]
    buffer_load_dwordx4 v[20:23], v10, s[44:47], s26 offen sc1
    v_mfma_f32_32x32x16_bf16 v[136:151], v[24:27], v[32:35], v[136:151]
    buffer_load_dwordx4 v[24:27], v11, s[44:47], s26 offen sc1
    v_mfma_f32_32x32x16_bf16 v[152:167], v[28:31], v[32:35], v[152:167]
    buffer_load_dwordx4 v[28:31], v12, s[44:47], s26 offen sc1
    buffer_load_dwordx4 v[32:35], v8, s[44:47], s16 offen sc1
    s_add_u32 s16, s16, 4096
    s_add_u32 s26, s26, 81920
    s_cmp_eq_u32 s16, s22
    s_cselect_b32 s16, s20, s16
    s_cselect_b32 s26, s23, s26
    s_waitcnt vmcnt(13)
    v_mfma_f32_32x32x16_bf16 v[88:103], v[40:43], v[36:39], v[88:103]
    s_waitcnt vmcnt(12)
    v_mfma_f32_32x32x16_bf16 v[104:119], v[44:47], v[36:39], v[104:119]
    buffer_load_dwordx4 v[36:39], v9, s[44:47], s16 offen sc1
    s_waitcnt vmcnt(11)
    v_mfma_f32_32x32x16_bf16 v[120:135], v[40:43], v[52:55], v[120:135]
    buffer_load_dwordx4 v[40:43], v10, s[44:47], s26 offen sc1
    v_mfma_f32_32x32x16_bf16 v[136:151], v[44:47], v[52:55], v[136:151]
    buffer_load_dwordx4 v[44:47], v11, s[44:47], s26 offen sc1
    v_mfma_f32_32x32x16_bf16 v[152:167], v[48:51], v[52:55], v[152:167]
    buffer_load_dwordx4 v[48:51], v12, s[44:47], s26 offen sc1
    buffer_load_dwordx4 v[52:55], v8, s[44:47], s16 offen sc1
    s_add_u32 s16, s16, 4096
    s_add_u32 s26, s26, 81920
    s_cmp_eq_u32 s16, s22
    s_cselect_b32 s16, s20, s16
    s_cselect_b32 s26, s23, s26
    s_waitcnt vmcnt(13)
    v_mfma_f32_32x32x16_bf16 v[88:103], v[60:63], v[56:59], v[88:103]
    s_waitcnt vmcnt(12)
    v_mfma_f32_32x32x16_bf16 v[104:119], v[64:67], v[56:59], v[104:119]
    buffer_load_dwordx4 v[56:59], v9, s[44:47], s16 offen sc1
    s_waitcnt vmcnt(11)
    v_mfma_f32_32x32x16_bf16 v[120:135], v[60:63], v[72:75], v[120:135]
    buffer_load_dwordx4 v[60:63], v10, s[44:47], s26 offen sc1
    v_mfma_f32_32x32x16_bf16 v[136:151], v[64:67], v[72:75], v[136:151]
    buffer_load_dwordx4 v[64:67], v11, s[44:47], s26 offen sc1
    v_mfma_f32_32x32x16_bf16 v[152:167], v[68:71], v[72:75], v[152:167]
    buffer_load_dwordx4 v[68:71], v12, s[44:47], s26 offen sc1
    buffer_load_dwordx4 v[72:75], v8, s[44:47], s16 offen sc1
    s_add_u32 s16, s16, 4096
    s_add_u32 s26, s26, 81920
    s_cmp_eq_u32 s16, s22
    s_cselect_b32 s16, s20, s16
    s_cselect_b32 s26, s23, s26
    s_waitcnt vmcnt(13)
    v_mfma_f32_32x32x16_bf16 v[88:103], v[20:23], v[16:19], v[88:103]
    s_waitcnt vmcnt(12)
    v_mfma_f32_32x32x16_bf16 v[104:119], v[24:27], v[16:19], v[104:119]
    buffer_load_dwordx4 v[16:19], v9, s[44:47], s16 offen sc1
    s_waitcnt vmcnt(11)
    v_mfma_f32_32x32x16_bf16 v[120:135], v[20:23], v[32:35], v[120:135]
    buffer_load_dwordx4 v[20:23], v10, s[44:47], s26 offen sc1
    v_mfma_f32_32x32x16_bf16 v[136:151], v[24:27], v[32:35], v[136:151]
    buffer_load_dwordx4 v[24:27], v11, s[44:47], s26 offen sc1
    v_mfma_f32_32x32x16_bf16 v[152:167], v[28:31], v[32:35], v[152:167]
    buffer_load_dwordx4 v[28:31], v12, s[44:47], s26 offen sc1
    buffer_load_dwordx4 v[32:35], v8, s[44:47], s16 offen sc1
    s_add_u32 s16, s16, 4096
    s_add_u32 s26, s26, 81920
    s_cmp_eq_u32 s16, s22
    s_cselect_b32 s16, s20, s16
    s_cselect_b32 s26, s23, s26
    s_waitcnt vmcnt(13)
    v_mfma_f32_32x32x16_bf16 v[88:103], v[40:43], v[36:39], v[88:103]
    s_waitcnt vmcnt(12)
    v_mfma_f32_32x32x16_bf16 v[104:119], v[44:47], v[36:39], v[104:119]
    buffer_load_dwordx4 v[36:39], v9, s[44:47], s16 offen sc1
    s_waitcnt vmcnt(11)
    v_mfma_f32_32x32x16_bf16 v[120:135], v[40:43], v[52:55], v[120:135]
    buffer_load_dwordx4 v[40:43], v10, s[44:47], s26 offen sc1
    v_mfma_f32_32x32x16_bf16 v[136:151], v[44:47], v[52:55], v[136:151]
    buffer_load_dwordx4 v[44:47], v11, s[44:47], s26 offen sc1
    v_mfma_f32_32x32x16_bf16 v[152:167], v[48:51], v[52:55], v[152:167]
    buffer_load_dwordx4 v[48:51], v12, s[44:47], s26 offen sc1
    buffer_load_dwordx4 v[52:55], v8, s[44:47], s16 offen sc1
    s_add_u32 s16, s16, 4096
    s_add_u32 s26, s26, 81920
    s_cmp_eq_u32 s16, s22
    s_cselect_b32 s16, s20, s16
    s_cselect_b32 s26, s23, s26
    s_waitcnt vmcnt(13)
    v_mfma_f32_32x32x16_bf16 v[88:103], v[60:63], v[56:59], v[88:103]
    s_waitcnt vmcnt(12)
    v_mfma_f32_32x32x16_bf16 v[104:119], v[64:67], v[56:59], v[104:119]
    buffer_load_dwordx4 v[56:59], v9, s[44:47], s16 offen sc1
    s_waitcnt vmcnt(11)
    v_mfma_f32_32x32x16_bf16 v[120:135], v[60:63], v[72:75], v[120:135]
    buffer_load_dwordx4 v[60:63], v10, s[44:47], s26 offen sc1
    v_mfma_f32_32x32x16_bf16 v[136:151], v[64:67], v[72:75], v[136:151]
    buffer_load_dwordx4 v[64:67], v11, s[44:47], s26 offen sc1
    v_mfma_f32_32x32x16_bf16 v[152:167], v[68:71], v[72:75], v[152:167]
    buffer_load_dwordx4 v[68:71], v12, s[44:47], s26 offen sc1
    buffer_load_dwordx4 v[72:75], v8, s[44:47], s16 offen sc1
    s_add_u32 s16, s16, 4096
    s_add_u32 s26, s26, 81920
    s_cmp_eq_u32 s16, s22
    s_cselect_b32 s16, s20, s16
    s_cselect_b32 s26, s23, s26
    s_waitcnt vmcnt(13)
    v_mfma_f32_32x32x16_bf16 v[88:103], v[20:23], v[16:19], v[88:103]
    s_waitcnt vmcnt(12)
    v_mfma_f32_32x32x16_bf16 v[104:119], v[24:27], v[16:19], v[104:119]
    buffer_load_dwordx4 v[16:19], v9, s[44:47], s16 offen sc1
    s_waitcnt vmcnt(11)
    v_mfma_f32_32x32x16_bf16 v[120:135], v[20:23], v[32:35], v[120:135]
    buffer_load_dwordx4 v[20:23], v10, s[44:47], s26 offen sc1
    v_mfma_f32_32x32x16_bf16 v[136:151], v[24:27], v[32:35], v[136:151]
    buffer_load_dwordx4 v[24:27], v11, s[44:47], s26 offen sc1
    v_mfma_f32_32x32x16_bf16 v[152:167], v[28:31], v[32:35], v[152:167]
    buffer_load_dwordx4 v[28:31], v12, s[44:47], s26 offen sc1
    buffer_load_dwordx4 v[32:35], v8, s[44:47], s16 offen sc1
    s_add_u32 s16, s16, 4096
    s_add_u32 s26, s26, 81920
    s_cmp_eq_u32 s16, s22
    s_cselect_b32 s16, s20, s16
    s_cselect_b32 s26, s23, s26
    s_waitcnt vmcnt(13)
    v_mfma_f32_32x32x16_bf16 v[88:103], v[40:43], v[36:39], v[88:103]
    s_waitcnt vmcnt(12)
    v_mfma_f32_32x32x16_bf16 v[104:119], v[44:47], v[36:39], v[104:119]
    buffer_load_dwordx4 v[36:39], v9, s[44:47], s16 offen sc1
    s_waitcnt vmcnt(11)
    v_mfma_f32_32x32x16_bf16 v[120:135], v[40:43], v[52:55], v[120:135]
    buffer_load_dwordx4 v[40:43], v10, s[44:47], s26 offen sc1
    v_mfma_f32_32x32x16_bf16 v[136:151], v[44:47], v[52:55], v[136:151]
    buffer_load_dwordx4 v[44:47], v11, s[44:47], s26 offen sc1
    v_mfma_f32_32x32x16_bf16 v[152:167], v[48:51], v[52:55], v[152:167]
    buffer_load_dwordx4 v[48:51], v12, s[44:47], s26 offen sc1
    buffer_load_dwordx4 v[52:55], v8, s[44:47], s16 offen sc1
    s_add_u32 s16, s16, 4096
    s_add_u32 s26, s26, 81920
    s_cmp_eq_u32 s16, s22
    s_cselect_b32 s16, s20, s16
    s_cselect_b32 s26, s23, s26
    s_waitcnt vmcnt(13)
    v_mfma_f32_32x32x16_bf16 v[88:103], v[60:63], v[56:59], v[88:103]
    s_waitcnt vmcnt(12)
    v_mfma_f32_32x32x16_bf16 v[104:119], v[64:67], v[56:59], v[104:119]
    buffer_load_dwordx4 v[56:59], v9, s[44:47], s16 offen sc1
    s_waitcnt vmcnt(11)
    v_mfma_f32_32x32x16_bf16 v[120:135], v[60:63], v[72:75], v[120:135]
    buffer_load_dwordx4 v[60:63], v10, s[44:47], s26 offen sc1
    v_mfma_f32_32x32x16_bf16 v[136:151], v[64:67], v[72:75], v[136:151]
    buffer_load_dwordx4 v[64:67], v11, s[44:47], s26 offen sc1
    v_mfma_f32_32x32x16_bf16 v[152:167], v[68:71], v[72:75], v[152:167]
    buffer_load_dwordx4 v[68:71], v12, s[44:47], s26 offen sc1
    buffer_load_dwordx4 v[72:75], v8, s[44:47], s16 offen sc1
    s_add_u32 s16, s16, 4096
    s_add_u32 s26, s26, 81920
    s_cmp_eq_u32 s16, s22
    s_cselect_b32 s16, s20, s16
    s_cselect_b32 s26, s23, s26
    s_waitcnt vmcnt(13)
    v_mfma_f32_32x32x16_bf16 v[88:103], v[20:23], v[16:19], v[88:103]
    s_waitcnt vmcnt(12)
    v_mfma_f32_32x32x16_bf16 v[104:119], v[24:27], v[16:19], v[104:119]
    s_waitcnt vmcnt(10)
    v_mfma_f32_32x32x16_bf16 v[120:135], v[20:23], v[32:35], v[120:135]
    v_mfma_f32_32x32x16_bf16 v[136:151], v[24:27], v[32:35], v[136:151]
    v_mfma_f32_32x32x16_bf16 v[152:167], v[28:31], v[32:35], v[152:167]
    s_waitcnt vmcnt(8)
    v_mfma_f32_32x32x16_bf16 v[88:103], v[40:43], v[36:39], v[88:103]
    s_waitcnt vmcnt(7)
    v_mfma_f32_32x32x16_bf16 v[104:119], v[44:47], v[36:39], v[104:119]
    s_waitcnt vmcnt(5)
    v_mfma_f32_32x32x16_bf16 v[120:135], v[40:43], v[52:55], v[120:135]
    v_mfma_f32_32x32x16_bf16 v[136:151], v[44:47], v[52:55], v[136:151]
    v_mfma_f32_32x32x16_bf16 v[152:167], v[48:51], v[52:55], v[152:167]
    s_waitcnt vmcnt(3)
    v_mfma_f32_32x32x16_bf16 v[88:103], v[60:63], v[56:59], v[88:103]
    s_waitcnt vmcnt(2)
    v_mfma_f32_32x32x16_bf16 v[104:119], v[64:67], v[56:59], v[104:119]
    s_waitcnt vmcnt(0)
    v_mfma_f32_32x32x16_bf16 v[120:135], v[60:63], v[72:75], v[120:135]
    v_mfma_f32_32x32x16_bf16 v[136:151], v[64:67], v[72:75], v[136:151]
    v_mfma_f32_32x32x16_bf16 v[152:167], v[68:71], v[72:75], v[152:167]
    s_setprio 1
    s_sub_u32 s16, s29, 1
    s_and_b32 s16, s16, 3
    s_mul_i32 s16, s16, 5120
    s_add_u32 s16, s16, 2560
    v_add_u32 v8, s16, v5
    s_sub_u32 s16, s29, 2
    s_and_b32 s16, s16, 3
    s_mul_i32 s16, s16, 5120
    s_add_u32 s16, s16, 17920
    v_add_u32 v9, s16, v5
    s_sub_u32 s16, s29, 3
    s_and_b32 s16, s16, 3
    s_mul_i32 s16, s16, 5120
    s_add_u32 s16, s16, 33280
    v_add_u32 v10, s16, v5
    s_sub_u32 s16, s29, 4
    s_and_b32 s16, s16, 3
    s_mul_i32 s16, s16, 5120
    s_add_u32 s16, s16, 48640
    v_add_u32 v11, s16, v5
    s_mul_i32 s17, s29, 15360
    s_add_u32 s17, s17, 2560
    v_add_u32 v12, s17, v5
    s_mov_b32 s48, s4
    s_mov_b32 s49, s5
    s_mov_b32 s50, 2621440
    s_mov_b32 s51, 0x20000
    s_mov_b32 s36, 0xffff0000
L_f_pw0:
    ds_read_b32 v0, v1 offset:64
    s_waitcnt lgkmcnt(0)
    v_cmp_gt_u32 vcc, 8, v0
    s_cbranch_vccz L_f_pwd0
    s_sleep 4
    s_branch L_f_pw0
L_f_pwd0:
    s_cmp_eq_u32 s29, 0
    s_cbranch_scc1 L_f_nx0
    ds_write_b128 v8, v[88:91] offset:0
    ds_write_b128 v8, v[104:107] offset:1024
    ds_write_b128 v8, v[120:123] offset:2048
    ds_write_b128 v8, v[136:139] offset:3072
    ds_write_b128 v8, v[152:155] offset:4096
L_f_nx0:
    s_cmp_eq_u32 s29, 1
    s_cbranch_scc1 L_f_nx1
    ds_write_b128 v9, v[92:95] offset:0
    ds_write_b128 v9, v[108:111] offset:1024
    ds_write_b128 v9, v[124:127] offset:2048
    ds_write_b128 v9, v[140:143] offset:3072
    ds_write_b128 v9, v[156:159] offset:4096
L_f_nx1:
    s_cmp_eq_u32 s29, 2
    s_cbranch_scc1 L_f_nx2
    ds_write_b128 v10, v[96:99] offset:0
    ds_write_b128 v10, v[112:115] offset:1024
    ds_write_b128 v10, v[128:131] offset:2048
    ds_write_b128 v10, v[144:147] offset:3072
    ds_write_b128 v10, v[160:163] offset:4096
L_f_nx2:
    s_cmp_eq_u32 s29, 3
    s_cbranch_scc1 L_f_nx3
    ds_write_b128 v11, v[100:103] offset:0
    ds_write_b128 v11, v[116:119] offset:1024
    ds_write_b128 v11, v[132:135] offset:2048
    ds_write_b128 v11, v[148:151] offset:3072
    ds_write_b128 v11, v[164:167] offset:4096
L_f_nx3:
    v_mov_b32 v0, 4
    ds_write_b32 v7, v0
L_f_pw1:
    ds_read_b32 v0, v15 offset:0
    s_waitcnt lgkmcnt(0)
    v_cmp_gt_u32 vcc, 4, v0
    s_cbranch_vccz L_f_pwd1
    s_sleep 1
    s_branch L_f_pw1
L_f_pwd1:
    ds_read_b128 v[16:19], v12 offset:0
    ds_read_b128 v[20:23], v12 offset:5120
    ds_read_b128 v[24:27], v12 offset:10240
    ds_read_b128 v[28:31], v12 offset:1024
    ds_read_b128 v[32:35], v12 offset:6144
    ds_read_b128 v[36:39], v12 offset:11264
    ds_read_b128 v[40:43], v12 offset:2048
    ds_read_b128 v[44:47], v12 offset:7168
    ds_read_b128 v[48:51], v12 offset:12288
    ds_read_b128 v[52:55], v12 offset:3072
    ds_read_b128 v[56:59], v12 offset:8192
    ds_read_b128 v[60:63], v12 offset:13312
    ds_read_b128 v[64:67], v12 offset:4096
    ds_read_b128 v[68:71], v12 offset:9216
    ds_read_b128 v[72:75], v12 offset:14336
    s_cmp_lg_u32 s29, 0
    s_cbranch_scc1 L_f_x1
    buffer_load_dwordx2 v[92:93], v85, s[48:51], s30 offen
    buffer_load_dwordx2 v[108:109], v85, s[48:51], s31 offen
    buffer_load_dwordx2 v[124:125], v85, s[48:51], s32 offen
    buffer_load_dwordx2 v[140:141], v85, s[48:51], s33 offen
    buffer_load_dwordx2 v[156:157], v85, s[48:51], s34 offen
    s_branch L_f_xd
L_f_x1:
    s_cmp_lg_u32 s29, 1
    s_cbranch_scc1 L_f_x2
    buffer_load_dwordx2 v[96:97], v85, s[48:51], s30 offen
    buffer_load_dwordx2 v[112:113], v85, s[48:51], s31 offen
    buffer_load_dwordx2 v[128:129], v85, s[48:51], s32 offen
    buffer_load_dwordx2 v[144:145], v85, s[48:51], s33 offen
    buffer_load_dwordx2 v[160:161], v85, s[48:51], s34 offen
    s_branch L_f_xd
L_f_x2:
    s_cmp_lg_u32 s29, 2
    s_cbranch_scc1 L_f_x3
    buffer_load_dwordx2 v[100:101], v85, s[48:51], s30 offen
    buffer_load_dwordx2 v[116:117], v85, s[48:51], s31 offen
    buffer_load_dwordx2 v[132:133], v85, s[48:51], s32 offen
    buffer_load_dwordx2 v[148:149], v85, s[48:51], s33 offen
    buffer_load_dwordx2 v[164:165], v85, s[48:51], s34 offen
    s_branch L_f_xd
L_f_x3:
    buffer_load_dwordx2 v[88:89], v85, s[48:51], s30 offen
    buffer_load_dwordx2 v[104:105], v85, s[48:51], s31 offen
    buffer_load_dwordx2 v[120:121], v85, s[48:51], s32 offen
    buffer_load_dwordx2 v[136:137], v85, s[48:51], s33 offen
    buffer_load_dwordx2 v[152:153], v85, s[48:51], s34 offen
L_f_xd:
    s_waitcnt lgkmcnt(0)
    v_mov_b32 v0, 5
    ds_write_b32 v7, v0
    s_setprio 3
    s_mov_b32 s48, s6
    s_mov_b32 s49, s7
    s_mov_b32 s50, 819200
    s_cmp_eq_u32 s29, 0
    s_cbranch_scc1 L_f_nd
L_f_pw2:
    ds_read_b32 v0, v15 offset:0
    s_waitcnt lgkmcnt(0)
    v_cmp_gt_u32 vcc, 5, v0
    s_cbranch_vccz L_f_pwd2
    s_sleep 1
    s_branch L_f_pw2
L_f_pwd2:
L_f_pw3:
    ds_read_b32 v0, v1 offset:64
    s_waitcnt lgkmcnt(0)
    v_cmp_gt_u32 vcc, s54, v0
    s_cbranch_vccz L_f_pwd3
    s_sleep 8
    s_branch L_f_pw3
L_f_pwd3:
    s_add_u32 m0, s53, 0
    s_nop 0
    buffer_load_dwordx4 v76, s[48:51], s52 offen lds
    s_add_u32 s52, s52, 20480
    s_add_u32 m0, s53, 1024
    s_nop 0
    buffer_load_dwordx4 v76, s[48:51], s52 offen lds
    s_add_u32 s52, s52, 20480
    s_add_u32 m0, s53, 2048
    s_nop 0
    buffer_load_dwordx4 v76, s[48:51], s52 offen lds
    s_add_u32 s52, s52, 20480
    s_add_u32 m0, s53, 3072
    s_nop 0
    buffer_load_dwordx4 v76, s[48:51], s52 offen lds
    s_add_u32 s52, s52, 20480
    s_add_u32 m0, s53, 4096
    s_nop 0
    buffer_load_dwordx4 v76, s[48:51], s52 offen lds
    s_add_u32 s52, s52, 20480
    s_add_u32 m0, s53, 5120
    s_nop 0
    buffer_load_dwordx4 v76, s[48:51], s52 offen lds
    s_add_u32 s52, s52, 20480
    s_add_u32 m0, s53, 6144
    s_nop 0
    buffer_load_dwordx4 v76, s[48:51], s52 offen lds
    s_add_u32 s52, s52, 20480
    s_add_u32 m0, s53, 7168
    s_nop 0
    buffer_load_dwordx4 v76, s[48:51], s52 offen lds
    s_add_u32 s52, s52, 20480
    s_add_u32 m0, s53, 8192
    s_nop 0
    buffer_load_dwordx4 v76, s[48:51], s52 offen lds
    s_add_u32 s52, s52, 20480
L_f_pw4:
    ds_read_b32 v0, v1 offset:64
    s_waitcnt lgkmcnt(0)
    v_cmp_gt_u32 vcc, s55, v0
    s_cbranch_vccz L_f_pwd4
    s_sleep 8
    s_branch L_f_pw4
L_f_pwd4:
    s_add_u32 m0, s53, 9216
    s_nop 0
    buffer_load_dwordx4 v76, s[48:51], s52 offen lds
    s_add_u32 s52, s52, s57
    s_add_u32 m0, s53, 10240
    s_nop 0
    buffer_load_dwordx4 v76, s[48:51], s52 offen lds
    s_add_u32 s52, s52, 20480
    s_add_u32 m0, s53, 11264
    s_nop 0
    buffer_load_dwordx4 v76, s[48:51], s52 offen lds
    s_add_u32 s52, s52, 20480
    s_add_u32 m0, s53, 12288
    s_nop 0
    buffer_load_dwordx4 v76, s[48:51], s52 offen lds
    s_add_u32 s52, s52, 20480
    s_add_u32 m0, s53, 13312
    s_nop 0
    buffer_load_dwordx4 v76, s[48:51], s52 offen lds
    s_add_u32 s52, s52, 20480
    s_add_u32 m0, s53, 14336
    s_nop 0
    buffer_load_dwordx4 v76, s[48:51], s52 offen lds
    s_add_u32 s52, s52, 20480
    s_add_u32 m0, s53, 15360
    s_nop 0
    buffer_load_dwordx4 v76, s[48:51], s52 offen lds
    s_add_u32 s52, s52, 20480
    s_add_u32 m0, s53, 16384
    s_nop 0
    buffer_load_dwordx4 v76, s[48:51], s52 offen lds
    s_add_u32 s52, s52, 20480
    s_add_u32 m0, s53, 17408
    s_nop 0
    buffer_load_dwordx4 v76, s[48:51], s52 offen lds
    s_add_u32 s52, s52, 20480
    s_add_u32 m0, s53, 18432
    s_nop 0
    buffer_load_dwordx4 v76, s[48:51], s52 offen lds
    s_add_u32 s52, s52, 20480
L_f_pw5:
    ds_read_b32 v0, v1 offset:64
    s_waitcnt lgkmcnt(0)
    v_cmp_gt_u32 vcc, s63, v0
    s_cbranch_vccz L_f_pwd5
    s_sleep 8
    s_branch L_f_pw5
L_f_pwd5:
    s_add_u32 m0, s53, 19456
    s_nop 0
    buffer_load_dwordx4 v76, s[48:51], s52 offen lds
    s_add_u32 s52, s52, s58
    s_add_u32 m0, s53, 20480
    s_nop 0
    buffer_load_dwordx4 v76, s[48:51], s52 offen lds
    s_add_u32 s52, s52, 20480
    s_add_u32 m0, s53, 21504
    s_nop 0
    buffer_load_dwordx4 v76, s[48:51], s52 offen lds
    s_add_u32 s52, s52, 20480
    s_add_u32 m0, s53, 22528
    s_nop 0
    buffer_load_dwordx4 v76, s[48:51], s52 offen lds
    s_add_u32 s52, s52, 20480
    s_add_u32 m0, s53, 23552
    s_nop 0
    buffer_load_dwordx4 v76, s[48:51], s52 offen lds
    s_add_u32 s52, s52, 20480
    s_add_u32 m0, s53, 24576
    s_nop 0
    buffer_load_dwordx4 v76, s[48:51], s52 offen lds
    s_add_u32 s52, s52, 20480
    s_add_u32 m0, s53, 25600
    s_nop 0
    buffer_load_dwordx4 v76, s[48:51], s52 offen lds
    s_add_u32 s52, s52, 20480
    s_add_u32 m0, s53, 26624
    s_nop 0
    buffer_load_dwordx4 v76, s[48:51], s52 offen lds
    s_add_u32 s52, s52, 20480
    s_add_u32 m0, s53, 27648
    s_nop 0
    buffer_load_dwordx4 v76, s[48:51], s52 offen lds
    s_add_u32 s52, s52, 20480
    s_add_u32 m0, s53, 28672
    s_nop 0
    buffer_load_dwordx4 v76, s[48:51], s52 offen lds
    s_add_u32 s52, s52, 20480
L_f_pw6:
    ds_read_b32 v0, v1 offset:64
    s_waitcnt lgkmcnt(0)
    v_cmp_gt_u32 vcc, s3, v0
    s_cbranch_vccz L_f_pwd6
    s_sleep 8
    s_branch L_f_pw6
L_f_pwd6:
    s_add_u32 m0, s53, 29696
    s_nop 0
    buffer_load_dwordx4 v76, s[48:51], s52 offen lds
    s_add_u32 s52, s52, s59
    s_add_u32 m0, s53, 30720
    s_nop 0
    buffer_load_dwordx4 v76, s[48:51], s52 offen lds
    s_add_u32 s52, s52, 20480
    s_add_u32 m0, s53, 31744
    s_nop 0
    buffer_load_dwordx4 v76, s[48:51], s52 offen lds
    s_add_u32 s52, s52, 20480
    s_add_u32 m0, s53, 32768
    s_nop 0
    buffer_load_dwordx4 v76, s[48:51], s52 offen lds
    s_add_u32 s52, s52, 20480
    s_add_u32 m0, s53, 33792
    s_nop 0
    buffer_load_dwordx4 v76, s[48:51], s52 offen lds
    s_add_u32 s52, s52, 20480
    s_add_u32 m0, s53, 34816
    s_nop 0
    buffer_load_dwordx4 v76, s[48:51], s52 offen lds
    s_add_u32 s52, s52, 20480
    s_add_u32 m0, s53, 35840
    s_nop 0
    buffer_load_dwordx4 v76, s[48:51], s52 offen lds
    s_add_u32 s52, s52, 20480
    s_add_u32 m0, s53, 36864
    s_nop 0
    buffer_load_dwordx4 v76, s[48:51], s52 offen lds
    s_add_u32 s52, s52, 20480
    s_add_u32 m0, s53, 37888
    s_nop 0
    buffer_load_dwordx4 v76, s[48:51], s52 offen lds
    s_add_u32 s52, s52, 20480
    s_add_u32 m0, s53, 38912
    s_nop 0
    buffer_load_dwordx4 v76, s[48:51], s52 offen lds
    s_add_u32 s52, s52, 20480
L_f_pw7:
    ds_read_b32 v0, v1 offset:64
    s_waitcnt lgkmcnt(0)
    v_cmp_gt_u32 vcc, s62, v0
    s_cbranch_vccz L_f_pwd7
    s_sleep 8
    s_branch L_f_pw7
L_f_pwd7:
    s_add_u32 m0, s53, 39936
    s_nop 0
    buffer_load_dwordx4 v76, s[48:51], s52 offen lds
    s_waitcnt vmcnt(0)
L_f_nd:
    v_mov_b32 v0, 6
    ds_write_b32 v7, v0
    s_cmp_eq_u32 s29, 0
    s_cbranch_scc1 L_f_pl
    s_setprio 0
    s_waitcnt vmcnt(0)
    s_cmp_lg_u32 s29, 0
    s_cbranch_scc1 L_f_fin1
    v_add_f32 v16, v16, v88
    v_add_f32 v17, v17, v89
    v_add_f32 v18, v18, v90
    v_add_f32 v19, v19, v91
    v_lshlrev_b32 v88, 16, v92
    v_and_b32 v89, s36, v92
    v_lshlrev_b32 v90, 16, v93
    v_and_b32 v91, s36, v93
    v_add_f32 v20, v20, v24
    v_add_f32 v21, v21, v25
    v_add_f32 v22, v22, v26
    v_add_f32 v23, v23, v27
    v_add_f32 v16, v16, v20
    v_add_f32 v17, v17, v21
    v_add_f32 v18, v18, v22
    v_add_f32 v19, v19, v23
    v_add_f32 v16, v16, v88
    v_add_f32 v17, v17, v89
    v_add_f32 v18, v18, v90
    v_add_f32 v19, v19, v91
    v_add_f32 v28, v28, v104
    v_add_f32 v29, v29, v105
    v_add_f32 v30, v30, v106
    v_add_f32 v31, v31, v107
    v_lshlrev_b32 v104, 16, v108
    v_and_b32 v105, s36, v108
    v_lshlrev_b32 v106, 16, v109
    v_and_b32 v107, s36, v109
    v_add_f32 v32, v32, v36
    v_add_f32 v33, v33, v37
    v_add_f32 v34, v34, v38
    v_add_f32 v35, v35, v39
    v_add_f32 v28, v28, v32
    v_add_f32 v29, v29, v33
    v_add_f32 v30, v30, v34
    v_add_f32 v31, v31, v35
    v_add_f32 v28, v28, v104
    v_add_f32 v29, v29, v105
    v_add_f32 v30, v30, v106
    v_add_f32 v31, v31, v107
    v_add_f32 v40, v40, v120
    v_add_f32 v41, v41, v121
    v_add_f32 v42, v42, v122
    v_add_f32 v43, v43, v123
    v_lshlrev_b32 v120, 16, v124
    v_and_b32 v121, s36, v124
    v_lshlrev_b32 v122, 16, v125
    v_and_b32 v123, s36, v125
    v_add_f32 v44, v44, v48
    v_add_f32 v45, v45, v49
    v_add_f32 v46, v46, v50
    v_add_f32 v47, v47, v51
    v_add_f32 v40, v40, v44
    v_add_f32 v41, v41, v45
    v_add_f32 v42, v42, v46
    v_add_f32 v43, v43, v47
    v_add_f32 v40, v40, v120
    v_add_f32 v41, v41, v121
    v_add_f32 v42, v42, v122
    v_add_f32 v43, v43, v123
    v_add_f32 v52, v52, v136
    v_add_f32 v53, v53, v137
    v_add_f32 v54, v54, v138
    v_add_f32 v55, v55, v139
    v_lshlrev_b32 v136, 16, v140
    v_and_b32 v137, s36, v140
    v_lshlrev_b32 v138, 16, v141
    v_and_b32 v139, s36, v141
    v_add_f32 v56, v56, v60
    v_add_f32 v57, v57, v61
    v_add_f32 v58, v58, v62
    v_add_f32 v59, v59, v63
    v_add_f32 v52, v52, v56
    v_add_f32 v53, v53, v57
    v_add_f32 v54, v54, v58
    v_add_f32 v55, v55, v59
    v_add_f32 v52, v52, v136
    v_add_f32 v53, v53, v137
    v_add_f32 v54, v54, v138
    v_add_f32 v55, v55, v139
    v_add_f32 v64, v64, v152
    v_add_f32 v65, v65, v153
    v_add_f32 v66, v66, v154
    v_add_f32 v67, v67, v155
    v_lshlrev_b32 v152, 16, v156
    v_and_b32 v153, s36, v156
    v_lshlrev_b32 v154, 16, v157
    v_and_b32 v155, s36, v157
    v_add_f32 v68, v68, v72
    v_add_f32 v69, v69, v73
    v_add_f32 v70, v70, v74
    v_add_f32 v71, v71, v75
    v_add_f32 v64, v64, v68
    v_add_f32 v65, v65, v69
    v_add_f32 v66, v66, v70
    v_add_f32 v67, v67, v71
    v_add_f32 v64, v64, v152
    v_add_f32 v65, v65, v153
    v_add_f32 v66, v66, v154
    v_add_f32 v67, v67, v155
    s_branch L_f_find
L_f_fin1:
    s_cmp_lg_u32 s29, 1
    s_cbranch_scc1 L_f_fin2
    v_add_f32 v16, v16, v92
    v_add_f32 v17, v17, v93
    v_add_f32 v18, v18, v94
    v_add_f32 v19, v19, v95
    v_lshlrev_b32 v92, 16, v96
    v_and_b32 v93, s36, v96
    v_lshlrev_b32 v94, 16, v97
    v_and_b32 v95, s36, v97
    v_add_f32 v20, v20, v24
    v_add_f32 v21, v21, v25
    v_add_f32 v22, v22, v26
    v_add_f32 v23, v23, v27
    v_add_f32 v16, v16, v20
    v_add_f32 v17, v17, v21
    v_add_f32 v18, v18, v22
    v_add_f32 v19, v19, v23
    v_add_f32 v16, v16, v92
    v_add_f32 v17, v17, v93
    v_add_f32 v18, v18, v94
    v_add_f32 v19, v19, v95
    v_add_f32 v28, v28, v108
    v_add_f32 v29, v29, v109
    v_add_f32 v30, v30, v110
    v_add_f32 v31, v31, v111
    v_lshlrev_b32 v108, 16, v112
    v_and_b32 v109, s36, v112
    v_lshlrev_b32 v110, 16, v113
    v_and_b32 v111, s36, v113
    v_add_f32 v32, v32, v36
    v_add_f32 v33, v33, v37
    v_add_f32 v34, v34, v38
    v_add_f32 v35, v35, v39
    v_add_f32 v28, v28, v32
    v_add_f32 v29, v29, v33
    v_add_f32 v30, v30, v34
    v_add_f32 v31, v31, v35
    v_add_f32 v28, v28, v108
    v_add_f32 v29, v29, v109
    v_add_f32 v30, v30, v110
    v_add_f32 v31, v31, v111
    v_add_f32 v40, v40, v124
    v_add_f32 v41, v41, v125
    v_add_f32 v42, v42, v126
    v_add_f32 v43, v43, v127
    v_lshlrev_b32 v124, 16, v128
    v_and_b32 v125, s36, v128
    v_lshlrev_b32 v126, 16, v129
    v_and_b32 v127, s36, v129
    v_add_f32 v44, v44, v48
    v_add_f32 v45, v45, v49
    v_add_f32 v46, v46, v50
    v_add_f32 v47, v47, v51
    v_add_f32 v40, v40, v44
    v_add_f32 v41, v41, v45
    v_add_f32 v42, v42, v46
    v_add_f32 v43, v43, v47
    v_add_f32 v40, v40, v124
    v_add_f32 v41, v41, v125
    v_add_f32 v42, v42, v126
    v_add_f32 v43, v43, v127
    v_add_f32 v52, v52, v140
    v_add_f32 v53, v53, v141
    v_add_f32 v54, v54, v142
    v_add_f32 v55, v55, v143
    v_lshlrev_b32 v140, 16, v144
    v_and_b32 v141, s36, v144
    v_lshlrev_b32 v142, 16, v145
    v_and_b32 v143, s36, v145
    v_add_f32 v56, v56, v60
    v_add_f32 v57, v57, v61
    v_add_f32 v58, v58, v62
    v_add_f32 v59, v59, v63
    v_add_f32 v52, v52, v56
    v_add_f32 v53, v53, v57
    v_add_f32 v54, v54, v58
    v_add_f32 v55, v55, v59
    v_add_f32 v52, v52, v140
    v_add_f32 v53, v53, v141
    v_add_f32 v54, v54, v142
    v_add_f32 v55, v55, v143
    v_add_f32 v64, v64, v156
    v_add_f32 v65, v65, v157
    v_add_f32 v66, v66, v158
    v_add_f32 v67, v67, v159
    v_lshlrev_b32 v156, 16, v160
    v_and_b32 v157, s36, v160
    v_lshlrev_b32 v158, 16, v161
    v_and_b32 v159, s36, v161
    v_add_f32 v68, v68, v72
    v_add_f32 v69, v69, v73
    v_add_f32 v70, v70, v74
    v_add_f32 v71, v71, v75
    v_add_f32 v64, v64, v68
    v_add_f32 v65, v65, v69
    v_add_f32 v66, v66, v70
    v_add_f32 v67, v67, v71
    v_add_f32 v64, v64, v156
    v_add_f32 v65, v65, v157
    v_add_f32 v66, v66, v158
    v_add_f32 v67, v67, v159
    s_branch L_f_find
L_f_fin2:
    s_cmp_lg_u32 s29, 2
    s_cbranch_scc1 L_f_fin3
    v_add_f32 v16, v16, v96
    v_add_f32 v17, v17, v97
    v_add_f32 v18, v18, v98
    v_add_f32 v19, v19, v99
    v_lshlrev_b32 v96, 16, v100
    v_and_b32 v97, s36, v100
    v_lshlrev_b32 v98, 16, v101
    v_and_b32 v99, s36, v101
    v_add_f32 v20, v20, v24
    v_add_f32 v21, v21, v25
    v_add_f32 v22, v22, v26
    v_add_f32 v23, v23, v27
    v_add_f32 v16, v16, v20
    v_add_f32 v17, v17, v21
    v_add_f32 v18, v18, v22
    v_add_f32 v19, v19, v23
    v_add_f32 v16, v16, v96
    v_add_f32 v17, v17, v97
    v_add_f32 v18, v18, v98
    v_add_f32 v19, v19, v99
    v_add_f32 v28, v28, v112
    v_add_f32 v29, v29, v113
    v_add_f32 v30, v30, v114
    v_add_f32 v31, v31, v115
    v_lshlrev_b32 v112, 16, v116
    v_and_b32 v113, s36, v116
    v_lshlrev_b32 v114, 16, v117
    v_and_b32 v115, s36, v117
    v_add_f32 v32, v32, v36
    v_add_f32 v33, v33, v37
    v_add_f32 v34, v34, v38
    v_add_f32 v35, v35, v39
    v_add_f32 v28, v28, v32
    v_add_f32 v29, v29, v33
    v_add_f32 v30, v30, v34
    v_add_f32 v31, v31, v35
    v_add_f32 v28, v28, v112
    v_add_f32 v29, v29, v113
    v_add_f32 v30, v30, v114
    v_add_f32 v31, v31, v115
    v_add_f32 v40, v40, v128
    v_add_f32 v41, v41, v129
    v_add_f32 v42, v42, v130
    v_add_f32 v43, v43, v131
    v_lshlrev_b32 v128, 16, v132
    v_and_b32 v129, s36, v132
    v_lshlrev_b32 v130, 16, v133
    v_and_b32 v131, s36, v133
    v_add_f32 v44, v44, v48
    v_add_f32 v45, v45, v49
    v_add_f32 v46, v46, v50
    v_add_f32 v47, v47, v51
    v_add_f32 v40, v40, v44
    v_add_f32 v41, v41, v45
    v_add_f32 v42, v42, v46
    v_add_f32 v43, v43, v47
    v_add_f32 v40, v40, v128
    v_add_f32 v41, v41, v129
    v_add_f32 v42, v42, v130
    v_add_f32 v43, v43, v131
    v_add_f32 v52, v52, v144
    v_add_f32 v53, v53, v145
    v_add_f32 v54, v54, v146
    v_add_f32 v55, v55, v147
    v_lshlrev_b32 v144, 16, v148
    v_and_b32 v145, s36, v148
    v_lshlrev_b32 v146, 16, v149
    v_and_b32 v147, s36, v149
    v_add_f32 v56, v56, v60
    v_add_f32 v57, v57, v61
    v_add_f32 v58, v58, v62
    v_add_f32 v59, v59, v63
    v_add_f32 v52, v52, v56
    v_add_f32 v53, v53, v57
    v_add_f32 v54, v54, v58
    v_add_f32 v55, v55, v59
    v_add_f32 v52, v52, v144
    v_add_f32 v53, v53, v145
    v_add_f32 v54, v54, v146
    v_add_f32 v55, v55, v147
    v_add_f32 v64, v64, v160
    v_add_f32 v65, v65, v161
    v_add_f32 v66, v66, v162
    v_add_f32 v67, v67, v163
    v_lshlrev_b32 v160, 16, v164
    v_and_b32 v161, s36, v164
    v_lshlrev_b32 v162, 16, v165
    v_and_b32 v163, s36, v165
    v_add_f32 v68, v68, v72
    v_add_f32 v69, v69, v73
    v_add_f32 v70, v70, v74
    v_add_f32 v71, v71, v75
    v_add_f32 v64, v64, v68
    v_add_f32 v65, v65, v69
    v_add_f32 v66, v66, v70
    v_add_f32 v67, v67, v71
    v_add_f32 v64, v64, v160
    v_add_f32 v65, v65, v161
    v_add_f32 v66, v66, v162
    v_add_f32 v67, v67, v163
    s_branch L_f_find
L_f_fin3:
    v_add_f32 v16, v16, v100
    v_add_f32 v17, v17, v101
    v_add_f32 v18, v18, v102
    v_add_f32 v19, v19, v103
    v_lshlrev_b32 v100, 16, v88
    v_and_b32 v101, s36, v88
    v_lshlrev_b32 v102, 16, v89
    v_and_b32 v103, s36, v89
    v_add_f32 v20, v20, v24
    v_add_f32 v21, v21, v25
    v_add_f32 v22, v22, v26
    v_add_f32 v23, v23, v27
    v_add_f32 v16, v16, v20
    v_add_f32 v17, v17, v21
    v_add_f32 v18, v18, v22
    v_add_f32 v19, v19, v23
    v_add_f32 v16, v16, v100
    v_add_f32 v17, v17, v101
    v_add_f32 v18, v18, v102
    v_add_f32 v19, v19, v103
    v_add_f32 v28, v28, v116
    v_add_f32 v29, v29, v117
    v_add_f32 v30, v30, v118
    v_add_f32 v31, v31, v119
    v_lshlrev_b32 v116, 16, v104
    v_and_b32 v117, s36, v104
    v_lshlrev_b32 v118, 16, v105
    v_and_b32 v119, s36, v105
    v_add_f32 v32, v32, v36
    v_add_f32 v33, v33, v37
    v_add_f32 v34, v34, v38
    v_add_f32 v35, v35, v39
    v_add_f32 v28, v28, v32
    v_add_f32 v29, v29, v33
    v_add_f32 v30, v30, v34
    v_add_f32 v31, v31, v35
    v_add_f32 v28, v28, v116
    v_add_f32 v29, v29, v117
    v_add_f32 v30, v30, v118
    v_add_f32 v31, v31, v119
    v_add_f32 v40, v40, v132
    v_add_f32 v41, v41, v133
    v_add_f32 v42, v42, v134
    v_add_f32 v43, v43, v135
    v_lshlrev_b32 v132, 16, v120
    v_and_b32 v133, s36, v120
    v_lshlrev_b32 v134, 16, v121
    v_and_b32 v135, s36, v121
    v_add_f32 v44, v44, v48
    v_add_f32 v45, v45, v49
    v_add_f32 v46, v46, v50
    v_add_f32 v47, v47, v51
    v_add_f32 v40, v40, v44
    v_add_f32 v41, v41, v45
    v_add_f32 v42, v42, v46
    v_add_f32 v43, v43, v47
    v_add_f32 v40, v40, v132
    v_add_f32 v41, v41, v133
    v_add_f32 v42, v42, v134
    v_add_f32 v43, v43, v135
    v_add_f32 v52, v52, v148
    v_add_f32 v53, v53, v149
    v_add_f32 v54, v54, v150
    v_add_f32 v55, v55, v151
    v_lshlrev_b32 v148, 16, v136
    v_and_b32 v149, s36, v136
    v_lshlrev_b32 v150, 16, v137
    v_and_b32 v151, s36, v137
    v_add_f32 v56, v56, v60
    v_add_f32 v57, v57, v61
    v_add_f32 v58, v58, v62
    v_add_f32 v59, v59, v63
    v_add_f32 v52, v52, v56
    v_add_f32 v53, v53, v57
    v_add_f32 v54, v54, v58
    v_add_f32 v55, v55, v59
    v_add_f32 v52, v52, v148
    v_add_f32 v53, v53, v149
    v_add_f32 v54, v54, v150
    v_add_f32 v55, v55, v151
    v_add_f32 v64, v64, v164
    v_add_f32 v65, v65, v165
    v_add_f32 v66, v66, v166
    v_add_f32 v67, v67, v167
    v_lshlrev_b32 v164, 16, v152
    v_and_b32 v165, s36, v152
    v_lshlrev_b32 v166, 16, v153
    v_and_b32 v167, s36, v153
    v_add_f32 v68, v68, v72
    v_add_f32 v69, v69, v73
    v_add_f32 v70, v70, v74
    v_add_f32 v71, v71, v75
    v_add_f32 v64, v64, v68
    v_add_f32 v65, v65, v69
    v_add_f32 v66, v66, v70
    v_add_f32 v67, v67, v71
    v_add_f32 v64, v64, v164
    v_add_f32 v65, v65, v165
    v_add_f32 v66, v66, v166
    v_add_f32 v67, v67, v167
L_f_find:
    s_setprio 3
L_f_pw8:
    ds_read_b32 v0, v1 offset:64
    s_waitcnt lgkmcnt(0)
    v_cmp_gt_u32 vcc, 16, v0
    s_cbranch_vccz L_f_pwd8
    s_sleep 1
    s_branch L_f_pw8
L_f_pwd8:
    ds_write_b128 v79, v[16:19] offset:0
    ds_write_b128 v79, v[28:31] offset:1024
    ds_write_b128 v79, v[40:43] offset:2048
    ds_write_b128 v79, v[52:55] offset:3072
    ds_write_b128 v79, v[64:67] offset:4096
    v_mov_b32 v0, 7
    ds_write_b32 v7, v0
    s_waitcnt lgkmcnt(0)
    s_endpgm
L_f_pl:
    s_waitcnt vmcnt(0)
    v_mov_b32 v80, 0
    v_mov_b32 v6, 0
    s_mov_b32 s57, 300000
    s_mov_b32 s58, 0
    s_mov_b32 s59, 0
    s_setprio 0
    v_add_f32 v16, v16, v88
    v_add_f32 v17, v17, v89
    v_add_f32 v18, v18, v90
    v_add_f32 v19, v19, v91
    v_lshlrev_b32 v88, 16, v92
    v_and_b32 v89, s36, v92
    v_lshlrev_b32 v90, 16, v93
    v_and_b32 v91, s36, v93
    v_add_f32 v20, v20, v24
    v_add_f32 v21, v21, v25
    v_add_f32 v22, v22, v26
    v_add_f32 v23, v23, v27
    v_add_f32 v16, v16, v20
    v_add_f32 v17, v17, v21
    v_add_f32 v18, v18, v22
    v_add_f32 v19, v19, v23
    v_add_f32 v16, v16, v88
    v_add_f32 v17, v17, v89
    v_add_f32 v18, v18, v90
    v_add_f32 v19, v19, v91
    v_add_f32 v28, v28, v104
    v_add_f32 v29, v29, v105
    v_add_f32 v30, v30, v106
    v_add_f32 v31, v31, v107
    v_lshlrev_b32 v104, 16, v108
    v_and_b32 v105, s36, v108
    v_lshlrev_b32 v106, 16, v109
    v_and_b32 v107, s36, v109
    v_add_f32 v32, v32, v36
    v_add_f32 v33, v33, v37
    v_add_f32 v34, v34, v38
    v_add_f32 v35, v35, v39
    v_add_f32 v28, v28, v32
    v_add_f32 v29, v29, v33
    v_add_f32 v30, v30, v34
    v_add_f32 v31, v31, v35
    v_add_f32 v28, v28, v104
    v_add_f32 v29, v29, v105
    v_add_f32 v30, v30, v106
    v_add_f32 v31, v31, v107
    v_add_f32 v40, v40, v120
    v_add_f32 v41, v41, v121
    v_add_f32 v42, v42, v122
    v_add_f32 v43, v43, v123
    v_lshlrev_b32 v120, 16, v124
    v_and_b32 v121, s36, v124
    v_lshlrev_b32 v122, 16, v125
    v_and_b32 v123, s36, v125
    v_add_f32 v44, v44, v48
    v_add_f32 v45, v45, v49
    v_add_f32 v46, v46, v50
    v_add_f32 v47, v47, v51
    v_add_f32 v40, v40, v44
    v_add_f32 v41, v41, v45
    v_add_f32 v42, v42, v46
    v_add_f32 v43, v43, v47
    v_add_f32 v40, v40, v120
    v_add_f32 v41, v41, v121
    v_add_f32 v42, v42, v122
    v_add_f32 v43, v43, v123
    v_add_f32 v52, v52, v136
    v_add_f32 v53, v53, v137
    v_add_f32 v54, v54, v138
    v_add_f32 v55, v55, v139
    v_lshlrev_b32 v136, 16, v140
    v_and_b32 v137, s36, v140
    v_lshlrev_b32 v138, 16, v141
    v_and_b32 v139, s36, v141
    v_add_f32 v56, v56, v60
    v_add_f32 v57, v57, v61
    v_add_f32 v58, v58, v62
    v_add_f32 v59, v59, v63
    v_add_f32 v52, v52, v56
    v_add_f32 v53, v53, v57
    v_add_f32 v54, v54, v58
    v_add_f32 v55, v55, v59
    v_add_f32 v52, v52, v136
    v_add_f32 v53, v53, v137
    v_add_f32 v54, v54, v138
    v_add_f32 v55, v55, v139
    v_add_f32 v64, v64, v152
    v_add_f32 v65, v65, v153
    v_add_f32 v66, v66, v154
    v_add_f32 v67, v67, v155
    v_lshlrev_b32 v152, 16, v156
    v_and_b32 v153, s36, v156
    v_lshlrev_b32 v154, 16, v157
    v_and_b32 v155, s36, v157
    v_add_f32 v68, v68, v72
    v_add_f32 v69, v69, v73
    v_add_f32 v70, v70, v74
    v_add_f32 v71, v71, v75
    v_add_f32 v64, v64, v68
    v_add_f32 v65, v65, v69
    v_add_f32 v66, v66, v70
    v_add_f32 v67, v67, v71
    v_add_f32 v64, v64, v152
    v_add_f32 v65, v65, v153
    v_add_f32 v66, v66, v154
    v_add_f32 v67, v67, v155
    s_setprio 3
L_f_pw9:
    ds_read_b32 v0, v1 offset:64
    s_waitcnt lgkmcnt(0)
    v_cmp_gt_u32 vcc, 13, v0
    s_cbranch_vccz L_f_pwd9
    s_sleep 8
    s_branch L_f_pw9
L_f_pwd9:
L_f_rp:
    s_sub_u32 s59, s59, 1
    s_cbranch_scc0 L_f_np
    s_mov_b32 s59, 12
    s_waitcnt vmcnt(0)
    buffer_load_dword v80, v84, s[44:47], s56 offen sc1
L_f_np:
    ds_read_b32 v0, v1 offset:64
    v_cmp_ne_u32 s[60:61], 0, v80
    s_sub_u32 s57, s57, 1
    s_cselect_b64 s[60:61], -1, s[60:61]
    s_cselect_b32 s57, 0, s57
    v_mov_b32 v8, s60
    v_mov_b32 v9, s61
    ds_write_b64 v6, v[8:9] offset:96
    s_cmp_lg_u32 s58, 0
    s_cbranch_scc1 L_f_rr
    s_waitcnt lgkmcnt(1)
    v_cmp_gt_u32 vcc, 16, v0
    s_cbranch_vccnz L_f_rs
    ds_write_b128 v79, v[16:19] offset:0
    ds_write_b128 v79, v[28:31] offset:1024
    ds_write_b128 v79, v[40:43] offset:2048
    ds_write_b128 v79, v[52:55] offset:3072
    ds_write_b128 v79, v[64:67] offset:4096
    v_mov_b32 v0, 7
    ds_write_b32 v7, v0
    s_mov_b32 s58, 1
L_f_rr:
    s_cmp_eq_u64 s[60:61], -1
    s_cbranch_scc1 L_f_go
L_f_rs:
    s_sleep 1
    s_branch L_f_rp
L_f_go:
    s_waitcnt vmcnt(0) lgkmcnt(0)
L_f_end:
    s_endpgm
.section .rodata,"a"
.p2align 6
.amdhsa_kernel fused_kernel
.amdhsa_next_free_vgpr 168
.amdhsa_next_free_sgpr 72
.amdhsa_accum_offset 168
.amdhsa_group_segment_fixed_size 0
.amdhsa_kernarg_size 72
.amdhsa_user_sgpr_count 2
.amdhsa_user_sgpr_kernarg_segment_ptr 1
.amdhsa_system_sgpr_workgroup_id_x 1
.amdhsa_float_denorm_mode_32 3
.end_amdhsa_kernel
```
